```python
import torch

def _softmax(x, axis=-1):
    return torch.softmax(x, dim=axis)

def _gelu(x):
    return torch.nn.functional.gelu(x, approximate='tanh')

def _silu(x):
    return torch.nn.functional.silu(x)

def _sigmoid(x):
    return torch.sigmoid(x)

def _layernorm(x, axis=-1, eps=1e-05):
    m = x.mean(dim=axis, keepdim=True)
    v = x.var(dim=axis, keepdim=True, unbiased=False)
    return (x - m) / torch.sqrt(v + eps)

def _scatter_add(tgt, idx, src, axis=0):
    return tgt.clone().index_add_(axis, idx, src)

def _segment_sum(src, seg, n):
    out = torch.zeros((n,) + src.shape[1:], dtype=src.dtype)
    return out.index_add_(0, seg, src)

def _pad(x, pw):
    flat = tuple((v for pair in reversed(pw) for v in pair))
    return torch.nn.functional.pad(x, flat)
kernel_name = 'sequential_preLN__memory_aug_recurrent_mem_tr__dense_activation_relu__prompt'

def setup_inputs():

    _w = lambda a: (lambda t: t.to(torch.bfloat16) if t.is_floating_point() else t)(torch.as_tensor(a))

    def _A_setup():
        B, S, Dm = (1, 2048, 640)
        H, Dh = (32, 128)
        M, seg = (8, 32)
        seg = min(seg, S)
        S = S // seg * seg
        return {'x': _w((lambda *s: torch.randn(*s, dtype=torch.bfloat16) * 0.05)(B, S, Dm)), 'mem0': _w((lambda *s: torch.randn(*s, dtype=torch.bfloat16) * 0.2)(B, M, Dm)), 'Wq': _w((lambda *s: torch.randn(*s, dtype=torch.bfloat16) * 1.6)(Dm, H, Dh) * Dm ** (-0.5)), 'Wk': _w((lambda *s: torch.randn(*s, dtype=torch.bfloat16) * 1.6)(Dm, H, Dh) * Dm ** (-0.5)), 'Wv': _w((lambda *s: torch.randn(*s, dtype=torch.bfloat16) * 0.2)(Dm, H, Dh) * Dm ** (-0.5)), 'Wo': _w((lambda *s: torch.randn(*s, dtype=torch.bfloat16) * 0.2)(H, Dh, Dm) * (H * Dh) ** (-0.5)), 'seg_len': seg}
    _A_in = _A_setup()

    def _B_setup():
        B, S, D, Dff = (1, 2048, 640, 1728)
        return {'x': _w((lambda *s: torch.randn(*s, dtype=torch.bfloat16) * 0.05)(B, S, D)), 'w1': _w((lambda *s: torch.randn(*s, dtype=torch.bfloat16) * 0.05)(D, Dff)), 'w2': _w((lambda *s: torch.randn(*s, dtype=torch.bfloat16) * 0.05)(Dff, D))}
    _B_in = _B_setup()
    return {'A_x': _A_in['x'], 'A_mem0': _A_in['mem0'], 'A_Wq': _A_in['Wq'], 'A_Wk': _A_in['Wk'], 'A_Wv': _A_in['Wv'], 'A_Wo': _A_in['Wo'], 'A_seg_len': _A_in['seg_len'], 'B_x': _B_in['x'], 'B_w1': _B_in['w1'], 'B_w2': _B_in['w2']}

def reference(A_x, A_mem0, A_Wq, A_Wk, A_Wv, A_Wo, A_seg_len, B_x, B_w1, B_w2):

    def _A_ref(x, mem0, Wq, Wk, Wv, Wo, seg_len):
        B, S, Dm = x.shape
        H, Dh = (Wq.shape[1], Wq.shape[2])
        M = mem0.shape[1]
        scale = Dh ** (-0.5)
        n_seg = S // seg_len
        L = M + seg_len
        idx = torch.arange(L)
        mask = (idx[:, None] < M) | (idx[:, None] >= idx[None, :])
        mem = mem0
        outs = []
        for s in range(n_seg):
            xs = x[:, s * seg_len:(s + 1) * seg_len, :].clone()
            h = torch.concatenate([mem, xs], axis=1)
            q = torch.einsum('btd,dhe->bhte', h, Wq)
            k = torch.einsum('btd,dhe->bhte', h, Wk)
            v = torch.einsum('btd,dhe->bhte', h, Wv)
            scores = torch.einsum('bhqe,bhke->bhqk', q, k) * scale
            scores = torch.where(mask[None, None], scores, -1000000000.0)
            p = _softmax(scores, axis=-1)
            o = torch.einsum('bhqk,bhke->bhqe', p, v)
            o = torch.einsum('bhte,hed->btd', o, Wo)
            mem = o[:, :M, :].clone()
            outs.append(o[:, M:, :])
        return torch.concatenate(outs, axis=1)

    def _B_ref(x, w1, w2):
        h = torch.einsum('bsd,df->bsf', x, w1)
        zero = torch.zeros_like(h)
        h = torch.maximum(h, zero)
        return torch.einsum('bsf,fd->bsd', h, w2)
    x = A_x
    h = x + _A_ref(_layernorm(x, axis=-1), A_mem0, A_Wq, A_Wk, A_Wv, A_Wo, A_seg_len)
    h2 = h + _B_ref(_layernorm(h, axis=-1), B_w1, B_w2)
    return h2
```

```asm
; @launch kernel=prep_kernel grid=(256,1,1) block=(256,1,1) lds=0
; @launch kernel=main_kernel grid=(256,1,1) block=(256,1,1) lds=163840
.amdgcn_target "amdgcn-amd-amdhsa--gfx950"
.text
.globl prep_kernel
.p2align 8
.type prep_kernel,@function
prep_kernel:
    s_cmp_ge_u32 s2, 256
    s_cbranch_scc1 L_prep_end
    s_load_dwordx2 s[4:5], s[0:1], 0
    s_load_dwordx2 s[40:41], s[0:1], 8
    s_load_dwordx2 s[8:9], s[0:1], 16
    s_load_dwordx2 s[12:13], s[0:1], 24
    s_load_dwordx2 s[16:17], s[0:1], 32
    s_load_dwordx2 s[20:21], s[0:1], 40
    s_load_dwordx2 s[24:25], s[0:1], 64
    s_load_dwordx2 s[28:29], s[0:1], 72
    s_load_dwordx2 s[32:33], s[0:1], 80
    s_load_dwordx2 s[36:37], s[0:1], 96
    s_mov_b32 s6, 2621440
    s_mov_b32 s7, 0x20000
    s_mov_b32 s42, 10240
    s_mov_b32 s43, 0x20000
    s_mov_b32 s10, 5242880
    s_mov_b32 s11, 0x20000
    s_mov_b32 s14, 5242880
    s_mov_b32 s15, 0x20000
    s_mov_b32 s18, 5242880
    s_mov_b32 s19, 0x20000
    s_mov_b32 s22, 5242880
    s_mov_b32 s23, 0x20000
    s_mov_b32 s26, 2211840
    s_mov_b32 s27, 0x20000
    s_mov_b32 s30, 2211840
    s_mov_b32 s31, 0x20000
    s_mov_b32 s34, 2621440
    s_mov_b32 s35, 0x20000
    s_mov_b32 s38, 268435456
    s_mov_b32 s39, 0x20000
    s_waitcnt lgkmcnt(0)
    s_and_b32 s5, s5, 0xffff
    s_and_b32 s41, s41, 0xffff
    s_and_b32 s9, s9, 0xffff
    s_and_b32 s13, s13, 0xffff
    s_and_b32 s17, s17, 0xffff
    s_and_b32 s21, s21, 0xffff
    s_and_b32 s25, s25, 0xffff
    s_and_b32 s29, s29, 0xffff
    s_and_b32 s33, s33, 0xffff
    s_and_b32 s37, s37, 0xffff
    s_cmp_ge_u32 s2, 128
    s_cbranch_scc1 L_prep_fill
    v_lshrrev_b32 v1, 4, v0
    v_and_b32 v2, 15, v0
    v_mul_u32_u24 v3, 1280, v1
    v_lshl_add_u32 v3, v2, 4, v3
    s_mul_i32 s48, s2, 20480
    buffer_load_dwordx4 v[8:11], v3, s[4:7], s48 offen offset:0
    buffer_load_dwordx4 v[12:15], v3, s[4:7], s48 offen offset:256
    buffer_load_dwordx4 v[16:19], v3, s[4:7], s48 offen offset:512
    buffer_load_dwordx4 v[20:23], v3, s[4:7], s48 offen offset:768
    buffer_load_dwordx4 v[24:27], v3, s[4:7], s48 offen offset:1024
    v_mov_b32 v4, 0
    v_mov_b32 v5, 0
    v_mov_b32 v6, 0
    v_mov_b32 v7, 0
    v_lshlrev_b32 v28, 4, v0
    s_mul_i32 s49, s2, 2048
    s_add_u32 s49, s49, 121634816
    v_cmp_gt_u32 vcc, 128, v0
    s_and_saveexec_b64 s[50:51], vcc
    s_cbranch_execz L_prep_nz
    buffer_store_dwordx4 v[4:7], v28, s[36:39], s49 offen
L_prep_nz:
    s_mov_b64 exec, -1
    s_waitcnt vmcnt(0)
    v_lshlrev_b32 v32, 16, v8
    v_and_b32 v33, 0xffff0000, v8
    v_lshlrev_b32 v34, 16, v9
    v_and_b32 v35, 0xffff0000, v9
    v_lshlrev_b32 v36, 16, v10
    v_and_b32 v37, 0xffff0000, v10
    v_lshlrev_b32 v38, 16, v11
    v_and_b32 v39, 0xffff0000, v11
    v_lshlrev_b32 v40, 16, v12
    v_and_b32 v41, 0xffff0000, v12
    v_lshlrev_b32 v42, 16, v13
    v_and_b32 v43, 0xffff0000, v13
    v_lshlrev_b32 v44, 16, v14
    v_and_b32 v45, 0xffff0000, v14
    v_lshlrev_b32 v46, 16, v15
    v_and_b32 v47, 0xffff0000, v15
    v_lshlrev_b32 v48, 16, v16
    v_and_b32 v49, 0xffff0000, v16
    v_lshlrev_b32 v50, 16, v17
    v_and_b32 v51, 0xffff0000, v17
    v_lshlrev_b32 v52, 16, v18
    v_and_b32 v53, 0xffff0000, v18
    v_lshlrev_b32 v54, 16, v19
    v_and_b32 v55, 0xffff0000, v19
    v_lshlrev_b32 v56, 16, v20
    v_and_b32 v57, 0xffff0000, v20
    v_lshlrev_b32 v58, 16, v21
    v_and_b32 v59, 0xffff0000, v21
    v_lshlrev_b32 v60, 16, v22
    v_and_b32 v61, 0xffff0000, v22
    v_lshlrev_b32 v62, 16, v23
    v_and_b32 v63, 0xffff0000, v23
    v_lshlrev_b32 v64, 16, v24
    v_and_b32 v65, 0xffff0000, v24
    v_lshlrev_b32 v66, 16, v25
    v_and_b32 v67, 0xffff0000, v25
    v_lshlrev_b32 v68, 16, v26
    v_and_b32 v69, 0xffff0000, v26
    v_lshlrev_b32 v70, 16, v27
    v_and_b32 v71, 0xffff0000, v27
    v_add_f32 v72, v32, v33
    v_add_f32 v72, v72, v34
    v_add_f32 v72, v72, v35
    v_add_f32 v72, v72, v36
    v_add_f32 v72, v72, v37
    v_add_f32 v72, v72, v38
    v_add_f32 v72, v72, v39
    v_add_f32 v72, v72, v40
    v_add_f32 v72, v72, v41
    v_add_f32 v72, v72, v42
    v_add_f32 v72, v72, v43
    v_add_f32 v72, v72, v44
    v_add_f32 v72, v72, v45
    v_add_f32 v72, v72, v46
    v_add_f32 v72, v72, v47
    v_add_f32 v72, v72, v48
    v_add_f32 v72, v72, v49
    v_add_f32 v72, v72, v50
    v_add_f32 v72, v72, v51
    v_add_f32 v72, v72, v52
    v_add_f32 v72, v72, v53
    v_add_f32 v72, v72, v54
    v_add_f32 v72, v72, v55
    v_add_f32 v72, v72, v56
    v_add_f32 v72, v72, v57
    v_add_f32 v72, v72, v58
    v_add_f32 v72, v72, v59
    v_add_f32 v72, v72, v60
    v_add_f32 v72, v72, v61
    v_add_f32 v72, v72, v62
    v_add_f32 v72, v72, v63
    v_add_f32 v72, v72, v64
    v_add_f32 v72, v72, v65
    v_add_f32 v72, v72, v66
    v_add_f32 v72, v72, v67
    v_add_f32 v72, v72, v68
    v_add_f32 v72, v72, v69
    v_add_f32 v72, v72, v70
    v_add_f32 v72, v72, v71
    s_nop 1
    v_add_f32_dpp v72, v72, v72 row_ror:8 row_mask:0xf bank_mask:0xf
    s_nop 1
    v_add_f32_dpp v72, v72, v72 row_ror:4 row_mask:0xf bank_mask:0xf
    s_nop 1
    v_add_f32_dpp v72, v72, v72 row_ror:2 row_mask:0xf bank_mask:0xf
    s_nop 1
    v_add_f32_dpp v72, v72, v72 row_ror:1 row_mask:0xf bank_mask:0xf
    v_mul_f32 v73, 0x3acccccd, v72
    v_mov_b32 v74, 0
    v_sub_f32 v75, v32, v73
    v_fmac_f32 v74, v75, v75
    v_sub_f32 v75, v33, v73
    v_fmac_f32 v74, v75, v75
    v_sub_f32 v75, v34, v73
    v_fmac_f32 v74, v75, v75
    v_sub_f32 v75, v35, v73
    v_fmac_f32 v74, v75, v75
    v_sub_f32 v75, v36, v73
    v_fmac_f32 v74, v75, v75
    v_sub_f32 v75, v37, v73
    v_fmac_f32 v74, v75, v75
    v_sub_f32 v75, v38, v73
    v_fmac_f32 v74, v75, v75
    v_sub_f32 v75, v39, v73
    v_fmac_f32 v74, v75, v75
    v_sub_f32 v75, v40, v73
    v_fmac_f32 v74, v75, v75
    v_sub_f32 v75, v41, v73
    v_fmac_f32 v74, v75, v75
    v_sub_f32 v75, v42, v73
    v_fmac_f32 v74, v75, v75
    v_sub_f32 v75, v43, v73
    v_fmac_f32 v74, v75, v75
    v_sub_f32 v75, v44, v73
    v_fmac_f32 v74, v75, v75
    v_sub_f32 v75, v45, v73
    v_fmac_f32 v74, v75, v75
    v_sub_f32 v75, v46, v73
    v_fmac_f32 v74, v75, v75
    v_sub_f32 v75, v47, v73
    v_fmac_f32 v74, v75, v75
    v_sub_f32 v75, v48, v73
    v_fmac_f32 v74, v75, v75
    v_sub_f32 v75, v49, v73
    v_fmac_f32 v74, v75, v75
    v_sub_f32 v75, v50, v73
    v_fmac_f32 v74, v75, v75
    v_sub_f32 v75, v51, v73
    v_fmac_f32 v74, v75, v75
    v_sub_f32 v75, v52, v73
    v_fmac_f32 v74, v75, v75
    v_sub_f32 v75, v53, v73
    v_fmac_f32 v74, v75, v75
    v_sub_f32 v75, v54, v73
    v_fmac_f32 v74, v75, v75
    v_sub_f32 v75, v55, v73
    v_fmac_f32 v74, v75, v75
    v_sub_f32 v75, v56, v73
    v_fmac_f32 v74, v75, v75
    v_sub_f32 v75, v57, v73
    v_fmac_f32 v74, v75, v75
    v_sub_f32 v75, v58, v73
    v_fmac_f32 v74, v75, v75
    v_sub_f32 v75, v59, v73
    v_fmac_f32 v74, v75, v75
    v_sub_f32 v75, v60, v73
    v_fmac_f32 v74, v75, v75
    v_sub_f32 v75, v61, v73
    v_fmac_f32 v74, v75, v75
    v_sub_f32 v75, v62, v73
    v_fmac_f32 v74, v75, v75
    v_sub_f32 v75, v63, v73
    v_fmac_f32 v74, v75, v75
    v_sub_f32 v75, v64, v73
    v_fmac_f32 v74, v75, v75
    v_sub_f32 v75, v65, v73
    v_fmac_f32 v74, v75, v75
    v_sub_f32 v75, v66, v73
    v_fmac_f32 v74, v75, v75
    v_sub_f32 v75, v67, v73
    v_fmac_f32 v74, v75, v75
    v_sub_f32 v75, v68, v73
    v_fmac_f32 v74, v75, v75
    v_sub_f32 v75, v69, v73
    v_fmac_f32 v74, v75, v75
    v_sub_f32 v75, v70, v73
    v_fmac_f32 v74, v75, v75
    v_sub_f32 v75, v71, v73
    v_fmac_f32 v74, v75, v75
    s_nop 1
    v_add_f32_dpp v74, v74, v74 row_ror:8 row_mask:0xf bank_mask:0xf
    s_nop 1
    v_add_f32_dpp v74, v74, v74 row_ror:4 row_mask:0xf bank_mask:0xf
    s_nop 1
    v_add_f32_dpp v74, v74, v74 row_ror:2 row_mask:0xf bank_mask:0xf
    s_nop 1
    v_add_f32_dpp v74, v74, v74 row_ror:1 row_mask:0xf bank_mask:0xf
    v_mul_f32 v74, 0x3acccccd, v74
    v_cvt_pk_bf16_f32 v74, v74, v74
    v_lshlrev_b32 v74, 16, v74
    v_add_f32 v74, 0x3727c5ac, v74
    v_cvt_pk_bf16_f32 v74, v74, v74
    v_lshlrev_b32 v74, 16, v74
    v_sqrt_f32 v74, v74
    s_nop 0
    v_cvt_pk_bf16_f32 v74, v74, v74
    v_lshlrev_b32 v74, 16, v74
    v_rcp_f32 v74, v74
    v_cvt_pk_bf16_f32 v73, v73, v73
    v_lshlrev_b32 v73, 16, v73
    v_sub_f32 v32, v32, v73
    v_sub_f32 v33, v33, v73
    v_cvt_pk_bf16_f32 v75, v32, v33
    v_lshlrev_b32 v32, 16, v75
    v_and_b32 v33, 0xffff0000, v75
    v_mul_f32 v32, v32, v74
    v_mul_f32 v33, v33, v74
    v_sub_f32 v34, v34, v73
    v_sub_f32 v35, v35, v73
    v_cvt_pk_bf16_f32 v75, v34, v35
    v_lshlrev_b32 v34, 16, v75
    v_and_b32 v35, 0xffff0000, v75
    v_mul_f32 v34, v34, v74
    v_mul_f32 v35, v35, v74
    v_sub_f32 v36, v36, v73
    v_sub_f32 v37, v37, v73
    v_cvt_pk_bf16_f32 v75, v36, v37
    v_lshlrev_b32 v36, 16, v75
    v_and_b32 v37, 0xffff0000, v75
    v_mul_f32 v36, v36, v74
    v_mul_f32 v37, v37, v74
    v_sub_f32 v38, v38, v73
    v_sub_f32 v39, v39, v73
    v_cvt_pk_bf16_f32 v75, v38, v39
    v_lshlrev_b32 v38, 16, v75
    v_and_b32 v39, 0xffff0000, v75
    v_mul_f32 v38, v38, v74
    v_mul_f32 v39, v39, v74
    v_sub_f32 v40, v40, v73
    v_sub_f32 v41, v41, v73
    v_cvt_pk_bf16_f32 v75, v40, v41
    v_lshlrev_b32 v40, 16, v75
    v_and_b32 v41, 0xffff0000, v75
    v_mul_f32 v40, v40, v74
    v_mul_f32 v41, v41, v74
    v_sub_f32 v42, v42, v73
    v_sub_f32 v43, v43, v73
    v_cvt_pk_bf16_f32 v75, v42, v43
    v_lshlrev_b32 v42, 16, v75
    v_and_b32 v43, 0xffff0000, v75
    v_mul_f32 v42, v42, v74
    v_mul_f32 v43, v43, v74
    v_sub_f32 v44, v44, v73
    v_sub_f32 v45, v45, v73
    v_cvt_pk_bf16_f32 v75, v44, v45
    v_lshlrev_b32 v44, 16, v75
    v_and_b32 v45, 0xffff0000, v75
    v_mul_f32 v44, v44, v74
    v_mul_f32 v45, v45, v74
    v_sub_f32 v46, v46, v73
    v_sub_f32 v47, v47, v73
    v_cvt_pk_bf16_f32 v75, v46, v47
    v_lshlrev_b32 v46, 16, v75
    v_and_b32 v47, 0xffff0000, v75
    v_mul_f32 v46, v46, v74
    v_mul_f32 v47, v47, v74
    v_sub_f32 v48, v48, v73
    v_sub_f32 v49, v49, v73
    v_cvt_pk_bf16_f32 v75, v48, v49
    v_lshlrev_b32 v48, 16, v75
    v_and_b32 v49, 0xffff0000, v75
    v_mul_f32 v48, v48, v74
    v_mul_f32 v49, v49, v74
    v_sub_f32 v50, v50, v73
    v_sub_f32 v51, v51, v73
    v_cvt_pk_bf16_f32 v75, v50, v51
    v_lshlrev_b32 v50, 16, v75
    v_and_b32 v51, 0xffff0000, v75
    v_mul_f32 v50, v50, v74
    v_mul_f32 v51, v51, v74
    v_sub_f32 v52, v52, v73
    v_sub_f32 v53, v53, v73
    v_cvt_pk_bf16_f32 v75, v52, v53
    v_lshlrev_b32 v52, 16, v75
    v_and_b32 v53, 0xffff0000, v75
    v_mul_f32 v52, v52, v74
    v_mul_f32 v53, v53, v74
    v_sub_f32 v54, v54, v73
    v_sub_f32 v55, v55, v73
    v_cvt_pk_bf16_f32 v75, v54, v55
    v_lshlrev_b32 v54, 16, v75
    v_and_b32 v55, 0xffff0000, v75
    v_mul_f32 v54, v54, v74
    v_mul_f32 v55, v55, v74
    v_sub_f32 v56, v56, v73
    v_sub_f32 v57, v57, v73
    v_cvt_pk_bf16_f32 v75, v56, v57
    v_lshlrev_b32 v56, 16, v75
    v_and_b32 v57, 0xffff0000, v75
    v_mul_f32 v56, v56, v74
    v_mul_f32 v57, v57, v74
    v_sub_f32 v58, v58, v73
    v_sub_f32 v59, v59, v73
    v_cvt_pk_bf16_f32 v75, v58, v59
    v_lshlrev_b32 v58, 16, v75
    v_and_b32 v59, 0xffff0000, v75
    v_mul_f32 v58, v58, v74
    v_mul_f32 v59, v59, v74
    v_sub_f32 v60, v60, v73
    v_sub_f32 v61, v61, v73
    v_cvt_pk_bf16_f32 v75, v60, v61
    v_lshlrev_b32 v60, 16, v75
    v_and_b32 v61, 0xffff0000, v75
    v_mul_f32 v60, v60, v74
    v_mul_f32 v61, v61, v74
    v_sub_f32 v62, v62, v73
    v_sub_f32 v63, v63, v73
    v_cvt_pk_bf16_f32 v75, v62, v63
    v_lshlrev_b32 v62, 16, v75
    v_and_b32 v63, 0xffff0000, v75
    v_mul_f32 v62, v62, v74
    v_mul_f32 v63, v63, v74
    v_sub_f32 v64, v64, v73
    v_sub_f32 v65, v65, v73
    v_cvt_pk_bf16_f32 v75, v64, v65
    v_lshlrev_b32 v64, 16, v75
    v_and_b32 v65, 0xffff0000, v75
    v_mul_f32 v64, v64, v74
    v_mul_f32 v65, v65, v74
    v_sub_f32 v66, v66, v73
    v_sub_f32 v67, v67, v73
    v_cvt_pk_bf16_f32 v75, v66, v67
    v_lshlrev_b32 v66, 16, v75
    v_and_b32 v67, 0xffff0000, v75
    v_mul_f32 v66, v66, v74
    v_mul_f32 v67, v67, v74
    v_sub_f32 v68, v68, v73
    v_sub_f32 v69, v69, v73
    v_cvt_pk_bf16_f32 v75, v68, v69
    v_lshlrev_b32 v68, 16, v75
    v_and_b32 v69, 0xffff0000, v75
    v_mul_f32 v68, v68, v74
    v_mul_f32 v69, v69, v74
    v_sub_f32 v70, v70, v73
    v_sub_f32 v71, v71, v73
    v_cvt_pk_bf16_f32 v75, v70, v71
    v_lshlrev_b32 v70, 16, v75
    v_and_b32 v71, 0xffff0000, v75
    v_mul_f32 v70, v70, v74
    v_mul_f32 v71, v71, v74
    v_cvt_pk_bf16_f32 v8, v32, v33
    v_cvt_pk_bf16_f32 v9, v34, v35
    v_cvt_pk_bf16_f32 v10, v36, v37
    v_cvt_pk_bf16_f32 v11, v38, v39
    v_cvt_pk_bf16_f32 v12, v40, v41
    v_cvt_pk_bf16_f32 v13, v42, v43
    v_cvt_pk_bf16_f32 v14, v44, v45
    v_cvt_pk_bf16_f32 v15, v46, v47
    v_cvt_pk_bf16_f32 v16, v48, v49
    v_cvt_pk_bf16_f32 v17, v50, v51
    v_cvt_pk_bf16_f32 v18, v52, v53
    v_cvt_pk_bf16_f32 v19, v54, v55
    v_cvt_pk_bf16_f32 v20, v56, v57
    v_cvt_pk_bf16_f32 v21, v58, v59
    v_cvt_pk_bf16_f32 v22, v60, v61
    v_cvt_pk_bf16_f32 v23, v62, v63
    v_cvt_pk_bf16_f32 v24, v64, v65
    v_cvt_pk_bf16_f32 v25, v66, v67
    v_cvt_pk_bf16_f32 v26, v68, v69
    v_cvt_pk_bf16_f32 v27, v70, v71
    v_lshrrev_b32 v4, 2, v2
    v_lshlrev_b32 v4, 11, v4
    v_and_b32 v5, 3, v2
    v_lshl_add_u32 v4, v5, 8, v4
    v_lshl_add_u32 v4, v1, 4, v4
    s_lshr_b32 s48, s2, 1
    s_mul_i32 s48, s48, 40960
    s_and_b32 s49, s2, 1
    s_lshl_b32 s49, s49, 10
    s_add_u32 s48, s48, s49
    s_add_u32 s49, s48, 0
    buffer_store_dwordx4 v[8:11], v4, s[36:39], s49 offen
    s_add_u32 s49, s48, 8192
    buffer_store_dwordx4 v[12:15], v4, s[36:39], s49 offen
    s_add_u32 s49, s48, 16384
    buffer_store_dwordx4 v[16:19], v4, s[36:39], s49 offen
    s_add_u32 s49, s48, 24576
    buffer_store_dwordx4 v[20:23], v4, s[36:39], s49 offen
    s_add_u32 s49, s48, 32768
    buffer_store_dwordx4 v[24:27], v4, s[36:39], s49 offen
    s_endpgm
L_prep_fill:
    s_cmp_eq_u32 s2, 255
    s_cbranch_scc1 L_prep_mem0
    v_mov_b32 v4, -1
    v_mov_b32 v5, -1
    v_mov_b32 v6, -1
    v_mov_b32 v7, -1
    v_lshlrev_b32 v1, 4, v0
    s_sub_u32 s48, s2, 128
    s_mul_i32 s48, s48, 20480
    s_add_u32 s49, s48, 117460992
    buffer_store_dwordx4 v[4:7], v1, s[36:39], s49 offen
    s_add_u32 s49, s48, 117465088
    buffer_store_dwordx4 v[4:7], v1, s[36:39], s49 offen
    s_add_u32 s49, s48, 117469184
    buffer_store_dwordx4 v[4:7], v1, s[36:39], s49 offen
    s_add_u32 s49, s48, 117473280
    buffer_store_dwordx4 v[4:7], v1, s[36:39], s49 offen
    s_add_u32 s49, s48, 117477376
    buffer_store_dwordx4 v[4:7], v1, s[36:39], s49 offen
    s_endpgm
L_prep_mem0:
    v_lshrrev_b32 v2, 6, v0
    s_nop 0
    v_readfirstlane_b32 s50, v2
    v_bfe_u32 v1, v0, 1, 3
    v_mul_u32_u24 v1, 1280, v1
    v_lshrrev_b32 v2, 4, v0
    v_lshl_add_u32 v1, v2, 5, v1
    v_and_b32 v2, 1, v0
    v_lshl_add_u32 v1, v2, 4, v1
    v_lshlrev_b32 v3, 4, v0
    buffer_load_dwordx4 v[4:7], v1, s[40:43], 0 offen offset:0
    s_waitcnt vmcnt(0)
    s_mov_b32 s48, 117440512
    s_mov_b32 s49, 117450752
    buffer_store_dwordx4 v[4:7], v3, s[36:39], s48 offen
    buffer_store_dwordx4 v[4:7], v3, s[36:39], s49 offen
    s_waitcnt vmcnt(0)
    buffer_load_dwordx4 v[4:7], v1, s[40:43], 0 offen offset:512
    s_waitcnt vmcnt(0)
    s_mov_b32 s48, 117444608
    s_mov_b32 s49, 117454848
    buffer_store_dwordx4 v[4:7], v3, s[36:39], s48 offen
    buffer_store_dwordx4 v[4:7], v3, s[36:39], s49 offen
    s_waitcnt vmcnt(0)
    s_cmp_ge_u32 s50, 2
    s_cbranch_scc1 L_prep_end
    buffer_load_dwordx4 v[4:7], v1, s[40:43], 0 offen offset:1024
    s_waitcnt vmcnt(0)
    s_mov_b32 s48, 117448704
    s_mov_b32 s49, 117458944
    buffer_store_dwordx4 v[4:7], v3, s[36:39], s48 offen
    buffer_store_dwordx4 v[4:7], v3, s[36:39], s49 offen
    s_waitcnt vmcnt(0)
L_prep_end:
    s_endpgm
.globl main_kernel
.p2align 8
.type main_kernel,@function
main_kernel:
    s_load_dwordx2 s[4:5], s[0:1], 0
    s_load_dwordx2 s[40:41], s[0:1], 8
    s_load_dwordx2 s[8:9], s[0:1], 16
    s_load_dwordx2 s[12:13], s[0:1], 24
    s_load_dwordx2 s[16:17], s[0:1], 32
    s_load_dwordx2 s[20:21], s[0:1], 40
    s_load_dwordx2 s[24:25], s[0:1], 64
    s_load_dwordx2 s[28:29], s[0:1], 72
    s_load_dwordx2 s[32:33], s[0:1], 80
    s_load_dwordx2 s[36:37], s[0:1], 96
    s_mov_b32 s6, 2621440
    s_mov_b32 s7, 0x20000
    s_mov_b32 s42, 10240
    s_mov_b32 s43, 0x20000
    s_mov_b32 s10, 5242880
    s_mov_b32 s11, 0x20000
    s_mov_b32 s14, 5242880
    s_mov_b32 s15, 0x20000
    s_mov_b32 s18, 5242880
    s_mov_b32 s19, 0x20000
    s_mov_b32 s22, 5242880
    s_mov_b32 s23, 0x20000
    s_mov_b32 s26, 2211840
    s_mov_b32 s27, 0x20000
    s_mov_b32 s30, 2211840
    s_mov_b32 s31, 0x20000
    s_mov_b32 s34, 2621440
    s_mov_b32 s35, 0x20000
    s_mov_b32 s38, 268435456
    s_mov_b32 s39, 0x20000
    s_waitcnt lgkmcnt(0)
    s_and_b32 s5, s5, 0xffff
    s_and_b32 s41, s41, 0xffff
    s_and_b32 s9, s9, 0xffff
    s_and_b32 s13, s13, 0xffff
    s_and_b32 s17, s17, 0xffff
    s_and_b32 s21, s21, 0xffff
    s_and_b32 s25, s25, 0xffff
    s_and_b32 s29, s29, 0xffff
    s_and_b32 s33, s33, 0xffff
    s_and_b32 s37, s37, 0xffff
    v_lshrrev_b32 v1, 6, v0
    s_mov_b32 s53, 40000
    v_readfirstlane_b32 s49, v1
    v_mov_b32 v5, 0
    s_cmp_lg_u32 s49, 0
    s_cbranch_scc1 L_as_wait
    s_mov_b64 exec, 1
    s_getreg_b32 s48, hwreg(HW_REG_XCC_ID)
    s_and_b32 s48, s48, 15
    s_lshl_b32 s54, s48, 7
    s_add_u32 s54, s54, 121823232
    v_mov_b32 v2, 1
    buffer_atomic_add v2, v5, s[36:39], s54 offen sc0 sc1
    s_waitcnt vmcnt(0)
    v_readfirstlane_b32 s61, v2
    s_mov_b32 s62, 121825408
    s_cmp_lg_u32 s61, 31
    s_cbranch_scc1 L_as_1
    s_cmp_ge_u32 s48, 8
    s_cbranch_scc1 L_as_1
    v_mov_b32 v2, 0x10000
    buffer_atomic_add v2, v5, s[36:39], s62 offen sc1
L_as_1:
    s_cmp_lg_u32 s61, 31
    s_cbranch_scc1 L_as_2
    s_cmp_ge_u32 s48, 8
    s_cbranch_scc1 L_as_2
    v_mov_b32 v2, 1
    s_mov_b32 s54, 121825280
    buffer_atomic_add v2, v5, s[36:39], s54 offen sc0 sc1
    s_waitcnt vmcnt(0)
    v_readfirstlane_b32 s54, v2
    s_cmp_ge_u32 s54, 2
    s_cbranch_scc1 L_as_2
    s_lshl_b32 s54, s54, 3
    s_add_u32 s55, s48, 1
    s_lshl_b32 s55, s55, s54
    v_mov_b32 v2, s55
    buffer_atomic_add v2, v5, s[36:39], s62 offen sc1
L_as_2:
    s_mov_b32 s63, 3000
L_as_poll:
    buffer_load_dword v2, v5, s[36:39], s62 offen sc1
    s_waitcnt vmcnt(0)
    v_readfirstlane_b32 s64, v2
    s_bitcmp1_b32 s64, 31
    s_cbranch_scc1 L_as_slow
    s_and_b32 s54, s64, 0xff
    s_bfe_u32 s55, s64, 0x80008
    s_lshr_b32 s56, s64, 16
    s_min_u32 s57, s54, s55
    s_cmp_eq_u32 s57, 0
    s_cbranch_scc1 L_as_notyet
    s_cmp_eq_u32 s56, 8
    s_cbranch_scc1 L_as_fast
L_as_notyet:
    s_sub_u32 s63, s63, 1
    s_cbranch_scc0 L_as_poll
    s_or_b32 s54, s64, 0x80000000
    v_mov_b32 v2, s54
    v_mov_b32 v3, s64
    buffer_atomic_cmpswap v[2:3], v5, s[36:39], s62 offen sc1
    s_waitcnt vmcnt(0)
    s_mov_b32 s63, 0
    s_sub_u32 s53, s53, 1
    s_cbranch_scc0 L_as_poll
    s_mov_b32 s48, 0
    s_branch L_as_pub
L_as_slow:
    v_mov_b32 v2, 1
    s_mov_b32 s54, 121825536
    buffer_atomic_add v2, v5, s[36:39], s54 offen sc0 sc1
    s_waitcnt vmcnt(0)
    v_readfirstlane_b32 s54, v2
    s_min_u32 s54, s54, 300
    s_add_u32 s48, s54, 0x5000
    s_cmp_lt_u32 s54, 64
    s_cbranch_scc1 L_as_pub
    s_add_u32 s48, s54, 24512
    s_branch L_as_pub
L_as_fast:
    s_add_u32 s56, s48, 1
    s_cmp_eq_u32 s56, s54
    s_cbranch_scc1 L_as_t0
    s_cmp_eq_u32 s56, s55
    s_cbranch_scc1 L_as_t1
    s_mov_b32 s57, s48
    s_cmp_gt_u32 s56, s54
    s_subb_u32 s57, s57, 0
    s_cmp_gt_u32 s56, s55
    s_subb_u32 s57, s57, 0
    s_mul_i32 s57, s57, 32
    s_add_u32 s57, s57, s61
    s_add_u32 s57, s57, 0x2000
    s_cmp_ge_u32 s48, 8
    s_cselect_b32 s57, 0, s57
    s_cmp_ge_u32 s61, 32
    s_cselect_b32 s48, 0, s57
    s_branch L_as_pub
L_as_t0:
    s_add_u32 s48, s61, 0x1000
    s_cmp_ge_u32 s61, 32
    s_cselect_b32 s48, 0, s48
    s_branch L_as_pub
L_as_t1:
    s_add_u32 s48, s61, 0x1020
    s_cmp_ge_u32 s61, 32
    s_cselect_b32 s48, 0, s48
L_as_pub:
    v_mov_b32 v2, s48
    ds_write_b32 v5, v2
    s_waitcnt vmcnt(0) lgkmcnt(0)
    s_mov_b64 exec, -1
L_as_wait:
    s_barrier
    ds_read_b32 v2, v5
    s_waitcnt lgkmcnt(0)
    v_readfirstlane_b32 s48, v2
    s_barrier
    s_and_b32 s50, s48, 0xfff
    s_bfe_u32 s51, s48, 0x1000e
    s_bfe_u32 s48, s48, 0x2000c
    s_cmp_eq_u32 s48, 0
    s_cbranch_scc1 L_fail
    s_cmp_eq_u32 s48, 1
    s_cbranch_scc1 L_team
    s_cmp_lt_u32 s50, 32
    s_cbranch_scc1 L_kproj
    s_sub_u32 s50, s50, 32
    s_cmp_lt_u32 s50, 32
    s_cbranch_scc1 L_vproj
    s_sub_u32 s50, s50, 32
    s_cmp_lt_u32 s50, 32
    s_cbranch_scc1 L_qa
    s_sub_u32 s50, s50, 32
    s_cmp_lt_u32 s50, 40
    s_cbranch_scc1 L_wo
    s_sub_u32 s50, s50, 40
    s_cmp_lt_u32 s50, 8
    s_cbranch_scc1 L_red
    s_sub_u32 s50, s50, 8
    s_cmp_lt_u32 s50, 28
    s_cbranch_scc1 L_ffn1
    s_sub_u32 s50, s50, 28
    s_cmp_lt_u32 s50, 20
    s_cbranch_scc1 L_ffn2
    s_sub_u32 s50, s50, 20
L_fail:
    s_endpgm
L_team:
    s_and_b32 s66, s50, 31
    s_lshr_b32 s67, s50, 5
    v_and_b32 v1, 63, v0
    v_lshlrev_b32 v2, 4, v1
    s_lshl_b32 s58, s49, 15
    s_add_u32 s58, s58, 32768
    s_lshl_b32 s61, s49, 13
    v_lshrrev_b32 v16, 5, v1
    v_mul_u32_u24 v12, 2, v16
    v_bfe_u32 v16, v1, 3, 1
    v_mad_u32_u24 v12, v16, 4, v12
    v_bfe_u32 v16, v1, 2, 1
    v_mad_u32_u24 v12, v16, 8, v12
    v_bfe_u32 v16, v1, 1, 1
    v_mad_u32_u24 v12, v16, 1, v12
    v_mov_b32 v17, 8192
    v_mul_lo_u32 v12, v12, v17
    v_bfe_u32 v16, v1, 4, 1
    v_lshl_add_u32 v12, v16, 5, v12
    v_and_b32 v16, 1, v1
    v_lshl_add_u32 v12, v16, 4, v12
    v_lshrrev_b32 v16, 5, v1
    v_mul_u32_u24 v13, 2, v16
    v_bfe_u32 v16, v1, 3, 1
    v_mad_u32_u24 v13, v16, 16, v13
    v_bfe_u32 v16, v1, 2, 1
    v_mad_u32_u24 v13, v16, 4, v13
    v_bfe_u32 v16, v1, 1, 1
    v_mad_u32_u24 v13, v16, 1, v13
    v_mov_b32 v17, 1280
    v_mul_lo_u32 v13, v13, v17
    v_bfe_u32 v16, v1, 4, 1
    v_lshl_add_u32 v13, v16, 5, v13
    v_and_b32 v16, 1, v1
    v_lshl_add_u32 v13, v16, 4, v13
    v_lshrrev_b32 v16, 5, v1
    v_lshlrev_b32 v14, 10, v16
    v_and_b32 v16, 31, v1
    v_lshl_add_u32 v14, v16, 3, v14
    v_add_u32 v14, s58, v14
    v_lshrrev_b32 v16, 5, v1
    v_lshlrev_b32 v15, 10, v16
    v_and_b32 v16, 31, v1
    v_lshl_add_u32 v15, v16, 3, v15
    v_add_u32 v15, s61, v15
    v_add_u32 v78, s58, v2
    s_lshl_b32 s54, s66, 8
    s_lshl_b32 s55, s49, 6
    s_add_u32 s54, s54, s55
    s_mul_i32 s62, s67, 2621440
    s_sub_u32 s63, 2621440, s62
    s_add_u32 s62, s62, s54
    s_add_u32 s63, s63, s54
    s_mul_i32 s64, s66, 163840
    s_mul_i32 s54, s67, 640
    s_mul_i32 s55, s49, 160
    s_add_u32 s64, s64, s54
    s_add_u32 s64, s64, s55
    s_add_u32 s54, s62, 0
    s_add_u32 m0, s58, 16384
    s_nop 0
    buffer_load_dwordx4 v12, s[8:11], s54 offen lds
    s_add_u32 s54, s62, 131072
    s_add_u32 m0, s58, 17408
    s_nop 0
    buffer_load_dwordx4 v12, s[8:11], s54 offen lds
    s_add_u32 s54, s62, 262144
    s_add_u32 m0, s58, 18432
    s_nop 0
    buffer_load_dwordx4 v12, s[8:11], s54 offen lds
    s_add_u32 s54, s62, 393216
    s_add_u32 m0, s58, 19456
    s_nop 0
    buffer_load_dwordx4 v12, s[8:11], s54 offen lds
    s_add_u32 s54, s62, 524288
    s_add_u32 m0, s58, 20480
    s_nop 0
    buffer_load_dwordx4 v12, s[8:11], s54 offen lds
    s_add_u32 s54, s62, 655360
    s_add_u32 m0, s58, 21504
    s_nop 0
    buffer_load_dwordx4 v12, s[8:11], s54 offen lds
    s_add_u32 s54, s62, 786432
    s_add_u32 m0, s58, 22528
    s_nop 0
    buffer_load_dwordx4 v12, s[8:11], s54 offen lds
    s_add_u32 s54, s62, 917504
    s_add_u32 m0, s58, 23552
    s_nop 0
    buffer_load_dwordx4 v12, s[8:11], s54 offen lds
    s_add_u32 s54, s62, 1048576
    s_add_u32 m0, s58, 24576
    s_nop 0
    buffer_load_dwordx4 v12, s[8:11], s54 offen lds
    s_add_u32 s54, s62, 1179648
    s_add_u32 m0, s58, 25600
    s_nop 0
    buffer_load_dwordx4 v12, s[8:11], s54 offen lds
    s_add_u32 s54, s62, 1310720
    s_add_u32 m0, s58, 26624
    s_nop 0
    buffer_load_dwordx4 v12, s[8:11], s54 offen lds
    s_add_u32 s54, s62, 1441792
    s_add_u32 m0, s58, 27648
    s_nop 0
    buffer_load_dwordx4 v12, s[8:11], s54 offen lds
    s_add_u32 s54, s62, 1572864
    s_add_u32 m0, s58, 28672
    s_nop 0
    buffer_load_dwordx4 v12, s[8:11], s54 offen lds
    s_add_u32 s54, s62, 1703936
    s_add_u32 m0, s58, 29696
    s_nop 0
    buffer_load_dwordx4 v12, s[8:11], s54 offen lds
    s_add_u32 s54, s62, 1835008
    s_add_u32 m0, s58, 30720
    s_nop 0
    buffer_load_dwordx4 v12, s[8:11], s54 offen lds
    s_add_u32 s54, s62, 1966080
    s_add_u32 m0, s58, 31744
    s_nop 0
    buffer_load_dwordx4 v12, s[8:11], s54 offen lds
    s_add_u32 s54, s62, 2097152
    s_add_u32 m0, s61, 0
    s_nop 0
    buffer_load_dwordx4 v12, s[8:11], s54 offen lds
    s_add_u32 s54, s62, 2228224
    s_add_u32 m0, s61, 1024
    s_nop 0
    buffer_load_dwordx4 v12, s[8:11], s54 offen lds
    s_add_u32 s54, s62, 2359296
    s_add_u32 m0, s61, 2048
    s_nop 0
    buffer_load_dwordx4 v12, s[8:11], s54 offen lds
    s_add_u32 s54, s62, 2490368
    s_add_u32 m0, s61, 3072
    s_nop 0
    buffer_load_dwordx4 v12, s[8:11], s54 offen lds
    s_add_u32 s54, s63, 0
    s_add_u32 m0, s61, 4096
    s_nop 0
    buffer_load_dwordx4 v12, s[8:11], s54 offen lds
    s_add_u32 s54, s63, 131072
    s_add_u32 m0, s61, 5120
    s_nop 0
    buffer_load_dwordx4 v12, s[8:11], s54 offen lds
    s_add_u32 s54, s63, 262144
    s_add_u32 m0, s61, 6144
    s_nop 0
    buffer_load_dwordx4 v12, s[8:11], s54 offen lds
    s_add_u32 s54, s63, 393216
    s_add_u32 m0, s61, 7168
    s_nop 0
    buffer_load_dwordx4 v12, s[8:11], s54 offen lds
    s_add_u32 s54, s63, 524288
    s_add_u32 m0, s58, 0
    s_nop 0
    buffer_load_dwordx4 v12, s[8:11], s54 offen lds
    s_add_u32 s54, s63, 655360
    s_add_u32 m0, s58, 1024
    s_nop 0
    buffer_load_dwordx4 v12, s[8:11], s54 offen lds
    s_add_u32 s54, s63, 786432
    s_add_u32 m0, s58, 2048
    s_nop 0
    buffer_load_dwordx4 v12, s[8:11], s54 offen lds
    s_add_u32 s54, s63, 917504
    s_add_u32 m0, s58, 3072
    s_nop 0
    buffer_load_dwordx4 v12, s[8:11], s54 offen lds
    s_add_u32 s54, s63, 1048576
    s_add_u32 m0, s58, 4096
    s_nop 0
    buffer_load_dwordx4 v12, s[8:11], s54 offen lds
    s_add_u32 s54, s63, 1179648
    s_add_u32 m0, s58, 5120
    s_nop 0
    buffer_load_dwordx4 v12, s[8:11], s54 offen lds
    s_add_u32 s54, s63, 1310720
    s_add_u32 m0, s58, 6144
    s_nop 0
    buffer_load_dwordx4 v12, s[8:11], s54 offen lds
    s_add_u32 s54, s63, 1441792
    s_add_u32 m0, s58, 7168
    s_nop 0
    buffer_load_dwordx4 v12, s[8:11], s54 offen lds
    s_add_u32 s54, s63, 1572864
    s_add_u32 m0, s58, 8192
    s_nop 0
    buffer_load_dwordx4 v12, s[8:11], s54 offen lds
    s_add_u32 s54, s63, 1703936
    s_add_u32 m0, s58, 9216
    s_nop 0
    buffer_load_dwordx4 v12, s[8:11], s54 offen lds
    s_add_u32 s54, s63, 1835008
    s_add_u32 m0, s58, 10240
    s_nop 0
    buffer_load_dwordx4 v12, s[8:11], s54 offen lds
    s_add_u32 s54, s63, 1966080
    s_add_u32 m0, s58, 11264
    s_nop 0
    buffer_load_dwordx4 v12, s[8:11], s54 offen lds
    s_add_u32 s54, s63, 2097152
    s_add_u32 m0, s58, 12288
    s_nop 0
    buffer_load_dwordx4 v12, s[8:11], s54 offen lds
    s_add_u32 s54, s63, 2228224
    s_add_u32 m0, s58, 13312
    s_nop 0
    buffer_load_dwordx4 v12, s[8:11], s54 offen lds
    s_add_u32 s54, s63, 2359296
    s_add_u32 m0, s58, 14336
    s_nop 0
    buffer_load_dwordx4 v12, s[8:11], s54 offen lds
    s_add_u32 s54, s63, 2490368
    s_add_u32 m0, s58, 15360
    s_nop 0
    buffer_load_dwordx4 v12, s[8:11], s54 offen lds
    s_waitcnt vmcnt(36)
    ds_read_b64_tr_b16 a[0:1], v14 offset:16384
    ds_read_b64_tr_b16 a[2:3], v14 offset:16896
    ds_read_b64_tr_b16 a[4:5], v14 offset:18432
    ds_read_b64_tr_b16 a[6:7], v14 offset:18944
    ds_read_b64_tr_b16 a[8:9], v14 offset:16640
    ds_read_b64_tr_b16 a[10:11], v14 offset:17152
    ds_read_b64_tr_b16 a[12:13], v14 offset:18688
    ds_read_b64_tr_b16 a[14:15], v14 offset:19200
    s_waitcnt lgkmcnt(0)
    s_add_u32 s54, s62, 0
    s_add_u32 m0, s58, 16384
    s_nop 0
    buffer_load_dwordx4 v12, s[12:15], s54 offen lds
    s_add_u32 s54, s62, 131072
    s_add_u32 m0, s58, 17408
    s_nop 0
    buffer_load_dwordx4 v12, s[12:15], s54 offen lds
    s_add_u32 s54, s62, 262144
    s_add_u32 m0, s58, 18432
    s_nop 0
    buffer_load_dwordx4 v12, s[12:15], s54 offen lds
    s_add_u32 s54, s62, 393216
    s_add_u32 m0, s58, 19456
    s_nop 0
    buffer_load_dwordx4 v12, s[12:15], s54 offen lds
    s_waitcnt vmcnt(36)
    ds_read_b64_tr_b16 a[16:17], v14 offset:20480
    ds_read_b64_tr_b16 a[18:19], v14 offset:20992
    ds_read_b64_tr_b16 a[20:21], v14 offset:22528
    ds_read_b64_tr_b16 a[22:23], v14 offset:23040
    ds_read_b64_tr_b16 a[24:25], v14 offset:20736
    ds_read_b64_tr_b16 a[26:27], v14 offset:21248
    ds_read_b64_tr_b16 a[28:29], v14 offset:22784
    ds_read_b64_tr_b16 a[30:31], v14 offset:23296
    s_waitcnt lgkmcnt(0)
    s_add_u32 s54, s62, 524288
    s_add_u32 m0, s58, 20480
    s_nop 0
    buffer_load_dwordx4 v12, s[12:15], s54 offen lds
    s_add_u32 s54, s62, 655360
    s_add_u32 m0, s58, 21504
    s_nop 0
    buffer_load_dwordx4 v12, s[12:15], s54 offen lds
    s_add_u32 s54, s62, 786432
    s_add_u32 m0, s58, 22528
    s_nop 0
    buffer_load_dwordx4 v12, s[12:15], s54 offen lds
    s_add_u32 s54, s62, 917504
    s_add_u32 m0, s58, 23552
    s_nop 0
    buffer_load_dwordx4 v12, s[12:15], s54 offen lds
    s_waitcnt vmcnt(36)
    ds_read_b64_tr_b16 a[32:33], v14 offset:24576
    ds_read_b64_tr_b16 a[34:35], v14 offset:25088
    ds_read_b64_tr_b16 a[36:37], v14 offset:26624
    ds_read_b64_tr_b16 a[38:39], v14 offset:27136
    ds_read_b64_tr_b16 a[40:41], v14 offset:24832
    ds_read_b64_tr_b16 a[42:43], v14 offset:25344
    ds_read_b64_tr_b16 a[44:45], v14 offset:26880
    ds_read_b64_tr_b16 a[46:47], v14 offset:27392
    s_waitcnt lgkmcnt(0)
    s_add_u32 s54, s62, 1048576
    s_add_u32 m0, s58, 24576
    s_nop 0
    buffer_load_dwordx4 v12, s[12:15], s54 offen lds
    s_add_u32 s54, s62, 1179648
    s_add_u32 m0, s58, 25600
    s_nop 0
    buffer_load_dwordx4 v12, s[12:15], s54 offen lds
    s_add_u32 s54, s62, 1310720
    s_add_u32 m0, s58, 26624
    s_nop 0
    buffer_load_dwordx4 v12, s[12:15], s54 offen lds
    s_add_u32 s54, s62, 1441792
    s_add_u32 m0, s58, 27648
    s_nop 0
    buffer_load_dwordx4 v12, s[12:15], s54 offen lds
    s_waitcnt vmcnt(36)
    ds_read_b64_tr_b16 a[48:49], v14 offset:28672
    ds_read_b64_tr_b16 a[50:51], v14 offset:29184
    ds_read_b64_tr_b16 a[52:53], v14 offset:30720
    ds_read_b64_tr_b16 a[54:55], v14 offset:31232
    ds_read_b64_tr_b16 a[56:57], v14 offset:28928
    ds_read_b64_tr_b16 a[58:59], v14 offset:29440
    ds_read_b64_tr_b16 a[60:61], v14 offset:30976
    ds_read_b64_tr_b16 a[62:63], v14 offset:31488
    s_waitcnt lgkmcnt(0)
    s_add_u32 s54, s62, 1572864
    s_add_u32 m0, s58, 28672
    s_nop 0
    buffer_load_dwordx4 v12, s[12:15], s54 offen lds
    s_add_u32 s54, s62, 1703936
    s_add_u32 m0, s58, 29696
    s_nop 0
    buffer_load_dwordx4 v12, s[12:15], s54 offen lds
    s_add_u32 s54, s62, 1835008
    s_add_u32 m0, s58, 30720
    s_nop 0
    buffer_load_dwordx4 v12, s[12:15], s54 offen lds
    s_add_u32 s54, s62, 1966080
    s_add_u32 m0, s58, 31744
    s_nop 0
    buffer_load_dwordx4 v12, s[12:15], s54 offen lds
    s_waitcnt vmcnt(36)
    ds_read_b64_tr_b16 a[64:65], v15 offset:0
    ds_read_b64_tr_b16 a[66:67], v15 offset:512
    ds_read_b64_tr_b16 a[68:69], v15 offset:2048
    ds_read_b64_tr_b16 a[70:71], v15 offset:2560
    ds_read_b64_tr_b16 a[72:73], v15 offset:256
    ds_read_b64_tr_b16 a[74:75], v15 offset:768
    ds_read_b64_tr_b16 a[76:77], v15 offset:2304
    ds_read_b64_tr_b16 a[78:79], v15 offset:2816
    s_waitcnt lgkmcnt(0)
    s_add_u32 s54, s62, 2097152
    s_add_u32 m0, s61, 0
    s_nop 0
    buffer_load_dwordx4 v12, s[12:15], s54 offen lds
    s_add_u32 s54, s62, 2228224
    s_add_u32 m0, s61, 1024
    s_nop 0
    buffer_load_dwordx4 v12, s[12:15], s54 offen lds
    s_add_u32 s54, s62, 2359296
    s_add_u32 m0, s61, 2048
    s_nop 0
    buffer_load_dwordx4 v12, s[12:15], s54 offen lds
    s_add_u32 s54, s62, 2490368
    s_add_u32 m0, s61, 3072
    s_nop 0
    buffer_load_dwordx4 v12, s[12:15], s54 offen lds
    s_waitcnt vmcnt(36)
    ds_read_b64_tr_b16 a[80:81], v15 offset:4096
    ds_read_b64_tr_b16 a[82:83], v15 offset:4608
    ds_read_b64_tr_b16 a[84:85], v15 offset:6144
    ds_read_b64_tr_b16 a[86:87], v15 offset:6656
    ds_read_b64_tr_b16 a[88:89], v15 offset:4352
    ds_read_b64_tr_b16 a[90:91], v15 offset:4864
    ds_read_b64_tr_b16 a[92:93], v15 offset:6400
    ds_read_b64_tr_b16 a[94:95], v15 offset:6912
    s_waitcnt lgkmcnt(0)
    s_add_u32 s54, s63, 0
    s_add_u32 m0, s61, 4096
    s_nop 0
    buffer_load_dwordx4 v12, s[12:15], s54 offen lds
    s_add_u32 s54, s63, 131072
    s_add_u32 m0, s61, 5120
    s_nop 0
    buffer_load_dwordx4 v12, s[12:15], s54 offen lds
    s_add_u32 s54, s63, 262144
    s_add_u32 m0, s61, 6144
    s_nop 0
    buffer_load_dwordx4 v12, s[12:15], s54 offen lds
    s_add_u32 s54, s63, 393216
    s_add_u32 m0, s61, 7168
    s_nop 0
    buffer_load_dwordx4 v12, s[12:15], s54 offen lds
    s_waitcnt vmcnt(36)
    ds_read_b64_tr_b16 a[96:97], v14 offset:0
    ds_read_b64_tr_b16 a[98:99], v14 offset:512
    ds_read_b64_tr_b16 a[100:101], v14 offset:2048
    ds_read_b64_tr_b16 a[102:103], v14 offset:2560
    ds_read_b64_tr_b16 a[104:105], v14 offset:256
    ds_read_b64_tr_b16 a[106:107], v14 offset:768
    ds_read_b64_tr_b16 a[108:109], v14 offset:2304
    ds_read_b64_tr_b16 a[110:111], v14 offset:2816
    s_waitcnt lgkmcnt(0)
    s_add_u32 s54, s63, 524288
    s_add_u32 m0, s58, 0
    s_nop 0
    buffer_load_dwordx4 v12, s[12:15], s54 offen lds
    s_add_u32 s54, s63, 655360
    s_add_u32 m0, s58, 1024
    s_nop 0
    buffer_load_dwordx4 v12, s[12:15], s54 offen lds
    s_add_u32 s54, s63, 786432
    s_add_u32 m0, s58, 2048
    s_nop 0
    buffer_load_dwordx4 v12, s[12:15], s54 offen lds
    s_add_u32 s54, s63, 917504
    s_add_u32 m0, s58, 3072
    s_nop 0
    buffer_load_dwordx4 v12, s[12:15], s54 offen lds
    s_waitcnt vmcnt(36)
    ds_read_b64_tr_b16 a[112:113], v14 offset:4096
    ds_read_b64_tr_b16 a[114:115], v14 offset:4608
    ds_read_b64_tr_b16 a[116:117], v14 offset:6144
    ds_read_b64_tr_b16 a[118:119], v14 offset:6656
    ds_read_b64_tr_b16 a[120:121], v14 offset:4352
    ds_read_b64_tr_b16 a[122:123], v14 offset:4864
    ds_read_b64_tr_b16 a[124:125], v14 offset:6400
    ds_read_b64_tr_b16 a[126:127], v14 offset:6912
    s_waitcnt lgkmcnt(0)
    s_add_u32 s54, s63, 1048576
    s_add_u32 m0, s58, 4096
    s_nop 0
    buffer_load_dwordx4 v12, s[12:15], s54 offen lds
    s_add_u32 s54, s63, 1179648
    s_add_u32 m0, s58, 5120
    s_nop 0
    buffer_load_dwordx4 v12, s[12:15], s54 offen lds
    s_add_u32 s54, s63, 1310720
    s_add_u32 m0, s58, 6144
    s_nop 0
    buffer_load_dwordx4 v12, s[12:15], s54 offen lds
    s_add_u32 s54, s63, 1441792
    s_add_u32 m0, s58, 7168
    s_nop 0
    buffer_load_dwordx4 v12, s[12:15], s54 offen lds
    s_waitcnt vmcnt(36)
    ds_read_b64_tr_b16 a[128:129], v14 offset:8192
    ds_read_b64_tr_b16 a[130:131], v14 offset:8704
    ds_read_b64_tr_b16 a[132:133], v14 offset:10240
    ds_read_b64_tr_b16 a[134:135], v14 offset:10752
    ds_read_b64_tr_b16 a[136:137], v14 offset:8448
    ds_read_b64_tr_b16 a[138:139], v14 offset:8960
    ds_read_b64_tr_b16 a[140:141], v14 offset:10496
    ds_read_b64_tr_b16 a[142:143], v14 offset:11008
    s_waitcnt lgkmcnt(0)
    s_add_u32 s54, s63, 1572864
    s_add_u32 m0, s58, 8192
    s_nop 0
    buffer_load_dwordx4 v12, s[12:15], s54 offen lds
    s_add_u32 s54, s63, 1703936
    s_add_u32 m0, s58, 9216
    s_nop 0
    buffer_load_dwordx4 v12, s[12:15], s54 offen lds
    s_add_u32 s54, s63, 1835008
    s_add_u32 m0, s58, 10240
    s_nop 0
    buffer_load_dwordx4 v12, s[12:15], s54 offen lds
    s_add_u32 s54, s63, 1966080
    s_add_u32 m0, s58, 11264
    s_nop 0
    buffer_load_dwordx4 v12, s[12:15], s54 offen lds
    s_waitcnt vmcnt(36)
    ds_read_b64_tr_b16 a[144:145], v14 offset:12288
    ds_read_b64_tr_b16 a[146:147], v14 offset:12800
    ds_read_b64_tr_b16 a[148:149], v14 offset:14336
    ds_read_b64_tr_b16 a[150:151], v14 offset:14848
    ds_read_b64_tr_b16 a[152:153], v14 offset:12544
    ds_read_b64_tr_b16 a[154:155], v14 offset:13056
    ds_read_b64_tr_b16 a[156:157], v14 offset:14592
    ds_read_b64_tr_b16 a[158:159], v14 offset:15104
    s_waitcnt lgkmcnt(0)
    s_add_u32 s54, s63, 2097152
    s_add_u32 m0, s58, 12288
    s_nop 0
    buffer_load_dwordx4 v12, s[12:15], s54 offen lds
    s_add_u32 s54, s63, 2228224
    s_add_u32 m0, s58, 13312
    s_nop 0
    buffer_load_dwordx4 v12, s[12:15], s54 offen lds
    s_add_u32 s54, s63, 2359296
    s_add_u32 m0, s58, 14336
    s_nop 0
    buffer_load_dwordx4 v12, s[12:15], s54 offen lds
    s_add_u32 s54, s63, 2490368
    s_add_u32 m0, s58, 15360
    s_nop 0
    buffer_load_dwordx4 v12, s[12:15], s54 offen lds
    s_waitcnt vmcnt(36)
    ds_read_b64_tr_b16 v[96:97], v14 offset:16384
    ds_read_b64_tr_b16 v[98:99], v14 offset:16896
    ds_read_b64_tr_b16 v[100:101], v14 offset:18432
    ds_read_b64_tr_b16 v[102:103], v14 offset:18944
    ds_read_b64_tr_b16 v[104:105], v14 offset:16640
    ds_read_b64_tr_b16 v[106:107], v14 offset:17152
    ds_read_b64_tr_b16 v[108:109], v14 offset:18688
    ds_read_b64_tr_b16 v[110:111], v14 offset:19200
    s_waitcnt lgkmcnt(0)
    s_add_u32 s54, s64, 0
    s_add_u32 m0, s58, 16384
    s_nop 0
    buffer_load_dwordx4 v13, s[20:23], s54 offen lds
    s_add_u32 s54, s64, 10240
    s_add_u32 m0, s58, 17408
    s_nop 0
    buffer_load_dwordx4 v13, s[20:23], s54 offen lds
    s_add_u32 s54, s64, 40960
    s_add_u32 m0, s58, 18432
    s_nop 0
    buffer_load_dwordx4 v13, s[20:23], s54 offen lds
    s_add_u32 s54, s64, 51200
    s_add_u32 m0, s58, 19456
    s_nop 0
    buffer_load_dwordx4 v13, s[20:23], s54 offen lds
    s_waitcnt vmcnt(36)
    ds_read_b64_tr_b16 v[112:113], v14 offset:20480
    ds_read_b64_tr_b16 v[114:115], v14 offset:20992
    ds_read_b64_tr_b16 v[116:117], v14 offset:22528
    ds_read_b64_tr_b16 v[118:119], v14 offset:23040
    ds_read_b64_tr_b16 v[120:121], v14 offset:20736
    ds_read_b64_tr_b16 v[122:123], v14 offset:21248
    ds_read_b64_tr_b16 v[124:125], v14 offset:22784
    ds_read_b64_tr_b16 v[126:127], v14 offset:23296
    s_waitcnt lgkmcnt(0)
    s_add_u32 s54, s64, 64
    s_add_u32 m0, s58, 20480
    s_nop 0
    buffer_load_dwordx4 v13, s[20:23], s54 offen lds
    s_add_u32 s54, s64, 10304
    s_add_u32 m0, s58, 21504
    s_nop 0
    buffer_load_dwordx4 v13, s[20:23], s54 offen lds
    s_add_u32 s54, s64, 41024
    s_add_u32 m0, s58, 22528
    s_nop 0
    buffer_load_dwordx4 v13, s[20:23], s54 offen lds
    s_add_u32 s54, s64, 51264
    s_add_u32 m0, s58, 23552
    s_nop 0
    buffer_load_dwordx4 v13, s[20:23], s54 offen lds
    s_waitcnt vmcnt(36)
    ds_read_b64_tr_b16 v[128:129], v14 offset:24576
    ds_read_b64_tr_b16 v[130:131], v14 offset:25088
    ds_read_b64_tr_b16 v[132:133], v14 offset:26624
    ds_read_b64_tr_b16 v[134:135], v14 offset:27136
    ds_read_b64_tr_b16 v[136:137], v14 offset:24832
    ds_read_b64_tr_b16 v[138:139], v14 offset:25344
    ds_read_b64_tr_b16 v[140:141], v14 offset:26880
    ds_read_b64_tr_b16 v[142:143], v14 offset:27392
    s_waitcnt lgkmcnt(0)
    s_add_u32 s54, s64, 128
    s_add_u32 m0, s58, 24576
    s_nop 0
    buffer_load_dwordx4 v13, s[20:23], s54 offen lds
    s_add_u32 s54, s64, 10368
    s_add_u32 m0, s58, 25600
    s_nop 0
    buffer_load_dwordx4 v13, s[20:23], s54 offen lds
    s_add_u32 s54, s64, 41088
    s_add_u32 m0, s58, 26624
    s_nop 0
    buffer_load_dwordx4 v13, s[20:23], s54 offen lds
    s_add_u32 s54, s64, 51328
    s_add_u32 m0, s58, 27648
    s_nop 0
    buffer_load_dwordx4 v13, s[20:23], s54 offen lds
    s_waitcnt vmcnt(36)
    ds_read_b64_tr_b16 v[144:145], v14 offset:28672
    ds_read_b64_tr_b16 v[146:147], v14 offset:29184
    ds_read_b64_tr_b16 v[148:149], v14 offset:30720
    ds_read_b64_tr_b16 v[150:151], v14 offset:31232
    ds_read_b64_tr_b16 v[152:153], v14 offset:28928
    ds_read_b64_tr_b16 v[154:155], v14 offset:29440
    ds_read_b64_tr_b16 v[156:157], v14 offset:30976
    ds_read_b64_tr_b16 v[158:159], v14 offset:31488
    s_waitcnt lgkmcnt(0)
    s_add_u32 s54, s64, 81920
    s_add_u32 m0, s58, 28672
    s_nop 0
    buffer_load_dwordx4 v13, s[20:23], s54 offen lds
    s_add_u32 s54, s64, 92160
    s_add_u32 m0, s58, 29696
    s_nop 0
    buffer_load_dwordx4 v13, s[20:23], s54 offen lds
    s_add_u32 s54, s64, 122880
    s_add_u32 m0, s58, 30720
    s_nop 0
    buffer_load_dwordx4 v13, s[20:23], s54 offen lds
    s_add_u32 s54, s64, 133120
    s_add_u32 m0, s58, 31744
    s_nop 0
    buffer_load_dwordx4 v13, s[20:23], s54 offen lds
    s_waitcnt vmcnt(36)
    ds_read_b64_tr_b16 v[160:161], v15 offset:0
    ds_read_b64_tr_b16 v[162:163], v15 offset:512
    ds_read_b64_tr_b16 v[164:165], v15 offset:2048
    ds_read_b64_tr_b16 v[166:167], v15 offset:2560
    ds_read_b64_tr_b16 v[168:169], v15 offset:256
    ds_read_b64_tr_b16 v[170:171], v15 offset:768
    ds_read_b64_tr_b16 v[172:173], v15 offset:2304
    ds_read_b64_tr_b16 v[174:175], v15 offset:2816
    s_waitcnt lgkmcnt(0)
    s_add_u32 s54, s64, 81984
    s_add_u32 m0, s61, 0
    s_nop 0
    buffer_load_dwordx4 v13, s[20:23], s54 offen lds
    s_add_u32 s54, s64, 92224
    s_add_u32 m0, s61, 1024
    s_nop 0
    buffer_load_dwordx4 v13, s[20:23], s54 offen lds
    s_add_u32 s54, s64, 122944
    s_add_u32 m0, s61, 2048
    s_nop 0
    buffer_load_dwordx4 v13, s[20:23], s54 offen lds
    s_add_u32 s54, s64, 133184
    s_add_u32 m0, s61, 3072
    s_nop 0
    buffer_load_dwordx4 v13, s[20:23], s54 offen lds
    s_waitcnt vmcnt(36)
    ds_read_b64_tr_b16 v[176:177], v15 offset:4096
    ds_read_b64_tr_b16 v[178:179], v15 offset:4608
    ds_read_b64_tr_b16 v[180:181], v15 offset:6144
    ds_read_b64_tr_b16 v[182:183], v15 offset:6656
    ds_read_b64_tr_b16 v[184:185], v15 offset:4352
    ds_read_b64_tr_b16 v[186:187], v15 offset:4864
    ds_read_b64_tr_b16 v[188:189], v15 offset:6400
    ds_read_b64_tr_b16 v[190:191], v15 offset:6912
    s_waitcnt lgkmcnt(0)
    s_add_u32 s54, s64, 82048
    s_add_u32 m0, s61, 4096
    s_nop 0
    buffer_load_dwordx4 v13, s[20:23], s54 offen lds
    s_add_u32 s54, s64, 92288
    s_add_u32 m0, s61, 5120
    s_nop 0
    buffer_load_dwordx4 v13, s[20:23], s54 offen lds
    s_add_u32 s54, s64, 123008
    s_add_u32 m0, s61, 6144
    s_nop 0
    buffer_load_dwordx4 v13, s[20:23], s54 offen lds
    s_add_u32 s54, s64, 133248
    s_add_u32 m0, s61, 7168
    s_nop 0
    buffer_load_dwordx4 v13, s[20:23], s54 offen lds
    s_waitcnt vmcnt(36)
    ds_read_b64_tr_b16 v[192:193], v14 offset:0
    ds_read_b64_tr_b16 v[194:195], v14 offset:512
    ds_read_b64_tr_b16 v[196:197], v14 offset:2048
    ds_read_b64_tr_b16 v[198:199], v14 offset:2560
    ds_read_b64_tr_b16 v[200:201], v14 offset:256
    ds_read_b64_tr_b16 v[202:203], v14 offset:768
    ds_read_b64_tr_b16 v[204:205], v14 offset:2304
    ds_read_b64_tr_b16 v[206:207], v14 offset:2816
    s_waitcnt lgkmcnt(0)
    s_add_u32 s54, s62, 0
    s_add_u32 m0, s58, 0
    s_nop 0
    buffer_load_dwordx4 v12, s[16:19], s54 offen lds
    s_add_u32 s54, s62, 131072
    s_add_u32 m0, s58, 1024
    s_nop 0
    buffer_load_dwordx4 v12, s[16:19], s54 offen lds
    s_add_u32 s54, s62, 262144
    s_add_u32 m0, s58, 2048
    s_nop 0
    buffer_load_dwordx4 v12, s[16:19], s54 offen lds
    s_add_u32 s54, s62, 393216
    s_add_u32 m0, s58, 3072
    s_nop 0
    buffer_load_dwordx4 v12, s[16:19], s54 offen lds
    s_waitcnt vmcnt(36)
    ds_read_b64_tr_b16 v[208:209], v14 offset:4096
    ds_read_b64_tr_b16 v[210:211], v14 offset:4608
    ds_read_b64_tr_b16 v[212:213], v14 offset:6144
    ds_read_b64_tr_b16 v[214:215], v14 offset:6656
    ds_read_b64_tr_b16 v[216:217], v14 offset:4352
    ds_read_b64_tr_b16 v[218:219], v14 offset:4864
    ds_read_b64_tr_b16 v[220:221], v14 offset:6400
    ds_read_b64_tr_b16 v[222:223], v14 offset:6912
    s_waitcnt lgkmcnt(0)
    s_add_u32 s54, s62, 524288
    s_add_u32 m0, s58, 4096
    s_nop 0
    buffer_load_dwordx4 v12, s[16:19], s54 offen lds
    s_add_u32 s54, s62, 655360
    s_add_u32 m0, s58, 5120
    s_nop 0
    buffer_load_dwordx4 v12, s[16:19], s54 offen lds
    s_add_u32 s54, s62, 786432
    s_add_u32 m0, s58, 6144
    s_nop 0
    buffer_load_dwordx4 v12, s[16:19], s54 offen lds
    s_add_u32 s54, s62, 917504
    s_add_u32 m0, s58, 7168
    s_nop 0
    buffer_load_dwordx4 v12, s[16:19], s54 offen lds
    s_waitcnt vmcnt(36)
    ds_read_b64_tr_b16 v[224:225], v14 offset:8192
    ds_read_b64_tr_b16 v[226:227], v14 offset:8704
    ds_read_b64_tr_b16 v[228:229], v14 offset:10240
    ds_read_b64_tr_b16 v[230:231], v14 offset:10752
    ds_read_b64_tr_b16 v[232:233], v14 offset:8448
    ds_read_b64_tr_b16 v[234:235], v14 offset:8960
    ds_read_b64_tr_b16 v[236:237], v14 offset:10496
    ds_read_b64_tr_b16 v[238:239], v14 offset:11008
    s_waitcnt lgkmcnt(0)
    s_add_u32 s54, s62, 1048576
    s_add_u32 m0, s58, 8192
    s_nop 0
    buffer_load_dwordx4 v12, s[16:19], s54 offen lds
    s_add_u32 s54, s62, 1179648
    s_add_u32 m0, s58, 9216
    s_nop 0
    buffer_load_dwordx4 v12, s[16:19], s54 offen lds
    s_add_u32 s54, s62, 1310720
    s_add_u32 m0, s58, 10240
    s_nop 0
    buffer_load_dwordx4 v12, s[16:19], s54 offen lds
    s_add_u32 s54, s62, 1441792
    s_add_u32 m0, s58, 11264
    s_nop 0
    buffer_load_dwordx4 v12, s[16:19], s54 offen lds
    s_waitcnt vmcnt(36)
    ds_read_b64_tr_b16 v[240:241], v14 offset:12288
    ds_read_b64_tr_b16 v[242:243], v14 offset:12800
    ds_read_b64_tr_b16 v[244:245], v14 offset:14336
    ds_read_b64_tr_b16 v[246:247], v14 offset:14848
    ds_read_b64_tr_b16 v[248:249], v14 offset:12544
    ds_read_b64_tr_b16 v[250:251], v14 offset:13056
    ds_read_b64_tr_b16 v[252:253], v14 offset:14592
    ds_read_b64_tr_b16 v[254:255], v14 offset:15104
    s_waitcnt lgkmcnt(0)
    s_add_u32 s54, s62, 1572864
    s_add_u32 m0, s58, 12288
    s_nop 0
    buffer_load_dwordx4 v12, s[16:19], s54 offen lds
    s_add_u32 s54, s62, 1703936
    s_add_u32 m0, s58, 13312
    s_nop 0
    buffer_load_dwordx4 v12, s[16:19], s54 offen lds
    s_add_u32 s54, s62, 1835008
    s_add_u32 m0, s58, 14336
    s_nop 0
    buffer_load_dwordx4 v12, s[16:19], s54 offen lds
    s_add_u32 s54, s62, 1966080
    s_add_u32 m0, s58, 15360
    s_nop 0
    buffer_load_dwordx4 v12, s[16:19], s54 offen lds
    s_waitcnt vmcnt(36)
    ds_read_b64_tr_b16 a[160:161], v14 offset:16384
    ds_read_b64_tr_b16 a[162:163], v14 offset:16896
    ds_read_b64_tr_b16 a[164:165], v14 offset:18432
    ds_read_b64_tr_b16 a[166:167], v14 offset:18944
    ds_read_b64_tr_b16 a[176:177], v14 offset:16640
    ds_read_b64_tr_b16 a[178:179], v14 offset:17152
    ds_read_b64_tr_b16 a[180:181], v14 offset:18688
    ds_read_b64_tr_b16 a[182:183], v14 offset:19200
    s_waitcnt lgkmcnt(0)
    s_add_u32 s54, s62, 2097152
    s_add_u32 m0, s58, 16384
    s_nop 0
    buffer_load_dwordx4 v12, s[16:19], s54 offen lds
    s_add_u32 s54, s62, 2228224
    s_add_u32 m0, s58, 17408
    s_nop 0
    buffer_load_dwordx4 v12, s[16:19], s54 offen lds
    s_add_u32 s54, s62, 2359296
    s_add_u32 m0, s58, 18432
    s_nop 0
    buffer_load_dwordx4 v12, s[16:19], s54 offen lds
    s_add_u32 s54, s62, 2490368
    s_add_u32 m0, s58, 19456
    s_nop 0
    buffer_load_dwordx4 v12, s[16:19], s54 offen lds
    s_waitcnt vmcnt(36)
    ds_read_b64_tr_b16 a[192:193], v14 offset:20480
    ds_read_b64_tr_b16 a[194:195], v14 offset:20992
    ds_read_b64_tr_b16 a[196:197], v14 offset:22528
    ds_read_b64_tr_b16 a[198:199], v14 offset:23040
    ds_read_b64_tr_b16 a[208:209], v14 offset:20736
    ds_read_b64_tr_b16 a[210:211], v14 offset:21248
    ds_read_b64_tr_b16 a[212:213], v14 offset:22784
    ds_read_b64_tr_b16 a[214:215], v14 offset:23296
    s_waitcnt lgkmcnt(0)
    s_add_u32 s54, s63, 0
    s_add_u32 m0, s58, 20480
    s_nop 0
    buffer_load_dwordx4 v12, s[16:19], s54 offen lds
    s_add_u32 s54, s63, 131072
    s_add_u32 m0, s58, 21504
    s_nop 0
    buffer_load_dwordx4 v12, s[16:19], s54 offen lds
    s_add_u32 s54, s63, 262144
    s_add_u32 m0, s58, 22528
    s_nop 0
    buffer_load_dwordx4 v12, s[16:19], s54 offen lds
    s_add_u32 s54, s63, 393216
    s_add_u32 m0, s58, 23552
    s_nop 0
    buffer_load_dwordx4 v12, s[16:19], s54 offen lds
    s_waitcnt vmcnt(36)
    ds_read_b64_tr_b16 a[224:225], v14 offset:24576
    ds_read_b64_tr_b16 a[226:227], v14 offset:25088
    ds_read_b64_tr_b16 a[228:229], v14 offset:26624
    ds_read_b64_tr_b16 a[230:231], v14 offset:27136
    s_waitcnt lgkmcnt(0)
    s_add_u32 s54, s63, 524288
    s_add_u32 m0, s58, 24576
    s_nop 0
    buffer_load_dwordx4 v12, s[16:19], s54 offen lds
    s_add_u32 s54, s63, 655360
    s_add_u32 m0, s58, 25600
    s_nop 0
    buffer_load_dwordx4 v12, s[16:19], s54 offen lds
    s_add_u32 s54, s63, 786432
    s_add_u32 m0, s58, 26624
    s_nop 0
    buffer_load_dwordx4 v12, s[16:19], s54 offen lds
    s_add_u32 s54, s63, 917504
    s_add_u32 m0, s58, 27648
    s_nop 0
    buffer_load_dwordx4 v12, s[16:19], s54 offen lds
    s_waitcnt vmcnt(36)
    ds_read_b64_tr_b16 a[168:169], v14 offset:28672
    ds_read_b64_tr_b16 a[170:171], v14 offset:29184
    ds_read_b64_tr_b16 a[172:173], v14 offset:30720
    ds_read_b64_tr_b16 a[174:175], v14 offset:31232
    ds_read_b64_tr_b16 a[184:185], v14 offset:28928
    ds_read_b64_tr_b16 a[186:187], v14 offset:29440
    ds_read_b64_tr_b16 a[188:189], v14 offset:30976
    ds_read_b64_tr_b16 a[190:191], v14 offset:31488
    s_waitcnt lgkmcnt(0)
    s_add_u32 s54, s63, 1048576
    s_add_u32 m0, s58, 28672
    s_nop 0
    buffer_load_dwordx4 v12, s[16:19], s54 offen lds
    s_add_u32 s54, s63, 1179648
    s_add_u32 m0, s58, 29696
    s_nop 0
    buffer_load_dwordx4 v12, s[16:19], s54 offen lds
    s_add_u32 s54, s63, 1310720
    s_add_u32 m0, s58, 30720
    s_nop 0
    buffer_load_dwordx4 v12, s[16:19], s54 offen lds
    s_add_u32 s54, s63, 1441792
    s_add_u32 m0, s58, 31744
    s_nop 0
    buffer_load_dwordx4 v12, s[16:19], s54 offen lds
    s_waitcnt vmcnt(36)
    ds_read_b64_tr_b16 a[200:201], v15 offset:0
    ds_read_b64_tr_b16 a[202:203], v15 offset:512
    ds_read_b64_tr_b16 a[204:205], v15 offset:2048
    ds_read_b64_tr_b16 a[206:207], v15 offset:2560
    ds_read_b64_tr_b16 a[216:217], v15 offset:256
    ds_read_b64_tr_b16 a[218:219], v15 offset:768
    ds_read_b64_tr_b16 a[220:221], v15 offset:2304
    ds_read_b64_tr_b16 a[222:223], v15 offset:2816
    s_waitcnt lgkmcnt(0)
    s_add_u32 s54, s63, 1572864
    s_add_u32 m0, s61, 0
    s_nop 0
    buffer_load_dwordx4 v12, s[16:19], s54 offen lds
    s_add_u32 s54, s63, 1703936
    s_add_u32 m0, s61, 1024
    s_nop 0
    buffer_load_dwordx4 v12, s[16:19], s54 offen lds
    s_add_u32 s54, s63, 1835008
    s_add_u32 m0, s61, 2048
    s_nop 0
    buffer_load_dwordx4 v12, s[16:19], s54 offen lds
    s_add_u32 s54, s63, 1966080
    s_add_u32 m0, s61, 3072
    s_nop 0
    buffer_load_dwordx4 v12, s[16:19], s54 offen lds
    s_waitcnt vmcnt(36)
    ds_read_b64_tr_b16 a[232:233], v15 offset:4096
    ds_read_b64_tr_b16 a[234:235], v15 offset:4608
    ds_read_b64_tr_b16 a[236:237], v15 offset:6144
    ds_read_b64_tr_b16 a[238:239], v15 offset:6656
    s_waitcnt lgkmcnt(0)
    s_add_u32 s54, s63, 2097152
    s_add_u32 m0, s61, 4096
    s_nop 0
    buffer_load_dwordx4 v12, s[16:19], s54 offen lds
    s_add_u32 s54, s63, 2228224
    s_add_u32 m0, s61, 5120
    s_nop 0
    buffer_load_dwordx4 v12, s[16:19], s54 offen lds
    s_add_u32 s54, s63, 2359296
    s_add_u32 m0, s61, 6144
    s_nop 0
    buffer_load_dwordx4 v12, s[16:19], s54 offen lds
    s_add_u32 s54, s63, 2490368
    s_add_u32 m0, s61, 7168
    s_nop 0
    buffer_load_dwordx4 v12, s[16:19], s54 offen lds
    s_waitcnt vmcnt(36)
    ds_read_b64_tr_b16 v[56:57], v14 offset:0
    ds_read_b64_tr_b16 v[58:59], v14 offset:512
    ds_read_b64_tr_b16 v[60:61], v14 offset:2048
    ds_read_b64_tr_b16 v[62:63], v14 offset:2560
    ds_read_b64_tr_b16 v[64:65], v14 offset:256
    ds_read_b64_tr_b16 v[66:67], v14 offset:768
    ds_read_b64_tr_b16 v[68:69], v14 offset:2304
    ds_read_b64_tr_b16 v[70:71], v14 offset:2816
    s_waitcnt lgkmcnt(0)
    ds_write_b128 v78, v[56:59] offset:0
    ds_write_b128 v78, v[60:63] offset:1024
    ds_write_b128 v78, v[64:67] offset:2048
    ds_write_b128 v78, v[68:71] offset:3072
    s_waitcnt vmcnt(32)
    ds_read_b64_tr_b16 v[56:57], v14 offset:4096
    ds_read_b64_tr_b16 v[58:59], v14 offset:4608
    ds_read_b64_tr_b16 v[60:61], v14 offset:6144
    ds_read_b64_tr_b16 v[62:63], v14 offset:6656
    ds_read_b64_tr_b16 v[64:65], v14 offset:4352
    ds_read_b64_tr_b16 v[66:67], v14 offset:4864
    ds_read_b64_tr_b16 v[68:69], v14 offset:6400
    ds_read_b64_tr_b16 v[70:71], v14 offset:6912
    s_waitcnt lgkmcnt(0)
    ds_write_b128 v78, v[56:59] offset:4096
    ds_write_b128 v78, v[60:63] offset:5120
    ds_write_b128 v78, v[64:67] offset:6144
    ds_write_b128 v78, v[68:71] offset:7168
    s_waitcnt vmcnt(28)
    ds_read_b64_tr_b16 v[56:57], v14 offset:8192
    ds_read_b64_tr_b16 v[58:59], v14 offset:8704
    ds_read_b64_tr_b16 v[60:61], v14 offset:10240
    ds_read_b64_tr_b16 v[62:63], v14 offset:10752
    ds_read_b64_tr_b16 v[64:65], v14 offset:8448
    ds_read_b64_tr_b16 v[66:67], v14 offset:8960
    ds_read_b64_tr_b16 v[68:69], v14 offset:10496
    ds_read_b64_tr_b16 v[70:71], v14 offset:11008
    s_waitcnt lgkmcnt(0)
    ds_write_b128 v78, v[56:59] offset:8192
    ds_write_b128 v78, v[60:63] offset:9216
    ds_write_b128 v78, v[64:67] offset:10240
    ds_write_b128 v78, v[68:71] offset:11264
    s_waitcnt vmcnt(24)
    ds_read_b64_tr_b16 v[56:57], v14 offset:12288
    ds_read_b64_tr_b16 v[58:59], v14 offset:12800
    ds_read_b64_tr_b16 v[60:61], v14 offset:14336
    ds_read_b64_tr_b16 v[62:63], v14 offset:14848
    ds_read_b64_tr_b16 v[64:65], v14 offset:12544
    ds_read_b64_tr_b16 v[66:67], v14 offset:13056
    ds_read_b64_tr_b16 v[68:69], v14 offset:14592
    ds_read_b64_tr_b16 v[70:71], v14 offset:15104
    s_waitcnt lgkmcnt(0)
    ds_write_b128 v78, v[56:59] offset:12288
    ds_write_b128 v78, v[60:63] offset:13312
    ds_write_b128 v78, v[64:67] offset:14336
    ds_write_b128 v78, v[68:71] offset:15360
    s_waitcnt vmcnt(20)
    ds_read_b64_tr_b16 v[56:57], v14 offset:16384
    ds_read_b64_tr_b16 v[58:59], v14 offset:16896
    ds_read_b64_tr_b16 v[60:61], v14 offset:18432
    ds_read_b64_tr_b16 v[62:63], v14 offset:18944
    ds_read_b64_tr_b16 v[64:65], v14 offset:16640
    ds_read_b64_tr_b16 v[66:67], v14 offset:17152
    ds_read_b64_tr_b16 v[68:69], v14 offset:18688
    ds_read_b64_tr_b16 v[70:71], v14 offset:19200
    s_waitcnt lgkmcnt(0)
    ds_write_b128 v78, v[56:59] offset:16384
    ds_write_b128 v78, v[60:63] offset:17408
    ds_write_b128 v78, v[64:67] offset:18432
    ds_write_b128 v78, v[68:71] offset:19456
    s_waitcnt vmcnt(16)
    ds_read_b64_tr_b16 v[56:57], v14 offset:20480
    ds_read_b64_tr_b16 v[58:59], v14 offset:20992
    ds_read_b64_tr_b16 v[60:61], v14 offset:22528
    ds_read_b64_tr_b16 v[62:63], v14 offset:23040
    ds_read_b64_tr_b16 v[64:65], v14 offset:20736
    ds_read_b64_tr_b16 v[66:67], v14 offset:21248
    ds_read_b64_tr_b16 v[68:69], v14 offset:22784
    ds_read_b64_tr_b16 v[70:71], v14 offset:23296
    s_waitcnt lgkmcnt(0)
    ds_write_b128 v78, v[56:59] offset:20480
    ds_write_b128 v78, v[60:63] offset:21504
    ds_write_b128 v78, v[64:67] offset:22528
    ds_write_b128 v78, v[68:71] offset:23552
    s_waitcnt vmcnt(12)
    ds_read_b64_tr_b16 v[56:57], v14 offset:24576
    ds_read_b64_tr_b16 v[58:59], v14 offset:25088
    ds_read_b64_tr_b16 v[60:61], v14 offset:26624
    ds_read_b64_tr_b16 v[62:63], v14 offset:27136
    ds_read_b64_tr_b16 v[64:65], v14 offset:24832
    ds_read_b64_tr_b16 v[66:67], v14 offset:25344
    ds_read_b64_tr_b16 v[68:69], v14 offset:26880
    ds_read_b64_tr_b16 v[70:71], v14 offset:27392
    s_waitcnt lgkmcnt(0)
    ds_write_b128 v78, v[56:59] offset:24576
    ds_write_b128 v78, v[60:63] offset:25600
    ds_write_b128 v78, v[64:67] offset:26624
    ds_write_b128 v78, v[68:71] offset:27648
    s_waitcnt vmcnt(8)
    ds_read_b64_tr_b16 v[56:57], v14 offset:28672
    ds_read_b64_tr_b16 v[58:59], v14 offset:29184
    ds_read_b64_tr_b16 v[60:61], v14 offset:30720
    ds_read_b64_tr_b16 v[62:63], v14 offset:31232
    ds_read_b64_tr_b16 v[64:65], v14 offset:28928
    ds_read_b64_tr_b16 v[66:67], v14 offset:29440
    ds_read_b64_tr_b16 v[68:69], v14 offset:30976
    ds_read_b64_tr_b16 v[70:71], v14 offset:31488
    s_waitcnt lgkmcnt(0)
    ds_write_b128 v78, v[56:59] offset:28672
    ds_write_b128 v78, v[60:63] offset:29696
    ds_write_b128 v78, v[64:67] offset:30720
    ds_write_b128 v78, v[68:71] offset:31744
    s_waitcnt vmcnt(4)
    ds_read_b64_tr_b16 v[80:81], v15 offset:0
    ds_read_b64_tr_b16 v[82:83], v15 offset:512
    ds_read_b64_tr_b16 v[84:85], v15 offset:2048
    ds_read_b64_tr_b16 v[86:87], v15 offset:2560
    ds_read_b64_tr_b16 v[88:89], v15 offset:256
    ds_read_b64_tr_b16 v[90:91], v15 offset:768
    ds_read_b64_tr_b16 v[92:93], v15 offset:2304
    ds_read_b64_tr_b16 v[94:95], v15 offset:2816
    s_waitcnt lgkmcnt(0)
    s_waitcnt vmcnt(0)
    ds_read_b64_tr_b16 a[240:241], v15 offset:4096
    ds_read_b64_tr_b16 a[242:243], v15 offset:4608
    ds_read_b64_tr_b16 a[244:245], v15 offset:6144
    ds_read_b64_tr_b16 a[246:247], v15 offset:6656
    ds_read_b64_tr_b16 a[248:249], v15 offset:4352
    ds_read_b64_tr_b16 a[250:251], v15 offset:4864
    ds_read_b64_tr_b16 a[252:253], v15 offset:6400
    ds_read_b64_tr_b16 a[254:255], v15 offset:6912
    s_waitcnt lgkmcnt(0)
    v_and_b32 v12, 15, v1
    v_lshrrev_b32 v13, 4, v1
    v_and_b32 v14, 1, v1
    v_mov_b32 v3, 0x4444
    v_mov_b32 v15, 0xeeee
    v_cmp_eq_u32 vcc, 1, v14
    s_nop 1
    v_cndmask_b32 v3, v3, v15, vcc
    v_lshlrev_b32 v4, 4, v0
    v_lshlrev_b32 v5, 2, v0
    v_add_u32 v5, 4096, v5
    v_lshlrev_b32 v6, 7, v13
    v_lshl_add_u32 v6, v12, 2, v6
    s_lshl_b32 s54, s49, 9
    v_add_u32 v6, s54, v6
    v_add_u32 v6, 10240, v6
    v_and_b32 v14, 7, v1
    v_lshlrev_b32 v7, 6, v14
    v_lshl_add_u32 v7, v13, 4, v7
    v_add_u32 v7, 10240, v7
    v_lshrrev_b32 v14, 2, v12
    v_lshlrev_b32 v8, 7, v14
    v_and_b32 v14, 1, v12
    v_lshl_add_u32 v8, v14, 6, v8
    v_lshl_add_u32 v8, v13, 4, v8
    v_add_u32 v8, 12288, v8
    v_lshrrev_b32 v14, 1, v13
    v_lshlrev_b32 v9, 8, v14
    v_and_b32 v14, 1, v13
    v_lshl_add_u32 v9, v14, 4, v9
    v_and_b32 v14, 7, v1
    v_lshl_add_u32 v9, v14, 5, v9
    s_lshl_b32 s54, s49, 9
    v_add_u32 v9, s54, v9
    v_add_u32 v9, 14336, v9
    v_lshrrev_b32 v14, 3, v1
    s_lshl_b32 s54, s49, 3
    v_add_u32 v14, s54, v14
    v_mul_u32_u24 v14, 10240, v14
    v_and_b32 v15, 7, v1
    s_lshl_b32 s54, s66, 7
    v_lshl_add_u32 v10, v15, 4, v14
    v_add_u32 v10, s54, v10
    s_lshl_b32 s54, s66, 6
    s_add_u32 s54, s54, 8192
    v_lshl_add_u32 v11, v15, 3, v14
    v_add_u32 v11, s54, v11
    s_mul_i32 s73, s66, 10240
    s_lshl_b32 s54, s49, 12
    s_add_u32 s73, s73, s54
    s_lshr_b32 s55, s66, 3
    s_mul_i32 s55, s55, 1280
    s_lshl_b32 s54, s49, 9
    s_add_u32 s55, s55, s54
    s_bfe_u32 s56, s66, 0x20001
    s_lshl_b32 s56, s56, 6
    s_add_u32 s55, s55, s56
    s_and_b32 s56, s66, 1
    s_lshl_b32 s56, s56, 4
    s_add_u32 s55, s55, s56
    s_cmp_eq_u32 s49, 2
    s_cselect_b32 s56, 32, 256
    s_cselect_b32 s57, 0, 32
    v_lshrrev_b32 v14, 5, v1
    v_mul_u32_u24 v16, s56, v14
    v_bfe_u32 v14, v1, 4, 1
    v_mad_u32_u24 v16, v14, s57, v16
    v_lshl_add_u32 v16, v15, 1, v16
    v_lshrrev_b32 v14, 1, v1
    v_lshlrev_b32 v14, 8, v14
    v_and_b32 v15, 1, v1
    v_lshl_add_u32 v14, v15, 5, v14
    v_subrev_u32 v14, 1536, v14
    s_cmp_eq_u32 s49, 3
    s_cselect_b64 vcc, -1, 0
    v_cndmask_b32 v16, v16, v14, vcc
    v_add_u32 v0, s55, v16
    v_and_b32 v14, 7, v1
    v_lshlrev_b32 v79, 2, v14
    v_lshlrev_b32 v1, 3, v1
    s_mov_b32 s80, 0x00ff00ff
    s_mov_b32 s81, 0x00ff00ff
    s_cmp_eq_u32 s49, 2
    s_cselect_b32 s82, 0, 0x00010000
    s_or_b32 s82, s82, 1
    s_mov_b32 s83, s82
    s_mov_b32 s84, 0x3e0293ee
    s_mul_i32 s54, s67, 5120
    s_add_u32 s68, s54, 117440512
    s_sub_u32 s69, 117455872, s54
    s_add_u32 s70, s54, 117440512
    s_add_u32 s71, s54, 117471232
    s_mul_i32 s54, s67, 327680
    s_add_u32 s72, s54, 118751232
    s_add_u32 s73, s73, s72
    s_add_u32 s54, s72, 655360
    s_xor_b32 s90, s54, s72
    s_add_u32 s54, s73, 655360
    s_xor_b32 s91, s54, s73
    s_lshr_b32 s85, 131072, s67
    s_lshl_b32 s54, s66, 13
    s_lshl_b32 s55, s49, 11
    s_add_u32 s75, s54, s55
    s_lshl_b32 s54, s66, 5
    s_add_u32 s76, s54, 121634816
    s_lshl_b32 s55, s67, 4
    s_add_u32 s78, s54, s55
    s_lshl_b32 s55, s49, 2
    s_add_u32 s78, s78, s55
    s_add_u32 s78, s78, 121700352
    s_lshl_b32 s54, s66, 2
    s_add_u32 s54, s54, s49
    s_lshl_b32 s55, s54, 10
    s_add_u32 s55, s55, 37748736
    s_lshl_b32 s54, s54, 9
    s_add_u32 s54, s54, 46137344
    s_cmp_eq_u32 s67, 0
    s_cselect_b32 s77, s55, s54
    s_lshl_b32 s61, s49, 11
    s_lshl_b32 s92, s49, 9
    s_mov_b32 s52, 0
    s_mov_b32 s74, 0
    s_mov_b32 s79, 121827328
    s_waitcnt lgkmcnt(0)
    s_barrier
L_wf_1:
    buffer_load_dword v56, v79, s[36:39], s76 offen sc1
    s_waitcnt vmcnt(0)
    v_cmp_eq_u32 vcc, 0, v56
    s_cbranch_vccz L_wfd_2
    s_sub_u32 s53, s53, 1
    s_cbranch_scc0 L_wf_1
    s_branch L_fail
L_wfd_2:
    s_add_u32 s76, s76, 1024
    v_mov_b32 v12, 0
    v_mov_b32 v13, 0
    v_mov_b32 v14, 0
    v_mov_b32 v15, 0
    v_mov_b32 v16, 0
    v_mov_b32 v17, 0
    v_mov_b32 v18, 0
    v_mov_b32 v19, 0
    v_mov_b32 v20, 0
    v_mov_b32 v21, 0
    v_mov_b32 v22, 0
    v_mov_b32 v23, 0
    v_mov_b32 v24, 0
    v_mov_b32 v25, 0
    v_mov_b32 v26, 0
    v_mov_b32 v27, 0
    v_mov_b32 v28, 0
    v_mov_b32 v29, 0
    v_mov_b32 v30, 0
    v_mov_b32 v31, 0
    v_mov_b32 v32, 0
    v_mov_b32 v33, 0
    v_mov_b32 v34, 0
    v_mov_b32 v35, 0
    s_cmp_lt_u32 s49, 3
    s_cbranch_scc1 L_gath
L_step:
    buffer_load_dwordx4 v[72:75], v4, s[36:39], s69 offen sc1
    buffer_load_dword v76, v5, s[36:39], s69 offen sc1
    buffer_load_dword v77, v79, s[36:39], s76 offen sc1
    s_waitcnt lgkmcnt(0)
    s_barrier
    ds_read_b128 v[36:39], v2 offset:0
    ds_read_b128 v[40:43], v2 offset:1024
    ds_read_b128 v[44:47], v2 offset:2048
    ds_read_b128 v[48:51], v2 offset:3072
    ds_read_b128 v[52:55], v2 offset:4096
    ds_read_b128 v[56:59], v78 offset:0
    ds_read_b128 v[60:63], v78 offset:1024
    ds_read_b128 v[64:67], v78 offset:2048
    ds_read_b128 v[68:71], v78 offset:3072
    s_waitcnt lgkmcnt(8)
    v_smfmac_f32_16x16x64_bf16 v[12:15], v[36:39], a[0:7], v3
    v_smfmac_f32_16x16x64_bf16 v[16:19], v[36:39], a[8:15], v3
    s_add_u32 m0, s61, 16384
    s_add_u32 s55, s75, 4194304
    buffer_load_dwordx4 v2, s[36:39], s55 offen sc1 lds
    v_smfmac_f32_16x16x64_bf16 v[20:23], v[36:39], v[96:103], v3
    v_smfmac_f32_16x16x64_bf16 v[24:27], v[36:39], v[104:111], v3
    s_waitcnt lgkmcnt(2)
    v_smfmac_f32_16x16x64_bf16 v[28:31], v[36:39], v[56:63], v3
    ds_read_b128 v[56:59], v78 offset:4096
    ds_read_b128 v[60:63], v78 offset:5120
    s_waitcnt lgkmcnt(2)
    v_smfmac_f32_16x16x64_bf16 v[32:35], v[36:39], v[64:71], v3
    ds_read_b128 v[64:67], v78 offset:6144
    ds_read_b128 v[68:71], v78 offset:7168
    v_smfmac_f32_16x16x64_bf16 v[12:15], v[40:43], a[16:23], v3
    v_smfmac_f32_16x16x64_bf16 v[16:19], v[40:43], a[24:31], v3
    s_add_u32 m0, s61, 17408
    s_add_u32 s55, s75, 4195328
    buffer_load_dwordx4 v2, s[36:39], s55 offen sc1 lds
    v_smfmac_f32_16x16x64_bf16 v[20:23], v[40:43], v[112:119], v3
    v_smfmac_f32_16x16x64_bf16 v[24:27], v[40:43], v[120:127], v3
    s_waitcnt lgkmcnt(2)
    v_smfmac_f32_16x16x64_bf16 v[28:31], v[40:43], v[56:63], v3
    ds_read_b128 v[56:59], v78 offset:8192
    ds_read_b128 v[60:63], v78 offset:9216
    s_waitcnt lgkmcnt(2)
    v_smfmac_f32_16x16x64_bf16 v[32:35], v[40:43], v[64:71], v3
    ds_read_b128 v[64:67], v78 offset:10240
    ds_read_b128 v[68:71], v78 offset:11264
    v_smfmac_f32_16x16x64_bf16 v[12:15], v[44:47], a[32:39], v3
    v_smfmac_f32_16x16x64_bf16 v[16:19], v[44:47], a[40:47], v3
    s_lshr_b32 s56, s61, 1
    s_add_u32 m0, s56, 24576
    s_add_u32 s55, s75, 20971520
    buffer_load_dwordx4 v2, s[36:39], s55 offen sc1 lds
    v_smfmac_f32_16x16x64_bf16 v[20:23], v[44:47], v[128:135], v3
    v_smfmac_f32_16x16x64_bf16 v[24:27], v[44:47], v[136:143], v3
    s_waitcnt lgkmcnt(2)
    v_smfmac_f32_16x16x64_bf16 v[28:31], v[44:47], v[56:63], v3
    ds_read_b128 v[56:59], v78 offset:12288
    ds_read_b128 v[60:63], v78 offset:13312
    s_waitcnt lgkmcnt(2)
    v_smfmac_f32_16x16x64_bf16 v[32:35], v[44:47], v[64:71], v3
    ds_read_b128 v[64:67], v78 offset:14336
    ds_read_b128 v[68:71], v78 offset:15360
    v_smfmac_f32_16x16x64_bf16 v[12:15], v[48:51], a[48:55], v3
    v_smfmac_f32_16x16x64_bf16 v[16:19], v[48:51], a[56:63], v3
    s_add_u32 m0, s56, 28672
    s_add_u32 s55, s75, 20972544
    buffer_load_dwordx4 v2, s[36:39], s55 offen sc1 lds
    v_smfmac_f32_16x16x64_bf16 v[20:23], v[48:51], v[144:151], v3
    v_smfmac_f32_16x16x64_bf16 v[24:27], v[48:51], v[152:159], v3
    s_waitcnt lgkmcnt(2)
    v_smfmac_f32_16x16x64_bf16 v[28:31], v[48:51], v[56:63], v3
    ds_read_b128 v[56:59], v78 offset:16384
    ds_read_b128 v[60:63], v78 offset:17408
    s_waitcnt lgkmcnt(2)
    v_smfmac_f32_16x16x64_bf16 v[32:35], v[48:51], v[64:71], v3
    ds_read_b128 v[64:67], v78 offset:18432
    ds_read_b128 v[68:71], v78 offset:19456
    v_smfmac_f32_16x16x64_bf16 v[12:15], v[52:55], a[64:71], v3
    v_smfmac_f32_16x16x64_bf16 v[16:19], v[52:55], a[72:79], v3
    v_smfmac_f32_16x16x64_bf16 v[20:23], v[52:55], v[160:167], v3
    v_smfmac_f32_16x16x64_bf16 v[24:27], v[52:55], v[168:175], v3
    s_waitcnt lgkmcnt(2)
    v_smfmac_f32_16x16x64_bf16 v[28:31], v[52:55], v[56:63], v3
    ds_read_b128 v[56:59], v78 offset:20480
    ds_read_b128 v[60:63], v78 offset:21504
    s_waitcnt lgkmcnt(2)
    v_smfmac_f32_16x16x64_bf16 v[32:35], v[52:55], v[64:71], v3
    ds_read_b128 v[64:67], v78 offset:22528
    ds_read_b128 v[68:71], v78 offset:23552
L_gr_3:
    s_waitcnt vmcnt(0)
    v_max3_u32 v36, v72, v73, v74
    v_add_u32 v37, -1, v77
    v_max3_u32 v36, v36, v75, v76
    ds_write_b128 v4, v[72:75] offset:5120
    v_max_u32 v36, v36, v37
    ds_write_b32 v5, v76 offset:5120
    v_cmp_eq_u32 vcc, -1, v36
    s_cbranch_vccz L_grd_4
    s_waitcnt lgkmcnt(0)
    buffer_load_dwordx4 v[72:75], v4, s[36:39], s69 offen sc1
    buffer_load_dword v76, v5, s[36:39], s69 offen sc1
    buffer_load_dword v77, v79, s[36:39], s76 offen sc1
    s_sub_u32 s53, s53, 1
    s_cbranch_scc0 L_gr_3
    s_branch L_fail
L_grd_4:
    s_waitcnt lgkmcnt(0)
    s_barrier
    ds_read_b128 v[36:39], v2 offset:5120
    ds_read_b128 v[40:43], v2 offset:6144
    ds_read_b128 v[44:47], v2 offset:7168
    ds_read_b128 v[48:51], v2 offset:8192
    ds_read_b128 v[52:55], v2 offset:9216
    s_mov_b64 exec, 1
    buffer_store_dword v3, v1, s[36:39], s79 offen sc1
    s_mov_b64 exec, -1
    s_cmp_lt_u32 s52, 63
    s_cselect_b32 s54, 262144, 0
    s_add_u32 s75, s75, s54
    v_bfe_u32 v77, v2, 4, 5
    v_lshlrev_b32 v77, 6, v77
    v_lshrrev_b32 v76, 9, v2
    v_lshl_add_u32 v77, v76, 24, v77
    s_add_u32 s55, s75, 4194304
    buffer_load_dword v77, v77, s[36:39], s55 offen sc1
    s_waitcnt lgkmcnt(4)
    v_smfmac_f32_16x16x64_bf16 v[12:15], v[36:39], a[80:87], v3
    v_smfmac_f32_16x16x64_bf16 v[16:19], v[36:39], a[88:95], v3
    s_waitcnt lgkmcnt(3)
    v_smfmac_f32_16x16x64_bf16 v[12:15], v[40:43], a[96:103], v3
    v_smfmac_f32_16x16x64_bf16 v[16:19], v[40:43], a[104:111], v3
    s_waitcnt lgkmcnt(2)
    v_smfmac_f32_16x16x64_bf16 v[12:15], v[44:47], a[112:119], v3
    v_smfmac_f32_16x16x64_bf16 v[16:19], v[44:47], a[120:127], v3
    s_waitcnt lgkmcnt(1)
    v_smfmac_f32_16x16x64_bf16 v[12:15], v[48:51], a[128:135], v3
    v_smfmac_f32_16x16x64_bf16 v[16:19], v[48:51], a[136:143], v3
    s_waitcnt lgkmcnt(0)
    v_smfmac_f32_16x16x64_bf16 v[12:15], v[52:55], a[144:151], v3
    v_smfmac_f32_16x16x64_bf16 v[16:19], v[52:55], a[152:159], v3
    v_smfmac_f32_16x16x64_bf16 v[20:23], v[36:39], v[176:183], v3
    v_smfmac_f32_16x16x64_bf16 v[24:27], v[36:39], v[184:191], v3
    s_nop 5
    v_add_f32 v12, v12, v13
    v_add_f32 v16, v16, v17
    v_smfmac_f32_16x16x64_bf16 v[20:23], v[40:43], v[192:199], v3
    v_cvt_pk_bf16_f32 v12, v12, v16
    ds_write_b32 v6, v12 offset:0
    v_smfmac_f32_16x16x64_bf16 v[24:27], v[40:43], v[200:207], v3
    v_add_f32 v14, v14, v15
    v_add_f32 v18, v18, v19
    v_smfmac_f32_16x16x64_bf16 v[20:23], v[44:47], v[208:215], v3
    v_cvt_pk_bf16_f32 v14, v14, v18
    ds_write_b32 v6, v14 offset:64
    v_smfmac_f32_16x16x64_bf16 v[24:27], v[44:47], v[216:223], v3
    v_smfmac_f32_16x16x64_bf16 v[20:23], v[48:51], v[224:231], v3
    v_smfmac_f32_16x16x64_bf16 v[24:27], v[48:51], v[232:239], v3
    v_smfmac_f32_16x16x64_bf16 v[20:23], v[52:55], v[240:247], v3
    v_smfmac_f32_16x16x64_bf16 v[24:27], v[52:55], v[248:255], v3
    v_smfmac_f32_16x16x64_bf16 v[28:31], v[48:51], v[80:87], v3
    v_smfmac_f32_16x16x64_bf16 v[32:35], v[48:51], v[88:95], v3
    s_nop 5
    v_add_f32 v20, v20, v21
    v_add_f32 v24, v24, v25
    v_cvt_pk_bf16_f32 v20, v20, v24
    ds_write_b32 v6, v20 offset:2048
    v_smfmac_f32_16x16x64_bf16 v[28:31], v[52:55], a[240:247], v3
    v_add_f32 v22, v22, v23
    v_add_f32 v26, v26, v27
    v_cvt_pk_bf16_f32 v22, v22, v26
    ds_write_b32 v6, v22 offset:2112
    v_smfmac_f32_16x16x64_bf16 v[32:35], v[52:55], a[248:255], v3
    v_smfmac_f32_16x16x64_bf16 v[28:31], v[36:39], v[56:63], v3
    ds_read_b128 v[56:59], v78 offset:24576
    ds_read_b128 v[60:63], v78 offset:25600
    v_smfmac_f32_16x16x64_bf16 v[32:35], v[36:39], v[64:71], v3
    ds_read_b128 v[64:67], v78 offset:26624
    ds_read_b128 v[68:71], v78 offset:27648
    s_waitcnt lgkmcnt(4)
    s_barrier
    ds_read_b128 v[12:15], v7 offset:0
    ds_read_b128 v[48:51], v2 offset:16384
    ds_read_b128 v[52:55], v2 offset:20480
    ds_read_b128 v[16:19], v7 offset:512
    ds_read_b128 v[72:75], v2 offset:17408
    ds_read_b128 v[20:23], v7 offset:1024
    ds_read_b128 v[24:27], v7 offset:1536
    s_waitcnt lgkmcnt(9)
    v_smfmac_f32_16x16x64_bf16 v[28:31], v[40:43], v[56:63], v3
    ds_read_b128 v[56:59], v78 offset:28672
    ds_read_b128 v[60:63], v78 offset:29696
    s_waitcnt lgkmcnt(9)
    v_smfmac_f32_16x16x64_bf16 v[32:35], v[40:43], v[64:71], v3
    ds_read_b128 v[64:67], v78 offset:30720
    ds_read_b128 v[68:71], v78 offset:31744
    s_waitcnt lgkmcnt(9)
    v_mfma_f32_16x16x32_bf16 v[36:39], v[48:51], v[12:15], 0
    ds_read_b128 v[48:51], v2 offset:21504
    s_waitcnt lgkmcnt(9)
    v_mfma_f32_16x16x32_bf16 v[40:43], v[52:55], v[12:15], 0
    ds_read_b128 v[52:55], v2 offset:18432
    s_waitcnt lgkmcnt(8)
    v_mfma_f32_16x16x32_bf16 v[36:39], v[72:75], v[16:19], v[36:39]
    ds_read_b128 v[72:75], v2 offset:22528
    s_waitcnt lgkmcnt(5)
    v_smfmac_f32_16x16x64_bf16 v[28:31], v[44:47], v[56:63], v3
    ds_read_b128 v[56:59], v2 offset:19456
    ds_read_b128 v[60:63], v2 offset:23552
    s_waitcnt lgkmcnt(5)
    v_smfmac_f32_16x16x64_bf16 v[32:35], v[44:47], v[64:71], v3
    ds_read_b128 v[64:67], v8 offset:0
    ds_read_b128 v[68:71], v8 offset:512
    s_waitcnt lgkmcnt(6)
    v_mfma_f32_16x16x32_bf16 v[40:43], v[48:51], v[16:19], v[40:43]
    ds_read_b128 v[48:51], v8 offset:1024
    s_waitcnt lgkmcnt(6)
    v_mfma_f32_16x16x32_bf16 v[36:39], v[52:55], v[20:23], v[36:39]
    ds_read_b128 v[52:55], v8 offset:1536
    s_waitcnt lgkmcnt(6)
    v_mfma_f32_16x16x32_bf16 v[40:43], v[72:75], v[20:23], v[40:43]
    v_add_u32 v76, s92, v8
    ds_read_b128 v[72:75], v76
    s_waitcnt lgkmcnt(6)
    v_mfma_f32_16x16x32_bf16 v[36:39], v[56:59], v[24:27], v[36:39]
    s_waitcnt lgkmcnt(4)
    v_mfma_f32_16x16x32_bf16 v[44:47], v[64:67], v[12:15], 0
    v_mfma_f32_16x16x32_bf16 v[40:43], v[60:63], v[24:27], v[40:43]
    s_waitcnt lgkmcnt(3)
    v_mfma_f32_16x16x32_bf16 v[44:47], v[68:71], v[16:19], v[44:47]
    ds_read_b128 v[56:59], v4 offset:24576
    ds_read_b128 v[60:63], v4 offset:28672
    s_waitcnt lgkmcnt(4)
    v_mfma_f32_16x16x32_bf16 v[44:47], v[48:51], v[20:23], v[44:47]
    v_add_f32 v28, v28, v29
    v_add_f32 v30, v30, v31
    v_add_f32 v32, v32, v33
    v_add_f32 v34, v34, v35
    s_waitcnt lgkmcnt(3)
    v_mfma_f32_16x16x32_bf16 v[44:47], v[52:55], v[24:27], v[44:47]
    v_cvt_pk_bf16_f32 v64, v28, v30
    v_mov_b32 v65, 0
    v_cvt_pk_bf16_f32 v66, v32, v34
    v_mov_b32 v67, 0
    v_max3_f32 v68, v36, v37, v38
    v_max3_f32 v69, v39, v40, v41
    v_max3_f32 v68, v68, v42, v43
    v_lshrrev_b32 v76, 1, v1
    s_waitcnt lgkmcnt(2)
    s_cmp_lg_u32 s67, 0
    s_cbranch_scc1 L_exv
    buffer_store_dwordx4 v[72:75], v2, s[36:39], s77 offen sc1
    s_branch L_exd
L_exv:
    buffer_store_dword v64, v76, s[36:39], s77 offen offset:0 sc1
    buffer_store_dword v66, v76, s[36:39], s77 offen offset:256 sc1
L_exd:
    s_cmp_eq_u32 s52, 63
    s_cbranch_scc1 L_team_done
    v_max3_f32 v69, v69, v44, v45
    v_max_f32 v68, v68, v69
    v_mov_b32 v69, v68
    s_nop 1
    v_permlane32_swap_b32 v68, v69
    s_nop 0
    v_max_f32 v68, v68, v69
    v_mov_b32 v69, v68
    s_nop 1
    v_permlane16_swap_b32 v68, v69
    s_nop 0
    v_max_f32 v68, v68, v69
    v_mul_f32 v68, s84, v68
    v_fma_f32 v36, v36, s84, -v68
    v_fma_f32 v37, v37, s84, -v68
    v_fma_f32 v38, v38, s84, -v68
    v_fma_f32 v39, v39, s84, -v68
    v_fma_f32 v40, v40, s84, -v68
    v_fma_f32 v41, v41, s84, -v68
    v_fma_f32 v42, v42, s84, -v68
    v_fma_f32 v43, v43, s84, -v68
    v_fma_f32 v44, v44, s84, -v68
    v_fma_f32 v45, v45, s84, -v68
    v_exp_f32 v36, v36
    v_exp_f32 v37, v37
    v_exp_f32 v38, v38
    v_exp_f32 v39, v39
    v_exp_f32 v40, v40
    v_exp_f32 v41, v41
    v_exp_f32 v42, v42
    v_exp_f32 v43, v43
    v_exp_f32 v44, v44
    v_exp_f32 v45, v45
    v_cvt_pk_bf16_f32 v12, v36, v37
    v_cvt_pk_bf16_f32 v13, v38, v39
    v_cvt_pk_bf16_f32 v14, v40, v41
    v_cvt_pk_bf16_f32 v15, v42, v43
    v_cvt_pk_bf16_f32 v16, v44, v45
    v_mov_b32 v17, 0
    s_waitcnt lgkmcnt(0)
    v_mfma_f32_16x16x32_bf16 v[28:31], v[56:59], v[12:15], 0
    v_mfma_f32_16x16x32_bf16 v[32:35], v[60:63], v[12:15], 0
    v_add_f32 v70, v36, v37
    v_add_f32 v70, v70, v38
    v_add_f32 v70, v70, v39
    v_add_f32 v70, v70, v40
    v_add_f32 v70, v70, v41
    v_add_f32 v70, v70, v42
    v_mfma_f32_16x16x16_bf16 v[28:31], v[64:65], v[16:17], v[28:31]
    v_mfma_f32_16x16x16_bf16 v[32:35], v[66:67], v[16:17], v[32:35]
    v_add_f32 v70, v70, v43
    v_add_f32 v70, v70, v44
    v_add_f32 v70, v70, v45
    v_mov_b32 v69, v70
    s_nop 1
    v_permlane32_swap_b32 v70, v69
    s_nop 0
    v_add_f32 v70, v70, v69
    v_mov_b32 v69, v70
    s_nop 1
    v_permlane16_swap_b32 v70, v69
    s_nop 0
    v_add_f32 v70, v70, v69
    v_rcp_f32 v70, v70
    v_mov_b32 v36, 0
    v_mul_f32 v28, v28, v70
    v_mul_f32 v29, v29, v70
    v_mul_f32 v30, v30, v70
    v_mul_f32 v31, v31, v70
    v_mul_f32 v32, v32, v70
    v_mul_f32 v33, v33, v70
    v_mul_f32 v34, v34, v70
    v_mul_f32 v35, v35, v70
    v_cvt_pk_bf16_f32 v20, v28, v29
    v_cvt_pk_bf16_f32 v21, v30, v31
    v_cvt_pk_bf16_f32 v22, v32, v33
    v_cvt_pk_bf16_f32 v23, v34, v35
    s_mov_b64 exec, s[80:81]
    ds_write_b128 v9, v[20:23]
    s_mov_b64 exec, -1
    v_mov_b32 v37, 0
    v_mov_b32 v38, 0
    v_mov_b32 v39, 0
    v_mov_b32 v40, 0
    v_mov_b32 v41, 0
    v_mov_b32 v42, 0
    v_mov_b32 v43, 0
    v_mov_b32 v44, 0
    v_mov_b32 v45, 0
    v_mov_b32 v46, 0
    v_mov_b32 v47, 0
    v_mov_b32 v48, 0
    v_mov_b32 v49, 0
    v_mov_b32 v50, 0
    v_mov_b32 v51, 0
    v_mov_b32 v52, 0
    v_mov_b32 v53, 0
    v_mov_b32 v54, 0
    v_mov_b32 v55, 0
    s_waitcnt lgkmcnt(0)
    s_barrier
    ds_read_b128 v[12:15], v2 offset:14336
    ds_read_b128 v[16:19], v2 offset:15360
    s_add_u32 s57, s72, 4096
    s_waitcnt lgkmcnt(1)
    v_smfmac_f32_16x16x64_bf16 v[36:39], v[12:15], a[160:167], v3
    v_smfmac_f32_16x16x64_bf16 v[40:43], v[12:15], a[176:183], v3
    v_smfmac_f32_16x16x64_bf16 v[44:47], v[12:15], a[192:199], v3
    v_smfmac_f32_16x16x64_bf16 v[48:51], v[12:15], a[208:215], v3
    v_smfmac_f32_16x16x64_bf16 v[52:55], v[12:15], a[224:231], v3
    s_waitcnt lgkmcnt(0)
    v_smfmac_f32_16x16x64_bf16 v[36:39], v[16:19], a[168:175], v3
    v_smfmac_f32_16x16x64_bf16 v[40:43], v[16:19], a[184:191], v3
    v_smfmac_f32_16x16x64_bf16 v[44:47], v[16:19], a[200:207], v3
    v_smfmac_f32_16x16x64_bf16 v[48:51], v[16:19], a[216:223], v3
    v_smfmac_f32_16x16x64_bf16 v[52:55], v[16:19], a[232:239], v3
    s_nop 3
    s_cmp_lg_u32 s51, 0
    s_cbranch_scc1 L_sl_5
    v_add_f32 v36, v36, v37
    v_and_or_b32 v20, v36, -2, s74
    v_add_f32 v38, v38, v39
    v_and_or_b32 v21, v38, -2, s74
    v_add_f32 v40, v40, v41
    v_and_or_b32 v22, v40, -2, s74
    v_add_f32 v42, v42, v43
    v_and_or_b32 v23, v42, -2, s74
    buffer_store_dwordx4 v[20:23], v10, s[36:39], s72 offen
    v_add_f32 v44, v44, v45
    v_and_or_b32 v24, v44, -2, s74
    v_add_f32 v46, v46, v47
    v_and_or_b32 v25, v46, -2, s74
    v_add_f32 v48, v48, v49
    v_and_or_b32 v26, v48, -2, s74
    v_add_f32 v50, v50, v51
    v_and_or_b32 v27, v50, -2, s74
    buffer_store_dwordx4 v[24:27], v10, s[36:39], s57 offen
    v_add_f32 v52, v52, v53
    v_and_or_b32 v28, v52, -2, s74
    v_add_f32 v54, v54, v55
    v_and_or_b32 v29, v54, -2, s74
    buffer_store_dwordx2 v[28:29], v11, s[36:39], s72 offen
    s_branch L_sd_6
L_sl_5:
    v_add_f32 v36, v36, v37
    v_and_or_b32 v20, v36, -2, s74
    v_add_f32 v38, v38, v39
    v_and_or_b32 v21, v38, -2, s74
    v_add_f32 v40, v40, v41
    v_and_or_b32 v22, v40, -2, s74
    v_add_f32 v42, v42, v43
    v_and_or_b32 v23, v42, -2, s74
    buffer_store_dwordx4 v[20:23], v10, s[36:39], s72 offen sc1
    v_add_f32 v44, v44, v45
    v_and_or_b32 v24, v44, -2, s74
    v_add_f32 v46, v46, v47
    v_and_or_b32 v25, v46, -2, s74
    v_add_f32 v48, v48, v49
    v_and_or_b32 v26, v48, -2, s74
    v_add_f32 v50, v50, v51
    v_and_or_b32 v27, v50, -2, s74
    buffer_store_dwordx4 v[24:27], v10, s[36:39], s57 offen sc1
    v_add_f32 v52, v52, v53
    v_and_or_b32 v28, v52, -2, s74
    v_add_f32 v54, v54, v55
    v_and_or_b32 v29, v54, -2, s74
    buffer_store_dwordx2 v[28:29], v11, s[36:39], s72 offen sc1
L_sd_6:
    s_add_u32 s69, s69, 20480
    s_add_u32 s54, s52, 1
    s_and_b32 s54, s54, 3
    s_mul_i32 s54, s54, 20480
    s_add_u32 s68, s70, s54
    s_add_u32 s57, s52, 3
    s_and_b32 s57, s57, 3
    s_mul_i32 s57, s57, 20480
    s_add_u32 s57, s70, s57
    s_mov_b32 s79, s78
    s_add_u32 s78, s78, 1024
    s_xor_b32 s72, s72, s90
    s_cmp_eq_u32 s49, 3
    s_cbranch_scc1 L_gath0
    s_cmp_eq_u32 s49, 2
    s_cbranch_scc1 L_own2
    s_sleep 4
L_ow_7:
    buffer_load_dwordx4 v[36:39], v2, s[36:39], s73 offen offset:0 sc1
    buffer_load_dwordx4 v[40:43], v2, s[36:39], s73 offen offset:1024 sc1
    buffer_load_dwordx4 v[44:47], v2, s[36:39], s73 offen offset:2048 sc1
    buffer_load_dwordx4 v[48:51], v2, s[36:39], s73 offen offset:3072 sc1
    s_mov_b64 exec, -1
    s_waitcnt vmcnt(3)
    v_bitop3_b32 v13, v36, v37, s74 bitop3:0x7e
    v_bitop3_b32 v14, v38, v39, s74 bitop3:0x7e
    v_or3_b32 v12, v13, v14, v13
    s_waitcnt vmcnt(2)
    v_bitop3_b32 v13, v40, v41, s74 bitop3:0x7e
    v_bitop3_b32 v14, v42, v43, s74 bitop3:0x7e
    v_or3_b32 v12, v13, v14, v12
    v_add_f32 v16, v40, v36
    v_add_f32 v17, v41, v37
    v_add_f32 v18, v42, v38
    v_add_f32 v19, v43, v39
    s_waitcnt vmcnt(1)
    v_bitop3_b32 v13, v44, v45, s74 bitop3:0x7e
    v_bitop3_b32 v14, v46, v47, s74 bitop3:0x7e
    v_or3_b32 v12, v13, v14, v12
    v_add_f32 v16, v44, v16
    v_add_f32 v17, v45, v17
    v_add_f32 v18, v46, v18
    v_add_f32 v19, v47, v19
    s_waitcnt vmcnt(0)
    v_bitop3_b32 v13, v48, v49, s74 bitop3:0x7e
    v_bitop3_b32 v14, v50, v51, s74 bitop3:0x7e
    v_or3_b32 v12, v13, v14, v12
    v_add_f32 v16, v48, v16
    v_add_f32 v17, v49, v17
    v_add_f32 v18, v50, v18
    v_add_f32 v19, v51, v19
    v_and_b32 v12, 1, v12
    v_cmp_ne_u32 vcc, 0, v12
    s_cbranch_vccz L_owd_8
    s_mov_b64 exec, vcc
    s_sub_u32 s53, s53, 1
    s_cbranch_scc0 L_ow_7
    s_branch L_fail
L_owd_8:
    v_permlane32_swap_b32 v16, v18
    v_permlane32_swap_b32 v17, v19
    v_add_f32 v16, v16, v18
    v_add_f32 v17, v17, v19
    s_nop 1
    v_permlane16_swap_b32 v16, v17
    s_nop 0
    v_add_f32 v16, v16, v17
    s_nop 1
    v_add_f32_dpp v16, v16, v16 row_ror:8 row_mask:0xf bank_mask:0xf
    s_nop 1
    v_mov_b32_dpp v17, v16 quad_perm:[1,0,3,2] row_mask:0xf bank_mask:0xf
    v_cvt_pk_bf16_f32 v16, v16, v17
    v_min_u32 v16, -2, v16
    v_mov_b32 v12, -1
    v_mov_b32 v13, -1
    v_mov_b32_dpp v17, v16 row_shl:2 row_mask:0xf bank_mask:0xf
    v_mov_b32_dpp v18, v16 row_shl:4 row_mask:0xf bank_mask:0xf
    v_mov_b32_dpp v19, v16 row_shl:6 row_mask:0xf bank_mask:0xf
    s_branch L_pub
L_own2:
    s_sleep 4
L_ow_9:
    buffer_load_dwordx2 v[36:37], v1, s[36:39], s73 offen offset:0 sc1
    buffer_load_dwordx2 v[40:41], v1, s[36:39], s73 offen offset:512 sc1
    buffer_load_dwordx2 v[44:45], v1, s[36:39], s73 offen offset:1024 sc1
    buffer_load_dwordx2 v[48:49], v1, s[36:39], s73 offen offset:1536 sc1
    s_mov_b64 exec, -1
    s_waitcnt vmcnt(3)
    v_bitop3_b32 v13, v36, v37, s74 bitop3:0x7e
    v_or3_b32 v12, v13, v13, v13
    s_waitcnt vmcnt(2)
    v_bitop3_b32 v13, v40, v41, s74 bitop3:0x7e
    v_or3_b32 v12, v13, v13, v12
    v_add_f32 v16, v40, v36
    v_add_f32 v17, v41, v37
    s_waitcnt vmcnt(1)
    v_bitop3_b32 v13, v44, v45, s74 bitop3:0x7e
    v_or3_b32 v12, v13, v13, v12
    v_add_f32 v16, v44, v16
    v_add_f32 v17, v45, v17
    s_waitcnt vmcnt(0)
    v_bitop3_b32 v13, v48, v49, s74 bitop3:0x7e
    v_or3_b32 v12, v13, v13, v12
    v_add_f32 v16, v48, v16
    v_add_f32 v17, v49, v17
    v_and_b32 v12, 1, v12
    v_cmp_ne_u32 vcc, 0, v12
    s_cbranch_vccz L_owd_10
    s_mov_b64 exec, vcc
    s_sub_u32 s53, s53, 1
    s_cbranch_scc0 L_ow_9
    s_branch L_fail
L_owd_10:
    v_permlane32_swap_b32 v16, v17
    s_nop 0
    v_add_f32 v16, v16, v17
    v_mov_b32 v17, v16
    s_nop 1
    v_permlane16_swap_b32 v16, v17
    s_nop 0
    v_add_f32 v16, v16, v17
    s_nop 1
    v_add_f32_dpp v16, v16, v16 row_ror:8 row_mask:0xf bank_mask:0xf
    s_nop 1
    v_mov_b32_dpp v17, v16 quad_perm:[1,0,3,2] row_mask:0xf bank_mask:0xf
    v_cvt_pk_bf16_f32 v16, v16, v17
    v_min_u32 v16, -2, v16
    v_mov_b32 v12, -1
    v_mov_b32 v13, -1
    v_mov_b32_dpp v17, v16 row_shl:2 row_mask:0xf bank_mask:0xf
    v_mov_b32_dpp v18, v16 row_shl:4 row_mask:0xf bank_mask:0xf
    v_mov_b32_dpp v19, v16 row_shl:6 row_mask:0xf bank_mask:0xf
L_pub:
    s_mov_b64 exec, s[82:83]
    s_cmp_lg_u32 s51, 0
    s_cbranch_scc1 L_sl_11
    buffer_store_dwordx4 v[16:19], v0, s[36:39], s68 offen
    ds_write_b128 v0, v[16:19] offset:0
    v_mov_b32 v14, -1
    v_mov_b32 v15, -1
    buffer_store_dwordx4 v[12:15], v0, s[36:39], s57 offen
    s_branch L_sd_12
L_sl_11:
    buffer_store_dwordx4 v[16:19], v0, s[36:39], s68 offen sc1
    ds_write_b128 v0, v[16:19] offset:0
    v_mov_b32 v14, -1
    v_mov_b32 v15, -1
    buffer_store_dwordx4 v[12:15], v0, s[36:39], s57 offen sc1
L_sd_12:
    s_mov_b64 exec, -1
    s_waitcnt lgkmcnt(0)
    s_barrier
    s_cmp_eq_u32 s49, 2
    s_cbranch_scc1 L_gf1
    buffer_load_dwordx4 v[36:39], v4, s[36:39], s68 offen offset:0 sc1
    buffer_load_dwordx4 v[40:43], v4, s[36:39], s68 offen offset:3072 sc1
    s_add_u32 s77, s77, s85
    s_cmp_lt_u32 s52, 62
    s_cselect_b32 s54, 1024, 0
    s_add_u32 s76, s76, s54
    s_add_u32 s71, s71, 20480
    s_and_b32 s54, s52, 1
    s_xor_b32 s74, s74, s54
    s_xor_b32 s73, s73, s91
    s_add_u32 s52, s52, 1
    v_mov_b32 v12, 0
    v_mov_b32 v13, 0
    v_mov_b32 v14, 0
    v_mov_b32 v15, 0
    v_mov_b32 v16, 0
    v_mov_b32 v17, 0
    v_mov_b32 v18, 0
    v_mov_b32 v19, 0
    v_mov_b32 v20, 0
    v_mov_b32 v21, 0
    v_mov_b32 v22, 0
    v_mov_b32 v23, 0
    v_mov_b32 v24, 0
    v_mov_b32 v25, 0
    v_mov_b32 v26, 0
    v_mov_b32 v27, 0
    v_mov_b32 v28, 0
    v_mov_b32 v29, 0
    v_mov_b32 v30, 0
    v_mov_b32 v31, 0
    v_mov_b32 v32, 0
    v_mov_b32 v33, 0
    v_mov_b32 v34, 0
    v_mov_b32 v35, 0
    s_branch L_gw2
L_gf1:
    buffer_load_dwordx4 v[36:39], v4, s[36:39], s68 offen offset:0 sc1
    s_add_u32 s77, s77, s85
    s_cmp_lt_u32 s52, 62
    s_cselect_b32 s54, 1024, 0
    s_add_u32 s76, s76, s54
    s_add_u32 s71, s71, 20480
    s_and_b32 s54, s52, 1
    s_xor_b32 s74, s74, s54
    s_xor_b32 s73, s73, s91
    s_add_u32 s52, s52, 1
    v_mov_b32 v12, 0
    v_mov_b32 v13, 0
    v_mov_b32 v14, 0
    v_mov_b32 v15, 0
    v_mov_b32 v16, 0
    v_mov_b32 v17, 0
    v_mov_b32 v18, 0
    v_mov_b32 v19, 0
    v_mov_b32 v20, 0
    v_mov_b32 v21, 0
    v_mov_b32 v22, 0
    v_mov_b32 v23, 0
    v_mov_b32 v24, 0
    v_mov_b32 v25, 0
    v_mov_b32 v26, 0
    v_mov_b32 v27, 0
    v_mov_b32 v28, 0
    v_mov_b32 v29, 0
    v_mov_b32 v30, 0
    v_mov_b32 v31, 0
    v_mov_b32 v32, 0
    v_mov_b32 v33, 0
    v_mov_b32 v34, 0
    v_mov_b32 v35, 0
    s_branch L_gw1
L_gath:
    s_cmp_eq_u32 s49, 2
    s_cbranch_scc1 L_gath2
L_ga_13:
    buffer_load_dwordx4 v[36:39], v4, s[36:39], s68 offen offset:0 sc1
    buffer_load_dwordx4 v[40:43], v4, s[36:39], s68 offen offset:3072 sc1
    s_mov_b64 exec, -1
L_gw2:
    s_waitcnt vmcnt(1)
    v_max3_u32 v44, v36, v37, v36
    v_max3_u32 v44, v38, v39, v44
    s_waitcnt vmcnt(0)
    v_max3_u32 v44, v40, v41, v44
    v_max3_u32 v44, v42, v43, v44
    v_cmp_eq_u32 vcc, -1, v44
    s_cbranch_vccz L_gad_14
    s_mov_b64 exec, vcc
    s_sub_u32 s53, s53, 1
    s_cbranch_scc0 L_ga_13
    s_branch L_fail
L_gad_14:
    ds_write_b128 v4, v[36:39] offset:0
    ds_write_b128 v4, v[40:43] offset:3072
    s_branch L_step
L_gath2:
L_ga_15:
    buffer_load_dwordx4 v[36:39], v4, s[36:39], s68 offen offset:0 sc1
    s_mov_b64 exec, -1
L_gw1:
    s_waitcnt vmcnt(0)
    v_max3_u32 v44, v36, v37, v36
    v_max3_u32 v44, v38, v39, v44
    v_cmp_eq_u32 vcc, -1, v44
    s_cbranch_vccz L_gad_16
    s_mov_b64 exec, vcc
    s_sub_u32 s53, s53, 1
    s_cbranch_scc0 L_ga_15
    s_branch L_fail
L_gad_16:
    ds_write_b128 v4, v[36:39] offset:0
    s_branch L_step
L_gath0:
    s_mov_b32 s57, s71
    s_add_u32 s77, s77, s85
    s_cmp_lt_u32 s52, 62
    s_cselect_b32 s54, 1024, 0
    s_add_u32 s76, s76, s54
    s_add_u32 s71, s71, 20480
    s_and_b32 s54, s52, 1
    s_xor_b32 s74, s74, s54
    s_xor_b32 s73, s73, s91
    s_add_u32 s52, s52, 1
    v_mov_b32 v12, 0
    v_mov_b32 v13, 0
    v_mov_b32 v14, 0
    v_mov_b32 v15, 0
    v_mov_b32 v16, 0
    v_mov_b32 v17, 0
    v_mov_b32 v18, 0
    v_mov_b32 v19, 0
    v_mov_b32 v20, 0
    v_mov_b32 v21, 0
    v_mov_b32 v22, 0
    v_mov_b32 v23, 0
    v_mov_b32 v24, 0
    v_mov_b32 v25, 0
    v_mov_b32 v26, 0
    v_mov_b32 v27, 0
    v_mov_b32 v28, 0
    v_mov_b32 v29, 0
    v_mov_b32 v30, 0
    v_mov_b32 v31, 0
    v_mov_b32 v32, 0
    v_mov_b32 v33, 0
    v_mov_b32 v34, 0
    v_mov_b32 v35, 0
    s_barrier
    s_mov_b64 exec, 0x3ff
    ds_read_b128 v[36:39], v0 offset:0
    s_waitcnt lgkmcnt(0)
    buffer_store_dwordx4 v[36:39], v0, s[36:39], s57 offen sc1
    s_mov_b64 exec, -1
    s_sleep 8
    s_branch L_step
L_team_done:
    s_waitcnt vmcnt(0)
    s_mov_b64 exec, 1
    buffer_store_dword v3, v1, s[36:39], s78 offen sc1
    s_endpgm
L_kproj:
    v_and_b32 v1, 63, v0
    v_lshlrev_b32 v2, 4, v1
    v_mov_b32 v8, 0
    v_mov_b32 v9, 1
    s_mul_i32 s61, s49, 10240
    s_add_u32 s55, s61, 0
    s_add_u32 s54, s55, 0
    s_add_u32 m0, s61, 0
    s_nop 0
    buffer_load_dwordx4 v2, s[36:39], s54 offen offset:0 lds
    buffer_load_dwordx4 v2, s[36:39], s54 offen offset:1024 lds
    buffer_load_dwordx4 v2, s[36:39], s54 offen offset:2048 lds
    buffer_load_dwordx4 v2, s[36:39], s54 offen offset:3072 lds
    s_add_u32 s54, s55, 4096
    s_add_u32 m0, s61, 4096
    s_nop 0
    buffer_load_dwordx4 v2, s[36:39], s54 offen offset:0 lds
    buffer_load_dwordx4 v2, s[36:39], s54 offen offset:1024 lds
    buffer_load_dwordx4 v2, s[36:39], s54 offen offset:2048 lds
    buffer_load_dwordx4 v2, s[36:39], s54 offen offset:3072 lds
    s_add_u32 s54, s55, 8192
    s_add_u32 m0, s61, 8192
    s_nop 0
    buffer_load_dwordx4 v2, s[36:39], s54 offen offset:0 lds
    buffer_load_dwordx4 v2, s[36:39], s54 offen offset:1024 lds
    s_lshl_b32 s59, s50, 8
    s_lshl_b32 s54, s49, 6
    s_add_u32 s59, s59, s54
    v_lshrrev_b32 v5, 5, v1
    v_mul_u32_u24 v3, 4, v5
    v_bfe_u32 v5, v1, 3, 1
    v_mad_u32_u24 v3, v5, 8, v3
    v_bfe_u32 v5, v1, 2, 1
    v_mad_u32_u24 v3, v5, 2, v3
    v_bfe_u32 v5, v1, 1, 1
    v_mad_u32_u24 v3, v5, 1, v3
    v_mov_b32 v6, 8192
    v_mul_lo_u32 v3, v3, v6
    v_bfe_u32 v5, v1, 4, 1
    v_lshl_add_u32 v3, v5, 5, v3
    v_and_b32 v5, 1, v1
    v_lshl_add_u32 v3, v5, 4, v3
    s_mul_i32 s58, s49, 20480
    s_add_u32 s58, s58, 81920
    v_lshrrev_b32 v5, 5, v1
    v_lshlrev_b32 v4, 10, v5
    v_and_b32 v5, 31, v1
    v_lshl_add_u32 v4, v5, 3, v4
    v_add_u32 v4, s58, v4
    s_add_u32 s54, s59, 0
    s_add_u32 m0, s58, 0
    s_nop 0
    buffer_load_dwordx4 v3, s[12:15], s54 offen lds
    s_add_u32 s54, s59, 131072
    s_add_u32 m0, s58, 1024
    s_nop 0
    buffer_load_dwordx4 v3, s[12:15], s54 offen lds
    s_add_u32 s54, s59, 262144
    s_add_u32 m0, s58, 2048
    s_nop 0
    buffer_load_dwordx4 v3, s[12:15], s54 offen lds
    s_add_u32 s54, s59, 393216
    s_add_u32 m0, s58, 3072
    s_nop 0
    buffer_load_dwordx4 v3, s[12:15], s54 offen lds
    s_add_u32 s54, s59, 524288
    s_add_u32 m0, s58, 4096
    s_nop 0
    buffer_load_dwordx4 v3, s[12:15], s54 offen lds
    s_add_u32 s54, s59, 655360
    s_add_u32 m0, s58, 5120
    s_nop 0
    buffer_load_dwordx4 v3, s[12:15], s54 offen lds
    s_add_u32 s54, s59, 786432
    s_add_u32 m0, s58, 6144
    s_nop 0
    buffer_load_dwordx4 v3, s[12:15], s54 offen lds
    s_add_u32 s54, s59, 917504
    s_add_u32 m0, s58, 7168
    s_nop 0
    buffer_load_dwordx4 v3, s[12:15], s54 offen lds
    s_add_u32 s54, s59, 1048576
    s_add_u32 m0, s58, 8192
    s_nop 0
    buffer_load_dwordx4 v3, s[12:15], s54 offen lds
    s_add_u32 s54, s59, 1179648
    s_add_u32 m0, s58, 9216
    s_nop 0
    buffer_load_dwordx4 v3, s[12:15], s54 offen lds
    s_add_u32 s54, s59, 1310720
    s_add_u32 m0, s58, 10240
    s_nop 0
    buffer_load_dwordx4 v3, s[12:15], s54 offen lds
    s_add_u32 s54, s59, 1441792
    s_add_u32 m0, s58, 11264
    s_nop 0
    buffer_load_dwordx4 v3, s[12:15], s54 offen lds
    s_add_u32 s54, s59, 1572864
    s_add_u32 m0, s58, 12288
    s_nop 0
    buffer_load_dwordx4 v3, s[12:15], s54 offen lds
    s_add_u32 s54, s59, 1703936
    s_add_u32 m0, s58, 13312
    s_nop 0
    buffer_load_dwordx4 v3, s[12:15], s54 offen lds
    s_add_u32 s54, s59, 1835008
    s_add_u32 m0, s58, 14336
    s_nop 0
    buffer_load_dwordx4 v3, s[12:15], s54 offen lds
    s_add_u32 s54, s59, 1966080
    s_add_u32 m0, s58, 15360
    s_nop 0
    buffer_load_dwordx4 v3, s[12:15], s54 offen lds
    s_add_u32 s54, s59, 2097152
    s_add_u32 m0, s58, 16384
    s_nop 0
    buffer_load_dwordx4 v3, s[12:15], s54 offen lds
    s_add_u32 s54, s59, 2228224
    s_add_u32 m0, s58, 17408
    s_nop 0
    buffer_load_dwordx4 v3, s[12:15], s54 offen lds
    s_add_u32 s54, s59, 2359296
    s_add_u32 m0, s58, 18432
    s_nop 0
    buffer_load_dwordx4 v3, s[12:15], s54 offen lds
    s_add_u32 s54, s59, 2490368
    s_add_u32 m0, s58, 19456
    s_nop 0
    buffer_load_dwordx4 v3, s[12:15], s54 offen lds
    s_waitcnt vmcnt(16)
    ds_read_b64_tr_b16 a[0:1], v4 offset:0
    ds_read_b64_tr_b16 a[2:3], v4 offset:512
    ds_read_b64_tr_b16 a[4:5], v4 offset:2048
    ds_read_b64_tr_b16 a[6:7], v4 offset:2560
    ds_read_b64_tr_b16 a[8:9], v4 offset:256
    ds_read_b64_tr_b16 a[10:11], v4 offset:768
    ds_read_b64_tr_b16 a[12:13], v4 offset:2304
    ds_read_b64_tr_b16 a[14:15], v4 offset:2816
    s_waitcnt lgkmcnt(0)
    s_add_u32 s54, s59, 2621440
    s_add_u32 m0, s58, 0
    s_nop 0
    buffer_load_dwordx4 v3, s[12:15], s54 offen lds
    s_add_u32 s54, s59, 2752512
    s_add_u32 m0, s58, 1024
    s_nop 0
    buffer_load_dwordx4 v3, s[12:15], s54 offen lds
    s_add_u32 s54, s59, 2883584
    s_add_u32 m0, s58, 2048
    s_nop 0
    buffer_load_dwordx4 v3, s[12:15], s54 offen lds
    s_add_u32 s54, s59, 3014656
    s_add_u32 m0, s58, 3072
    s_nop 0
    buffer_load_dwordx4 v3, s[12:15], s54 offen lds
    s_waitcnt vmcnt(16)
    ds_read_b64_tr_b16 a[16:17], v4 offset:4096
    ds_read_b64_tr_b16 a[18:19], v4 offset:4608
    ds_read_b64_tr_b16 a[20:21], v4 offset:6144
    ds_read_b64_tr_b16 a[22:23], v4 offset:6656
    ds_read_b64_tr_b16 a[24:25], v4 offset:4352
    ds_read_b64_tr_b16 a[26:27], v4 offset:4864
    ds_read_b64_tr_b16 a[28:29], v4 offset:6400
    ds_read_b64_tr_b16 a[30:31], v4 offset:6912
    s_waitcnt lgkmcnt(0)
    s_add_u32 s54, s59, 3145728
    s_add_u32 m0, s58, 4096
    s_nop 0
    buffer_load_dwordx4 v3, s[12:15], s54 offen lds
    s_add_u32 s54, s59, 3276800
    s_add_u32 m0, s58, 5120
    s_nop 0
    buffer_load_dwordx4 v3, s[12:15], s54 offen lds
    s_add_u32 s54, s59, 3407872
    s_add_u32 m0, s58, 6144
    s_nop 0
    buffer_load_dwordx4 v3, s[12:15], s54 offen lds
    s_add_u32 s54, s59, 3538944
    s_add_u32 m0, s58, 7168
    s_nop 0
    buffer_load_dwordx4 v3, s[12:15], s54 offen lds
    s_waitcnt vmcnt(16)
    ds_read_b64_tr_b16 a[32:33], v4 offset:8192
    ds_read_b64_tr_b16 a[34:35], v4 offset:8704
    ds_read_b64_tr_b16 a[36:37], v4 offset:10240
    ds_read_b64_tr_b16 a[38:39], v4 offset:10752
    ds_read_b64_tr_b16 a[40:41], v4 offset:8448
    ds_read_b64_tr_b16 a[42:43], v4 offset:8960
    ds_read_b64_tr_b16 a[44:45], v4 offset:10496
    ds_read_b64_tr_b16 a[46:47], v4 offset:11008
    s_waitcnt lgkmcnt(0)
    s_add_u32 s54, s59, 3670016
    s_add_u32 m0, s58, 8192
    s_nop 0
    buffer_load_dwordx4 v3, s[12:15], s54 offen lds
    s_add_u32 s54, s59, 3801088
    s_add_u32 m0, s58, 9216
    s_nop 0
    buffer_load_dwordx4 v3, s[12:15], s54 offen lds
    s_add_u32 s54, s59, 3932160
    s_add_u32 m0, s58, 10240
    s_nop 0
    buffer_load_dwordx4 v3, s[12:15], s54 offen lds
    s_add_u32 s54, s59, 4063232
    s_add_u32 m0, s58, 11264
    s_nop 0
    buffer_load_dwordx4 v3, s[12:15], s54 offen lds
    s_waitcnt vmcnt(16)
    ds_read_b64_tr_b16 a[48:49], v4 offset:12288
    ds_read_b64_tr_b16 a[50:51], v4 offset:12800
    ds_read_b64_tr_b16 a[52:53], v4 offset:14336
    ds_read_b64_tr_b16 a[54:55], v4 offset:14848
    ds_read_b64_tr_b16 a[56:57], v4 offset:12544
    ds_read_b64_tr_b16 a[58:59], v4 offset:13056
    ds_read_b64_tr_b16 a[60:61], v4 offset:14592
    ds_read_b64_tr_b16 a[62:63], v4 offset:15104
    s_waitcnt lgkmcnt(0)
    s_add_u32 s54, s59, 4194304
    s_add_u32 m0, s58, 12288
    s_nop 0
    buffer_load_dwordx4 v3, s[12:15], s54 offen lds
    s_add_u32 s54, s59, 4325376
    s_add_u32 m0, s58, 13312
    s_nop 0
    buffer_load_dwordx4 v3, s[12:15], s54 offen lds
    s_add_u32 s54, s59, 4456448
    s_add_u32 m0, s58, 14336
    s_nop 0
    buffer_load_dwordx4 v3, s[12:15], s54 offen lds
    s_add_u32 s54, s59, 4587520
    s_add_u32 m0, s58, 15360
    s_nop 0
    buffer_load_dwordx4 v3, s[12:15], s54 offen lds
    s_waitcnt vmcnt(16)
    ds_read_b64_tr_b16 a[64:65], v4 offset:16384
    ds_read_b64_tr_b16 a[66:67], v4 offset:16896
    ds_read_b64_tr_b16 a[68:69], v4 offset:18432
    ds_read_b64_tr_b16 a[70:71], v4 offset:18944
    ds_read_b64_tr_b16 a[72:73], v4 offset:16640
    ds_read_b64_tr_b16 a[74:75], v4 offset:17152
    ds_read_b64_tr_b16 a[76:77], v4 offset:18688
    ds_read_b64_tr_b16 a[78:79], v4 offset:19200
    s_waitcnt lgkmcnt(0)
    s_add_u32 s54, s59, 4718592
    s_add_u32 m0, s58, 16384
    s_nop 0
    buffer_load_dwordx4 v3, s[12:15], s54 offen lds
    s_add_u32 s54, s59, 4849664
    s_add_u32 m0, s58, 17408
    s_nop 0
    buffer_load_dwordx4 v3, s[12:15], s54 offen lds
    s_add_u32 s54, s59, 4980736
    s_add_u32 m0, s58, 18432
    s_nop 0
    buffer_load_dwordx4 v3, s[12:15], s54 offen lds
    s_add_u32 s54, s59, 5111808
    s_add_u32 m0, s58, 19456
    s_nop 0
    buffer_load_dwordx4 v3, s[12:15], s54 offen lds
    s_waitcnt vmcnt(16)
    ds_read_b64_tr_b16 a[80:81], v4 offset:0
    ds_read_b64_tr_b16 a[82:83], v4 offset:512
    ds_read_b64_tr_b16 a[84:85], v4 offset:2048
    ds_read_b64_tr_b16 a[86:87], v4 offset:2560
    ds_read_b64_tr_b16 a[88:89], v4 offset:256
    ds_read_b64_tr_b16 a[90:91], v4 offset:768
    ds_read_b64_tr_b16 a[92:93], v4 offset:2304
    ds_read_b64_tr_b16 a[94:95], v4 offset:2816
    s_waitcnt lgkmcnt(0)
    s_waitcnt vmcnt(12)
    ds_read_b64_tr_b16 a[96:97], v4 offset:4096
    ds_read_b64_tr_b16 a[98:99], v4 offset:4608
    ds_read_b64_tr_b16 a[100:101], v4 offset:6144
    ds_read_b64_tr_b16 a[102:103], v4 offset:6656
    ds_read_b64_tr_b16 a[104:105], v4 offset:4352
    ds_read_b64_tr_b16 a[106:107], v4 offset:4864
    ds_read_b64_tr_b16 a[108:109], v4 offset:6400
    ds_read_b64_tr_b16 a[110:111], v4 offset:6912
    s_waitcnt lgkmcnt(0)
    s_waitcnt vmcnt(8)
    ds_read_b64_tr_b16 a[112:113], v4 offset:8192
    ds_read_b64_tr_b16 a[114:115], v4 offset:8704
    ds_read_b64_tr_b16 a[116:117], v4 offset:10240
    ds_read_b64_tr_b16 a[118:119], v4 offset:10752
    ds_read_b64_tr_b16 a[120:121], v4 offset:8448
    ds_read_b64_tr_b16 a[122:123], v4 offset:8960
    ds_read_b64_tr_b16 a[124:125], v4 offset:10496
    ds_read_b64_tr_b16 a[126:127], v4 offset:11008
    s_waitcnt lgkmcnt(0)
    s_waitcnt vmcnt(4)
    ds_read_b64_tr_b16 a[128:129], v4 offset:12288
    ds_read_b64_tr_b16 a[130:131], v4 offset:12800
    ds_read_b64_tr_b16 a[132:133], v4 offset:14336
    ds_read_b64_tr_b16 a[134:135], v4 offset:14848
    ds_read_b64_tr_b16 a[136:137], v4 offset:12544
    ds_read_b64_tr_b16 a[138:139], v4 offset:13056
    ds_read_b64_tr_b16 a[140:141], v4 offset:14592
    ds_read_b64_tr_b16 a[142:143], v4 offset:15104
    s_waitcnt lgkmcnt(0)
    s_waitcnt vmcnt(0)
    ds_read_b64_tr_b16 a[144:145], v4 offset:16384
    ds_read_b64_tr_b16 a[146:147], v4 offset:16896
    ds_read_b64_tr_b16 a[148:149], v4 offset:18432
    ds_read_b64_tr_b16 a[150:151], v4 offset:18944
    ds_read_b64_tr_b16 a[152:153], v4 offset:16640
    ds_read_b64_tr_b16 a[154:155], v4 offset:17152
    ds_read_b64_tr_b16 a[156:157], v4 offset:18688
    ds_read_b64_tr_b16 a[158:159], v4 offset:19200
    s_waitcnt lgkmcnt(0)
    v_mov_b32 v7, v2
    s_mov_b32 s60, 40960
    s_mov_b32 s52, 0
    s_mov_b32 s62, 121827328
    s_lshl_b32 s63, s50, 5
    s_lshl_b32 s54, s49, 2
    s_add_u32 s63, s63, s54
    s_add_u32 s63, s63, 121634816
    s_lshl_b32 s64, s50, 13
    s_lshl_b32 s54, s49, 10
    s_add_u32 s64, s64, s54
    s_add_u32 s64, s64, 4194304
L_kproj_loop:
    s_waitcnt vmcnt(3)
    s_barrier
    s_add_u32 s55, s52, 1
    s_min_u32 s55, s55, 63
    s_mul_i32 s55, s55, 40960
    s_add_u32 s55, s55, s61
    s_add_u32 s55, s55, 0
    s_add_u32 s56, s61, s60
    s_add_u32 s54, s55, 0
    s_add_u32 m0, s56, 0
    s_nop 0
    buffer_load_dwordx4 v2, s[36:39], s54 offen offset:0 lds
    buffer_load_dwordx4 v2, s[36:39], s54 offen offset:1024 lds
    buffer_load_dwordx4 v2, s[36:39], s54 offen offset:2048 lds
    buffer_load_dwordx4 v2, s[36:39], s54 offen offset:3072 lds
    s_add_u32 s54, s55, 4096
    s_add_u32 m0, s56, 4096
    s_nop 0
    buffer_load_dwordx4 v2, s[36:39], s54 offen offset:0 lds
    buffer_load_dwordx4 v2, s[36:39], s54 offen offset:1024 lds
    buffer_load_dwordx4 v2, s[36:39], s54 offen offset:2048 lds
    buffer_load_dwordx4 v2, s[36:39], s54 offen offset:3072 lds
    s_add_u32 s54, s55, 8192
    s_add_u32 m0, s56, 8192
    s_nop 0
    buffer_load_dwordx4 v2, s[36:39], s54 offen offset:0 lds
    buffer_load_dwordx4 v2, s[36:39], s54 offen offset:1024 lds
    ds_read_b128 v[16:19], v7 offset:0
    ds_read_b128 v[20:23], v7 offset:1024
    ds_read_b128 v[24:27], v7 offset:2048
    ds_read_b128 v[28:31], v7 offset:3072
    ds_read_b128 v[32:35], v7 offset:4096
    ds_read_b128 v[36:39], v7 offset:5120
    s_waitcnt lgkmcnt(4)
    v_mfma_f32_16x16x32_bf16 v[40:43], a[0:3], v[16:19], 0
    v_mfma_f32_16x16x32_bf16 v[44:47], a[0:3], v[20:23], 0
    v_mfma_f32_16x16x32_bf16 v[48:51], a[8:11], v[16:19], 0
    v_mfma_f32_16x16x32_bf16 v[52:55], a[8:11], v[20:23], 0
    ds_read_b128 v[16:19], v7 offset:6144
    ds_read_b128 v[20:23], v7 offset:7168
    s_waitcnt lgkmcnt(4)
    v_mfma_f32_16x16x32_bf16 v[40:43], a[4:7], v[24:27], v[40:43]
    v_mfma_f32_16x16x32_bf16 v[44:47], a[4:7], v[28:31], v[44:47]
    v_mfma_f32_16x16x32_bf16 v[48:51], a[12:15], v[24:27], v[48:51]
    v_mfma_f32_16x16x32_bf16 v[52:55], a[12:15], v[28:31], v[52:55]
    ds_read_b128 v[24:27], v7 offset:8192
    ds_read_b128 v[28:31], v7 offset:9216
    s_waitcnt lgkmcnt(4)
    v_mfma_f32_16x16x32_bf16 v[40:43], a[16:19], v[32:35], v[40:43]
    v_mfma_f32_16x16x32_bf16 v[44:47], a[16:19], v[36:39], v[44:47]
    v_mfma_f32_16x16x32_bf16 v[48:51], a[24:27], v[32:35], v[48:51]
    v_mfma_f32_16x16x32_bf16 v[52:55], a[24:27], v[36:39], v[52:55]
    ds_read_b128 v[32:35], v7 offset:10240
    ds_read_b128 v[36:39], v7 offset:11264
    s_waitcnt lgkmcnt(4)
    v_mfma_f32_16x16x32_bf16 v[40:43], a[20:23], v[16:19], v[40:43]
    v_mfma_f32_16x16x32_bf16 v[44:47], a[20:23], v[20:23], v[44:47]
    v_mfma_f32_16x16x32_bf16 v[48:51], a[28:31], v[16:19], v[48:51]
    v_mfma_f32_16x16x32_bf16 v[52:55], a[28:31], v[20:23], v[52:55]
    ds_read_b128 v[16:19], v7 offset:12288
    ds_read_b128 v[20:23], v7 offset:13312
    s_waitcnt lgkmcnt(4)
    v_mfma_f32_16x16x32_bf16 v[40:43], a[32:35], v[24:27], v[40:43]
    v_mfma_f32_16x16x32_bf16 v[44:47], a[32:35], v[28:31], v[44:47]
    v_mfma_f32_16x16x32_bf16 v[48:51], a[40:43], v[24:27], v[48:51]
    v_mfma_f32_16x16x32_bf16 v[52:55], a[40:43], v[28:31], v[52:55]
    ds_read_b128 v[24:27], v7 offset:14336
    ds_read_b128 v[28:31], v7 offset:15360
    s_waitcnt lgkmcnt(4)
    v_mfma_f32_16x16x32_bf16 v[40:43], a[36:39], v[32:35], v[40:43]
    v_mfma_f32_16x16x32_bf16 v[44:47], a[36:39], v[36:39], v[44:47]
    v_mfma_f32_16x16x32_bf16 v[48:51], a[44:47], v[32:35], v[48:51]
    v_mfma_f32_16x16x32_bf16 v[52:55], a[44:47], v[36:39], v[52:55]
    ds_read_b128 v[32:35], v7 offset:16384
    ds_read_b128 v[36:39], v7 offset:17408
    s_waitcnt lgkmcnt(4)
    v_mfma_f32_16x16x32_bf16 v[40:43], a[48:51], v[16:19], v[40:43]
    v_mfma_f32_16x16x32_bf16 v[44:47], a[48:51], v[20:23], v[44:47]
    v_mfma_f32_16x16x32_bf16 v[48:51], a[56:59], v[16:19], v[48:51]
    v_mfma_f32_16x16x32_bf16 v[52:55], a[56:59], v[20:23], v[52:55]
    ds_read_b128 v[16:19], v7 offset:18432
    ds_read_b128 v[20:23], v7 offset:19456
    s_waitcnt lgkmcnt(4)
    v_mfma_f32_16x16x32_bf16 v[40:43], a[52:55], v[24:27], v[40:43]
    v_mfma_f32_16x16x32_bf16 v[44:47], a[52:55], v[28:31], v[44:47]
    v_mfma_f32_16x16x32_bf16 v[48:51], a[60:63], v[24:27], v[48:51]
    v_mfma_f32_16x16x32_bf16 v[52:55], a[60:63], v[28:31], v[52:55]
    ds_read_b128 v[24:27], v7 offset:20480
    ds_read_b128 v[28:31], v7 offset:21504
    s_waitcnt lgkmcnt(4)
    v_mfma_f32_16x16x32_bf16 v[40:43], a[64:67], v[32:35], v[40:43]
    v_mfma_f32_16x16x32_bf16 v[44:47], a[64:67], v[36:39], v[44:47]
    v_mfma_f32_16x16x32_bf16 v[48:51], a[72:75], v[32:35], v[48:51]
    v_mfma_f32_16x16x32_bf16 v[52:55], a[72:75], v[36:39], v[52:55]
    ds_read_b128 v[32:35], v7 offset:22528
    ds_read_b128 v[36:39], v7 offset:23552
    s_waitcnt lgkmcnt(4)
    v_mfma_f32_16x16x32_bf16 v[40:43], a[68:71], v[16:19], v[40:43]
    v_mfma_f32_16x16x32_bf16 v[44:47], a[68:71], v[20:23], v[44:47]
    v_mfma_f32_16x16x32_bf16 v[48:51], a[76:79], v[16:19], v[48:51]
    v_mfma_f32_16x16x32_bf16 v[52:55], a[76:79], v[20:23], v[52:55]
    s_waitcnt vmcnt(10)
    s_mov_b64 exec, 1
    buffer_store_dword v9, v8, s[36:39], s62 offen sc1
    s_mov_b64 exec, -1
    ds_read_b128 v[16:19], v7 offset:24576
    ds_read_b128 v[20:23], v7 offset:25600
    s_waitcnt lgkmcnt(4)
    v_mfma_f32_16x16x32_bf16 v[40:43], a[80:83], v[24:27], v[40:43]
    v_mfma_f32_16x16x32_bf16 v[44:47], a[80:83], v[28:31], v[44:47]
    v_mfma_f32_16x16x32_bf16 v[48:51], a[88:91], v[24:27], v[48:51]
    v_mfma_f32_16x16x32_bf16 v[52:55], a[88:91], v[28:31], v[52:55]
    ds_read_b128 v[24:27], v7 offset:26624
    ds_read_b128 v[28:31], v7 offset:27648
    s_waitcnt lgkmcnt(4)
    v_mfma_f32_16x16x32_bf16 v[40:43], a[84:87], v[32:35], v[40:43]
    v_mfma_f32_16x16x32_bf16 v[44:47], a[84:87], v[36:39], v[44:47]
    v_mfma_f32_16x16x32_bf16 v[48:51], a[92:95], v[32:35], v[48:51]
    v_mfma_f32_16x16x32_bf16 v[52:55], a[92:95], v[36:39], v[52:55]
    ds_read_b128 v[32:35], v7 offset:28672
    ds_read_b128 v[36:39], v7 offset:29696
    s_waitcnt lgkmcnt(4)
    v_mfma_f32_16x16x32_bf16 v[40:43], a[96:99], v[16:19], v[40:43]
    v_mfma_f32_16x16x32_bf16 v[44:47], a[96:99], v[20:23], v[44:47]
    v_mfma_f32_16x16x32_bf16 v[48:51], a[104:107], v[16:19], v[48:51]
    v_mfma_f32_16x16x32_bf16 v[52:55], a[104:107], v[20:23], v[52:55]
    ds_read_b128 v[16:19], v7 offset:30720
    ds_read_b128 v[20:23], v7 offset:31744
    s_waitcnt lgkmcnt(4)
    v_mfma_f32_16x16x32_bf16 v[40:43], a[100:103], v[24:27], v[40:43]
    v_mfma_f32_16x16x32_bf16 v[44:47], a[100:103], v[28:31], v[44:47]
    v_mfma_f32_16x16x32_bf16 v[48:51], a[108:111], v[24:27], v[48:51]
    v_mfma_f32_16x16x32_bf16 v[52:55], a[108:111], v[28:31], v[52:55]
    ds_read_b128 v[24:27], v7 offset:32768
    ds_read_b128 v[28:31], v7 offset:33792
    s_waitcnt lgkmcnt(4)
    v_mfma_f32_16x16x32_bf16 v[40:43], a[112:115], v[32:35], v[40:43]
    v_mfma_f32_16x16x32_bf16 v[44:47], a[112:115], v[36:39], v[44:47]
    v_mfma_f32_16x16x32_bf16 v[48:51], a[120:123], v[32:35], v[48:51]
    v_mfma_f32_16x16x32_bf16 v[52:55], a[120:123], v[36:39], v[52:55]
    ds_read_b128 v[32:35], v7 offset:34816
    ds_read_b128 v[36:39], v7 offset:35840
    s_waitcnt lgkmcnt(4)
    v_mfma_f32_16x16x32_bf16 v[40:43], a[116:119], v[16:19], v[40:43]
    v_mfma_f32_16x16x32_bf16 v[44:47], a[116:119], v[20:23], v[44:47]
    v_mfma_f32_16x16x32_bf16 v[48:51], a[124:127], v[16:19], v[48:51]
    v_mfma_f32_16x16x32_bf16 v[52:55], a[124:127], v[20:23], v[52:55]
    ds_read_b128 v[16:19], v7 offset:36864
    ds_read_b128 v[20:23], v7 offset:37888
    s_waitcnt lgkmcnt(4)
    v_mfma_f32_16x16x32_bf16 v[40:43], a[128:131], v[24:27], v[40:43]
    v_mfma_f32_16x16x32_bf16 v[44:47], a[128:131], v[28:31], v[44:47]
    v_mfma_f32_16x16x32_bf16 v[48:51], a[136:139], v[24:27], v[48:51]
    v_mfma_f32_16x16x32_bf16 v[52:55], a[136:139], v[28:31], v[52:55]
    ds_read_b128 v[24:27], v7 offset:38912
    ds_read_b128 v[28:31], v7 offset:39936
    s_waitcnt lgkmcnt(4)
    v_mfma_f32_16x16x32_bf16 v[40:43], a[132:135], v[32:35], v[40:43]
    v_mfma_f32_16x16x32_bf16 v[44:47], a[132:135], v[36:39], v[44:47]
    v_mfma_f32_16x16x32_bf16 v[48:51], a[140:143], v[32:35], v[48:51]
    v_mfma_f32_16x16x32_bf16 v[52:55], a[140:143], v[36:39], v[52:55]
    s_waitcnt lgkmcnt(2)
    v_mfma_f32_16x16x32_bf16 v[40:43], a[144:147], v[16:19], v[40:43]
    v_mfma_f32_16x16x32_bf16 v[44:47], a[144:147], v[20:23], v[44:47]
    v_mfma_f32_16x16x32_bf16 v[48:51], a[152:155], v[16:19], v[48:51]
    v_mfma_f32_16x16x32_bf16 v[52:55], a[152:155], v[20:23], v[52:55]
    s_waitcnt lgkmcnt(0)
    v_mfma_f32_16x16x32_bf16 v[40:43], a[148:151], v[24:27], v[40:43]
    v_mfma_f32_16x16x32_bf16 v[44:47], a[148:151], v[28:31], v[44:47]
    v_mfma_f32_16x16x32_bf16 v[48:51], a[156:159], v[24:27], v[48:51]
    v_mfma_f32_16x16x32_bf16 v[52:55], a[156:159], v[28:31], v[52:55]
    s_mov_b32 s62, s63
    s_add_u32 s63, s63, 1024
    s_xor_b32 s60, s60, 40960
    v_xor_b32 v7, 0xa000, v7
    s_nop 4
    s_add_u32 s54, s64, 4096
    v_cvt_pk_bf16_f32 v56, v40, v48
    v_cvt_pk_bf16_f32 v57, v41, v49
    v_cvt_pk_bf16_f32 v58, v42, v50
    v_cvt_pk_bf16_f32 v59, v43, v51
    buffer_store_dwordx4 v[56:59], v2, s[36:39], s64 offen sc1
    v_cvt_pk_bf16_f32 v60, v44, v52
    v_cvt_pk_bf16_f32 v61, v45, v53
    v_cvt_pk_bf16_f32 v62, v46, v54
    v_cvt_pk_bf16_f32 v63, v47, v55
    buffer_store_dwordx4 v[60:63], v2, s[36:39], s54 offen sc1
    s_add_u32 s64, s64, 262144
    s_add_u32 s52, s52, 1
    s_cmp_lt_u32 s52, 64
    s_cbranch_scc1 L_kproj_loop
    s_waitcnt vmcnt(0)
    s_mov_b64 exec, 1
    buffer_store_dword v9, v8, s[36:39], s62 offen sc1
    s_mov_b64 exec, -1
    s_endpgm
L_vproj:
    v_and_b32 v1, 63, v0
    v_lshlrev_b32 v2, 4, v1
    v_mov_b32 v8, 0
    v_mov_b32 v9, 1
    s_mul_i32 s61, s49, 10240
    s_add_u32 s55, s61, 0
    s_add_u32 s54, s55, 0
    s_add_u32 m0, s61, 0
    s_nop 0
    buffer_load_dwordx4 v2, s[36:39], s54 offen offset:0 lds
    buffer_load_dwordx4 v2, s[36:39], s54 offen offset:1024 lds
    buffer_load_dwordx4 v2, s[36:39], s54 offen offset:2048 lds
    buffer_load_dwordx4 v2, s[36:39], s54 offen offset:3072 lds
    s_add_u32 s54, s55, 4096
    s_add_u32 m0, s61, 4096
    s_nop 0
    buffer_load_dwordx4 v2, s[36:39], s54 offen offset:0 lds
    buffer_load_dwordx4 v2, s[36:39], s54 offen offset:1024 lds
    buffer_load_dwordx4 v2, s[36:39], s54 offen offset:2048 lds
    buffer_load_dwordx4 v2, s[36:39], s54 offen offset:3072 lds
    s_add_u32 s54, s55, 8192
    s_add_u32 m0, s61, 8192
    s_nop 0
    buffer_load_dwordx4 v2, s[36:39], s54 offen offset:0 lds
    buffer_load_dwordx4 v2, s[36:39], s54 offen offset:1024 lds
    s_lshl_b32 s59, s50, 8
    s_lshl_b32 s54, s49, 6
    s_add_u32 s59, s59, s54
    v_lshrrev_b32 v5, 5, v1
    v_mul_u32_u24 v3, 4, v5
    v_bfe_u32 v5, v1, 3, 1
    v_mad_u32_u24 v3, v5, 8, v3
    v_bfe_u32 v5, v1, 2, 1
    v_mad_u32_u24 v3, v5, 2, v3
    v_bfe_u32 v5, v1, 1, 1
    v_mad_u32_u24 v3, v5, 1, v3
    v_mov_b32 v6, 8192
    v_mul_lo_u32 v3, v3, v6
    v_bfe_u32 v5, v1, 4, 1
    v_lshl_add_u32 v3, v5, 5, v3
    v_and_b32 v5, 1, v1
    v_lshl_add_u32 v3, v5, 4, v3
    s_mul_i32 s58, s49, 20480
    s_add_u32 s58, s58, 81920
    v_lshrrev_b32 v5, 5, v1
    v_lshlrev_b32 v4, 10, v5
    v_and_b32 v5, 31, v1
    v_lshl_add_u32 v4, v5, 3, v4
    v_add_u32 v4, s58, v4
    s_add_u32 s54, s59, 0
    s_add_u32 m0, s58, 0
    s_nop 0
    buffer_load_dwordx4 v3, s[16:19], s54 offen lds
    s_add_u32 s54, s59, 131072
    s_add_u32 m0, s58, 1024
    s_nop 0
    buffer_load_dwordx4 v3, s[16:19], s54 offen lds
    s_add_u32 s54, s59, 262144
    s_add_u32 m0, s58, 2048
    s_nop 0
    buffer_load_dwordx4 v3, s[16:19], s54 offen lds
    s_add_u32 s54, s59, 393216
    s_add_u32 m0, s58, 3072
    s_nop 0
    buffer_load_dwordx4 v3, s[16:19], s54 offen lds
    s_add_u32 s54, s59, 524288
    s_add_u32 m0, s58, 4096
    s_nop 0
    buffer_load_dwordx4 v3, s[16:19], s54 offen lds
    s_add_u32 s54, s59, 655360
    s_add_u32 m0, s58, 5120
    s_nop 0
    buffer_load_dwordx4 v3, s[16:19], s54 offen lds
    s_add_u32 s54, s59, 786432
    s_add_u32 m0, s58, 6144
    s_nop 0
    buffer_load_dwordx4 v3, s[16:19], s54 offen lds
    s_add_u32 s54, s59, 917504
    s_add_u32 m0, s58, 7168
    s_nop 0
    buffer_load_dwordx4 v3, s[16:19], s54 offen lds
    s_add_u32 s54, s59, 1048576
    s_add_u32 m0, s58, 8192
    s_nop 0
    buffer_load_dwordx4 v3, s[16:19], s54 offen lds
    s_add_u32 s54, s59, 1179648
    s_add_u32 m0, s58, 9216
    s_nop 0
    buffer_load_dwordx4 v3, s[16:19], s54 offen lds
    s_add_u32 s54, s59, 1310720
    s_add_u32 m0, s58, 10240
    s_nop 0
    buffer_load_dwordx4 v3, s[16:19], s54 offen lds
    s_add_u32 s54, s59, 1441792
    s_add_u32 m0, s58, 11264
    s_nop 0
    buffer_load_dwordx4 v3, s[16:19], s54 offen lds
    s_add_u32 s54, s59, 1572864
    s_add_u32 m0, s58, 12288
    s_nop 0
    buffer_load_dwordx4 v3, s[16:19], s54 offen lds
    s_add_u32 s54, s59, 1703936
    s_add_u32 m0, s58, 13312
    s_nop 0
    buffer_load_dwordx4 v3, s[16:19], s54 offen lds
    s_add_u32 s54, s59, 1835008
    s_add_u32 m0, s58, 14336
    s_nop 0
    buffer_load_dwordx4 v3, s[16:19], s54 offen lds
    s_add_u32 s54, s59, 1966080
    s_add_u32 m0, s58, 15360
    s_nop 0
    buffer_load_dwordx4 v3, s[16:19], s54 offen lds
    s_add_u32 s54, s59, 2097152
    s_add_u32 m0, s58, 16384
    s_nop 0
    buffer_load_dwordx4 v3, s[16:19], s54 offen lds
    s_add_u32 s54, s59, 2228224
    s_add_u32 m0, s58, 17408
    s_nop 0
    buffer_load_dwordx4 v3, s[16:19], s54 offen lds
    s_add_u32 s54, s59, 2359296
    s_add_u32 m0, s58, 18432
    s_nop 0
    buffer_load_dwordx4 v3, s[16:19], s54 offen lds
    s_add_u32 s54, s59, 2490368
    s_add_u32 m0, s58, 19456
    s_nop 0
    buffer_load_dwordx4 v3, s[16:19], s54 offen lds
    s_waitcnt vmcnt(16)
    ds_read_b64_tr_b16 a[0:1], v4 offset:0
    ds_read_b64_tr_b16 a[2:3], v4 offset:512
    ds_read_b64_tr_b16 a[4:5], v4 offset:2048
    ds_read_b64_tr_b16 a[6:7], v4 offset:2560
    ds_read_b64_tr_b16 a[8:9], v4 offset:256
    ds_read_b64_tr_b16 a[10:11], v4 offset:768
    ds_read_b64_tr_b16 a[12:13], v4 offset:2304
    ds_read_b64_tr_b16 a[14:15], v4 offset:2816
    s_waitcnt lgkmcnt(0)
    s_add_u32 s54, s59, 2621440
    s_add_u32 m0, s58, 0
    s_nop 0
    buffer_load_dwordx4 v3, s[16:19], s54 offen lds
    s_add_u32 s54, s59, 2752512
    s_add_u32 m0, s58, 1024
    s_nop 0
    buffer_load_dwordx4 v3, s[16:19], s54 offen lds
    s_add_u32 s54, s59, 2883584
    s_add_u32 m0, s58, 2048
    s_nop 0
    buffer_load_dwordx4 v3, s[16:19], s54 offen lds
    s_add_u32 s54, s59, 3014656
    s_add_u32 m0, s58, 3072
    s_nop 0
    buffer_load_dwordx4 v3, s[16:19], s54 offen lds
    s_waitcnt vmcnt(16)
    ds_read_b64_tr_b16 a[16:17], v4 offset:4096
    ds_read_b64_tr_b16 a[18:19], v4 offset:4608
    ds_read_b64_tr_b16 a[20:21], v4 offset:6144
    ds_read_b64_tr_b16 a[22:23], v4 offset:6656
    ds_read_b64_tr_b16 a[24:25], v4 offset:4352
    ds_read_b64_tr_b16 a[26:27], v4 offset:4864
    ds_read_b64_tr_b16 a[28:29], v4 offset:6400
    ds_read_b64_tr_b16 a[30:31], v4 offset:6912
    s_waitcnt lgkmcnt(0)
    s_add_u32 s54, s59, 3145728
    s_add_u32 m0, s58, 4096
    s_nop 0
    buffer_load_dwordx4 v3, s[16:19], s54 offen lds
    s_add_u32 s54, s59, 3276800
    s_add_u32 m0, s58, 5120
    s_nop 0
    buffer_load_dwordx4 v3, s[16:19], s54 offen lds
    s_add_u32 s54, s59, 3407872
    s_add_u32 m0, s58, 6144
    s_nop 0
    buffer_load_dwordx4 v3, s[16:19], s54 offen lds
    s_add_u32 s54, s59, 3538944
    s_add_u32 m0, s58, 7168
    s_nop 0
    buffer_load_dwordx4 v3, s[16:19], s54 offen lds
    s_waitcnt vmcnt(16)
    ds_read_b64_tr_b16 a[32:33], v4 offset:8192
    ds_read_b64_tr_b16 a[34:35], v4 offset:8704
    ds_read_b64_tr_b16 a[36:37], v4 offset:10240
    ds_read_b64_tr_b16 a[38:39], v4 offset:10752
    ds_read_b64_tr_b16 a[40:41], v4 offset:8448
    ds_read_b64_tr_b16 a[42:43], v4 offset:8960
    ds_read_b64_tr_b16 a[44:45], v4 offset:10496
    ds_read_b64_tr_b16 a[46:47], v4 offset:11008
    s_waitcnt lgkmcnt(0)
    s_add_u32 s54, s59, 3670016
    s_add_u32 m0, s58, 8192
    s_nop 0
    buffer_load_dwordx4 v3, s[16:19], s54 offen lds
    s_add_u32 s54, s59, 3801088
    s_add_u32 m0, s58, 9216
    s_nop 0
    buffer_load_dwordx4 v3, s[16:19], s54 offen lds
    s_add_u32 s54, s59, 3932160
    s_add_u32 m0, s58, 10240
    s_nop 0
    buffer_load_dwordx4 v3, s[16:19], s54 offen lds
    s_add_u32 s54, s59, 4063232
    s_add_u32 m0, s58, 11264
    s_nop 0
    buffer_load_dwordx4 v3, s[16:19], s54 offen lds
    s_waitcnt vmcnt(16)
    ds_read_b64_tr_b16 a[48:49], v4 offset:12288
    ds_read_b64_tr_b16 a[50:51], v4 offset:12800
    ds_read_b64_tr_b16 a[52:53], v4 offset:14336
    ds_read_b64_tr_b16 a[54:55], v4 offset:14848
    ds_read_b64_tr_b16 a[56:57], v4 offset:12544
    ds_read_b64_tr_b16 a[58:59], v4 offset:13056
    ds_read_b64_tr_b16 a[60:61], v4 offset:14592
    ds_read_b64_tr_b16 a[62:63], v4 offset:15104
    s_waitcnt lgkmcnt(0)
    s_add_u32 s54, s59, 4194304
    s_add_u32 m0, s58, 12288
    s_nop 0
    buffer_load_dwordx4 v3, s[16:19], s54 offen lds
    s_add_u32 s54, s59, 4325376
    s_add_u32 m0, s58, 13312
    s_nop 0
    buffer_load_dwordx4 v3, s[16:19], s54 offen lds
    s_add_u32 s54, s59, 4456448
    s_add_u32 m0, s58, 14336
    s_nop 0
    buffer_load_dwordx4 v3, s[16:19], s54 offen lds
    s_add_u32 s54, s59, 4587520
    s_add_u32 m0, s58, 15360
    s_nop 0
    buffer_load_dwordx4 v3, s[16:19], s54 offen lds
    s_waitcnt vmcnt(16)
    ds_read_b64_tr_b16 a[64:65], v4 offset:16384
    ds_read_b64_tr_b16 a[66:67], v4 offset:16896
    ds_read_b64_tr_b16 a[68:69], v4 offset:18432
    ds_read_b64_tr_b16 a[70:71], v4 offset:18944
    ds_read_b64_tr_b16 a[72:73], v4 offset:16640
    ds_read_b64_tr_b16 a[74:75], v4 offset:17152
    ds_read_b64_tr_b16 a[76:77], v4 offset:18688
    ds_read_b64_tr_b16 a[78:79], v4 offset:19200
    s_waitcnt lgkmcnt(0)
    s_add_u32 s54, s59, 4718592
    s_add_u32 m0, s58, 16384
    s_nop 0
    buffer_load_dwordx4 v3, s[16:19], s54 offen lds
    s_add_u32 s54, s59, 4849664
    s_add_u32 m0, s58, 17408
    s_nop 0
    buffer_load_dwordx4 v3, s[16:19], s54 offen lds
    s_add_u32 s54, s59, 4980736
    s_add_u32 m0, s58, 18432
    s_nop 0
    buffer_load_dwordx4 v3, s[16:19], s54 offen lds
    s_add_u32 s54, s59, 5111808
    s_add_u32 m0, s58, 19456
    s_nop 0
    buffer_load_dwordx4 v3, s[16:19], s54 offen lds
    s_waitcnt vmcnt(16)
    ds_read_b64_tr_b16 a[80:81], v4 offset:0
    ds_read_b64_tr_b16 a[82:83], v4 offset:512
    ds_read_b64_tr_b16 a[84:85], v4 offset:2048
    ds_read_b64_tr_b16 a[86:87], v4 offset:2560
    ds_read_b64_tr_b16 a[88:89], v4 offset:256
    ds_read_b64_tr_b16 a[90:91], v4 offset:768
    ds_read_b64_tr_b16 a[92:93], v4 offset:2304
    ds_read_b64_tr_b16 a[94:95], v4 offset:2816
    s_waitcnt lgkmcnt(0)
    s_waitcnt vmcnt(12)
    ds_read_b64_tr_b16 a[96:97], v4 offset:4096
    ds_read_b64_tr_b16 a[98:99], v4 offset:4608
    ds_read_b64_tr_b16 a[100:101], v4 offset:6144
    ds_read_b64_tr_b16 a[102:103], v4 offset:6656
    ds_read_b64_tr_b16 a[104:105], v4 offset:4352
    ds_read_b64_tr_b16 a[106:107], v4 offset:4864
    ds_read_b64_tr_b16 a[108:109], v4 offset:6400
    ds_read_b64_tr_b16 a[110:111], v4 offset:6912
    s_waitcnt lgkmcnt(0)
    s_waitcnt vmcnt(8)
    ds_read_b64_tr_b16 a[112:113], v4 offset:8192
    ds_read_b64_tr_b16 a[114:115], v4 offset:8704
    ds_read_b64_tr_b16 a[116:117], v4 offset:10240
    ds_read_b64_tr_b16 a[118:119], v4 offset:10752
    ds_read_b64_tr_b16 a[120:121], v4 offset:8448
    ds_read_b64_tr_b16 a[122:123], v4 offset:8960
    ds_read_b64_tr_b16 a[124:125], v4 offset:10496
    ds_read_b64_tr_b16 a[126:127], v4 offset:11008
    s_waitcnt lgkmcnt(0)
    s_waitcnt vmcnt(4)
    ds_read_b64_tr_b16 a[128:129], v4 offset:12288
    ds_read_b64_tr_b16 a[130:131], v4 offset:12800
    ds_read_b64_tr_b16 a[132:133], v4 offset:14336
    ds_read_b64_tr_b16 a[134:135], v4 offset:14848
    ds_read_b64_tr_b16 a[136:137], v4 offset:12544
    ds_read_b64_tr_b16 a[138:139], v4 offset:13056
    ds_read_b64_tr_b16 a[140:141], v4 offset:14592
    ds_read_b64_tr_b16 a[142:143], v4 offset:15104
    s_waitcnt lgkmcnt(0)
    s_waitcnt vmcnt(0)
    ds_read_b64_tr_b16 a[144:145], v4 offset:16384
    ds_read_b64_tr_b16 a[146:147], v4 offset:16896
    ds_read_b64_tr_b16 a[148:149], v4 offset:18432
    ds_read_b64_tr_b16 a[150:151], v4 offset:18944
    ds_read_b64_tr_b16 a[152:153], v4 offset:16640
    ds_read_b64_tr_b16 a[154:155], v4 offset:17152
    ds_read_b64_tr_b16 a[156:157], v4 offset:18688
    ds_read_b64_tr_b16 a[158:159], v4 offset:19200
    s_waitcnt lgkmcnt(0)
    v_mov_b32 v7, v2
    s_mov_b32 s60, 40960
    s_mov_b32 s52, 0
    s_mov_b32 s62, 121827328
    s_lshl_b32 s63, s50, 5
    s_lshl_b32 s54, s49, 2
    s_add_u32 s63, s63, s54
    s_add_u32 s63, s63, 121634832
    s_lshl_b32 s64, s50, 13
    s_lshl_b32 s54, s49, 11
    s_add_u32 s64, s64, s54
    s_add_u32 s64, s64, 20971520
L_vproj_loop:
    s_waitcnt vmcnt(3)
    s_barrier
    s_add_u32 s55, s52, 1
    s_min_u32 s55, s55, 63
    s_mul_i32 s55, s55, 40960
    s_add_u32 s55, s55, s61
    s_add_u32 s55, s55, 0
    s_add_u32 s56, s61, s60
    s_add_u32 s54, s55, 0
    s_add_u32 m0, s56, 0
    s_nop 0
    buffer_load_dwordx4 v2, s[36:39], s54 offen offset:0 lds
    buffer_load_dwordx4 v2, s[36:39], s54 offen offset:1024 lds
    buffer_load_dwordx4 v2, s[36:39], s54 offen offset:2048 lds
    buffer_load_dwordx4 v2, s[36:39], s54 offen offset:3072 lds
    s_add_u32 s54, s55, 4096
    s_add_u32 m0, s56, 4096
    s_nop 0
    buffer_load_dwordx4 v2, s[36:39], s54 offen offset:0 lds
    buffer_load_dwordx4 v2, s[36:39], s54 offen offset:1024 lds
    buffer_load_dwordx4 v2, s[36:39], s54 offen offset:2048 lds
    buffer_load_dwordx4 v2, s[36:39], s54 offen offset:3072 lds
    s_add_u32 s54, s55, 8192
    s_add_u32 m0, s56, 8192
    s_nop 0
    buffer_load_dwordx4 v2, s[36:39], s54 offen offset:0 lds
    buffer_load_dwordx4 v2, s[36:39], s54 offen offset:1024 lds
    ds_read_b128 v[16:19], v7 offset:0
    ds_read_b128 v[20:23], v7 offset:1024
    ds_read_b128 v[24:27], v7 offset:2048
    ds_read_b128 v[28:31], v7 offset:3072
    ds_read_b128 v[32:35], v7 offset:4096
    ds_read_b128 v[36:39], v7 offset:5120
    s_waitcnt lgkmcnt(4)
    v_mfma_f32_16x16x32_bf16 v[40:43], v[16:19], a[0:3], 0
    v_mfma_f32_16x16x32_bf16 v[44:47], v[20:23], a[0:3], 0
    v_mfma_f32_16x16x32_bf16 v[48:51], v[16:19], a[8:11], 0
    v_mfma_f32_16x16x32_bf16 v[52:55], v[20:23], a[8:11], 0
    ds_read_b128 v[16:19], v7 offset:6144
    ds_read_b128 v[20:23], v7 offset:7168
    s_waitcnt lgkmcnt(4)
    v_mfma_f32_16x16x32_bf16 v[40:43], v[24:27], a[4:7], v[40:43]
    v_mfma_f32_16x16x32_bf16 v[44:47], v[28:31], a[4:7], v[44:47]
    v_mfma_f32_16x16x32_bf16 v[48:51], v[24:27], a[12:15], v[48:51]
    v_mfma_f32_16x16x32_bf16 v[52:55], v[28:31], a[12:15], v[52:55]
    ds_read_b128 v[24:27], v7 offset:8192
    ds_read_b128 v[28:31], v7 offset:9216
    s_waitcnt lgkmcnt(4)
    v_mfma_f32_16x16x32_bf16 v[40:43], v[32:35], a[16:19], v[40:43]
    v_mfma_f32_16x16x32_bf16 v[44:47], v[36:39], a[16:19], v[44:47]
    v_mfma_f32_16x16x32_bf16 v[48:51], v[32:35], a[24:27], v[48:51]
    v_mfma_f32_16x16x32_bf16 v[52:55], v[36:39], a[24:27], v[52:55]
    ds_read_b128 v[32:35], v7 offset:10240
    ds_read_b128 v[36:39], v7 offset:11264
    s_waitcnt lgkmcnt(4)
    v_mfma_f32_16x16x32_bf16 v[40:43], v[16:19], a[20:23], v[40:43]
    v_mfma_f32_16x16x32_bf16 v[44:47], v[20:23], a[20:23], v[44:47]
    v_mfma_f32_16x16x32_bf16 v[48:51], v[16:19], a[28:31], v[48:51]
    v_mfma_f32_16x16x32_bf16 v[52:55], v[20:23], a[28:31], v[52:55]
    ds_read_b128 v[16:19], v7 offset:12288
    ds_read_b128 v[20:23], v7 offset:13312
    s_waitcnt lgkmcnt(4)
    v_mfma_f32_16x16x32_bf16 v[40:43], v[24:27], a[32:35], v[40:43]
    v_mfma_f32_16x16x32_bf16 v[44:47], v[28:31], a[32:35], v[44:47]
    v_mfma_f32_16x16x32_bf16 v[48:51], v[24:27], a[40:43], v[48:51]
    v_mfma_f32_16x16x32_bf16 v[52:55], v[28:31], a[40:43], v[52:55]
    ds_read_b128 v[24:27], v7 offset:14336
    ds_read_b128 v[28:31], v7 offset:15360
    s_waitcnt lgkmcnt(4)
    v_mfma_f32_16x16x32_bf16 v[40:43], v[32:35], a[36:39], v[40:43]
    v_mfma_f32_16x16x32_bf16 v[44:47], v[36:39], a[36:39], v[44:47]
    v_mfma_f32_16x16x32_bf16 v[48:51], v[32:35], a[44:47], v[48:51]
    v_mfma_f32_16x16x32_bf16 v[52:55], v[36:39], a[44:47], v[52:55]
    ds_read_b128 v[32:35], v7 offset:16384
    ds_read_b128 v[36:39], v7 offset:17408
    s_waitcnt lgkmcnt(4)
    v_mfma_f32_16x16x32_bf16 v[40:43], v[16:19], a[48:51], v[40:43]
    v_mfma_f32_16x16x32_bf16 v[44:47], v[20:23], a[48:51], v[44:47]
    v_mfma_f32_16x16x32_bf16 v[48:51], v[16:19], a[56:59], v[48:51]
    v_mfma_f32_16x16x32_bf16 v[52:55], v[20:23], a[56:59], v[52:55]
    ds_read_b128 v[16:19], v7 offset:18432
    ds_read_b128 v[20:23], v7 offset:19456
    s_waitcnt lgkmcnt(4)
    v_mfma_f32_16x16x32_bf16 v[40:43], v[24:27], a[52:55], v[40:43]
    v_mfma_f32_16x16x32_bf16 v[44:47], v[28:31], a[52:55], v[44:47]
    v_mfma_f32_16x16x32_bf16 v[48:51], v[24:27], a[60:63], v[48:51]
    v_mfma_f32_16x16x32_bf16 v[52:55], v[28:31], a[60:63], v[52:55]
    ds_read_b128 v[24:27], v7 offset:20480
    ds_read_b128 v[28:31], v7 offset:21504
    s_waitcnt lgkmcnt(4)
    v_mfma_f32_16x16x32_bf16 v[40:43], v[32:35], a[64:67], v[40:43]
    v_mfma_f32_16x16x32_bf16 v[44:47], v[36:39], a[64:67], v[44:47]
    v_mfma_f32_16x16x32_bf16 v[48:51], v[32:35], a[72:75], v[48:51]
    v_mfma_f32_16x16x32_bf16 v[52:55], v[36:39], a[72:75], v[52:55]
    ds_read_b128 v[32:35], v7 offset:22528
    ds_read_b128 v[36:39], v7 offset:23552
    s_waitcnt lgkmcnt(4)
    v_mfma_f32_16x16x32_bf16 v[40:43], v[16:19], a[68:71], v[40:43]
    v_mfma_f32_16x16x32_bf16 v[44:47], v[20:23], a[68:71], v[44:47]
    v_mfma_f32_16x16x32_bf16 v[48:51], v[16:19], a[76:79], v[48:51]
    v_mfma_f32_16x16x32_bf16 v[52:55], v[20:23], a[76:79], v[52:55]
    s_waitcnt vmcnt(10)
    s_mov_b64 exec, 1
    buffer_store_dword v9, v8, s[36:39], s62 offen sc1
    s_mov_b64 exec, -1
    ds_read_b128 v[16:19], v7 offset:24576
    ds_read_b128 v[20:23], v7 offset:25600
    s_waitcnt lgkmcnt(4)
    v_mfma_f32_16x16x32_bf16 v[40:43], v[24:27], a[80:83], v[40:43]
    v_mfma_f32_16x16x32_bf16 v[44:47], v[28:31], a[80:83], v[44:47]
    v_mfma_f32_16x16x32_bf16 v[48:51], v[24:27], a[88:91], v[48:51]
    v_mfma_f32_16x16x32_bf16 v[52:55], v[28:31], a[88:91], v[52:55]
    ds_read_b128 v[24:27], v7 offset:26624
    ds_read_b128 v[28:31], v7 offset:27648
    s_waitcnt lgkmcnt(4)
    v_mfma_f32_16x16x32_bf16 v[40:43], v[32:35], a[84:87], v[40:43]
    v_mfma_f32_16x16x32_bf16 v[44:47], v[36:39], a[84:87], v[44:47]
    v_mfma_f32_16x16x32_bf16 v[48:51], v[32:35], a[92:95], v[48:51]
    v_mfma_f32_16x16x32_bf16 v[52:55], v[36:39], a[92:95], v[52:55]
    ds_read_b128 v[32:35], v7 offset:28672
    ds_read_b128 v[36:39], v7 offset:29696
    s_waitcnt lgkmcnt(4)
    v_mfma_f32_16x16x32_bf16 v[40:43], v[16:19], a[96:99], v[40:43]
    v_mfma_f32_16x16x32_bf16 v[44:47], v[20:23], a[96:99], v[44:47]
    v_mfma_f32_16x16x32_bf16 v[48:51], v[16:19], a[104:107], v[48:51]
    v_mfma_f32_16x16x32_bf16 v[52:55], v[20:23], a[104:107], v[52:55]
    ds_read_b128 v[16:19], v7 offset:30720
    ds_read_b128 v[20:23], v7 offset:31744
    s_waitcnt lgkmcnt(4)
    v_mfma_f32_16x16x32_bf16 v[40:43], v[24:27], a[100:103], v[40:43]
    v_mfma_f32_16x16x32_bf16 v[44:47], v[28:31], a[100:103], v[44:47]
    v_mfma_f32_16x16x32_bf16 v[48:51], v[24:27], a[108:111], v[48:51]
    v_mfma_f32_16x16x32_bf16 v[52:55], v[28:31], a[108:111], v[52:55]
    ds_read_b128 v[24:27], v7 offset:32768
    ds_read_b128 v[28:31], v7 offset:33792
    s_waitcnt lgkmcnt(4)
    v_mfma_f32_16x16x32_bf16 v[40:43], v[32:35], a[112:115], v[40:43]
    v_mfma_f32_16x16x32_bf16 v[44:47], v[36:39], a[112:115], v[44:47]
    v_mfma_f32_16x16x32_bf16 v[48:51], v[32:35], a[120:123], v[48:51]
    v_mfma_f32_16x16x32_bf16 v[52:55], v[36:39], a[120:123], v[52:55]
    ds_read_b128 v[32:35], v7 offset:34816
    ds_read_b128 v[36:39], v7 offset:35840
    s_waitcnt lgkmcnt(4)
    v_mfma_f32_16x16x32_bf16 v[40:43], v[16:19], a[116:119], v[40:43]
    v_mfma_f32_16x16x32_bf16 v[44:47], v[20:23], a[116:119], v[44:47]
    v_mfma_f32_16x16x32_bf16 v[48:51], v[16:19], a[124:127], v[48:51]
    v_mfma_f32_16x16x32_bf16 v[52:55], v[20:23], a[124:127], v[52:55]
    ds_read_b128 v[16:19], v7 offset:36864
    ds_read_b128 v[20:23], v7 offset:37888
    s_waitcnt lgkmcnt(4)
    v_mfma_f32_16x16x32_bf16 v[40:43], v[24:27], a[128:131], v[40:43]
    v_mfma_f32_16x16x32_bf16 v[44:47], v[28:31], a[128:131], v[44:47]
    v_mfma_f32_16x16x32_bf16 v[48:51], v[24:27], a[136:139], v[48:51]
    v_mfma_f32_16x16x32_bf16 v[52:55], v[28:31], a[136:139], v[52:55]
    ds_read_b128 v[24:27], v7 offset:38912
    ds_read_b128 v[28:31], v7 offset:39936
    s_waitcnt lgkmcnt(4)
    v_mfma_f32_16x16x32_bf16 v[40:43], v[32:35], a[132:135], v[40:43]
    v_mfma_f32_16x16x32_bf16 v[44:47], v[36:39], a[132:135], v[44:47]
    v_mfma_f32_16x16x32_bf16 v[48:51], v[32:35], a[140:143], v[48:51]
    v_mfma_f32_16x16x32_bf16 v[52:55], v[36:39], a[140:143], v[52:55]
    s_waitcnt lgkmcnt(2)
    v_mfma_f32_16x16x32_bf16 v[40:43], v[16:19], a[144:147], v[40:43]
    v_mfma_f32_16x16x32_bf16 v[44:47], v[20:23], a[144:147], v[44:47]
    v_mfma_f32_16x16x32_bf16 v[48:51], v[16:19], a[152:155], v[48:51]
    v_mfma_f32_16x16x32_bf16 v[52:55], v[20:23], a[152:155], v[52:55]
    s_waitcnt lgkmcnt(0)
    v_mfma_f32_16x16x32_bf16 v[40:43], v[24:27], a[148:151], v[40:43]
    v_mfma_f32_16x16x32_bf16 v[44:47], v[28:31], a[148:151], v[44:47]
    v_mfma_f32_16x16x32_bf16 v[48:51], v[24:27], a[156:159], v[48:51]
    v_mfma_f32_16x16x32_bf16 v[52:55], v[28:31], a[156:159], v[52:55]
    s_mov_b32 s62, s63
    s_add_u32 s63, s63, 1024
    s_xor_b32 s60, s60, 40960
    v_xor_b32 v7, 0xa000, v7
    s_nop 4
    v_cvt_pk_bf16_f32 v56, v40, v41
    v_cvt_pk_bf16_f32 v57, v42, v43
    v_cvt_pk_bf16_f32 v58, v44, v45
    v_cvt_pk_bf16_f32 v59, v46, v47
    buffer_store_dwordx4 v[56:59], v2, s[36:39], s64 offen offset:0 sc1
    v_cvt_pk_bf16_f32 v60, v48, v49
    v_cvt_pk_bf16_f32 v61, v50, v51
    v_cvt_pk_bf16_f32 v62, v52, v53
    v_cvt_pk_bf16_f32 v63, v54, v55
    buffer_store_dwordx4 v[60:63], v2, s[36:39], s64 offen offset:1024 sc1
    s_add_u32 s64, s64, 262144
    s_add_u32 s52, s52, 1
    s_cmp_lt_u32 s52, 64
    s_cbranch_scc1 L_vproj_loop
    s_waitcnt vmcnt(0)
    s_mov_b64 exec, 1
    buffer_store_dword v9, v8, s[36:39], s62 offen sc1
    s_mov_b64 exec, -1
    s_endpgm
L_qa:
    v_and_b32 v1, 63, v0
    v_lshlrev_b32 v2, 4, v1
    v_mov_b32 v8, 0
    v_mov_b32 v9, 1
    s_mul_i32 s61, s49, 10240
    s_add_u32 s55, s61, 0
    s_add_u32 s54, s55, 0
    s_add_u32 m0, s61, 0
    s_nop 0
    buffer_load_dwordx4 v2, s[36:39], s54 offen offset:0 lds
    buffer_load_dwordx4 v2, s[36:39], s54 offen offset:1024 lds
    buffer_load_dwordx4 v2, s[36:39], s54 offen offset:2048 lds
    buffer_load_dwordx4 v2, s[36:39], s54 offen offset:3072 lds
    s_add_u32 s54, s55, 4096
    s_add_u32 m0, s61, 4096
    s_nop 0
    buffer_load_dwordx4 v2, s[36:39], s54 offen offset:0 lds
    buffer_load_dwordx4 v2, s[36:39], s54 offen offset:1024 lds
    buffer_load_dwordx4 v2, s[36:39], s54 offen offset:2048 lds
    buffer_load_dwordx4 v2, s[36:39], s54 offen offset:3072 lds
    s_add_u32 s54, s55, 8192
    s_add_u32 m0, s61, 8192
    s_nop 0
    buffer_load_dwordx4 v2, s[36:39], s54 offen offset:0 lds
    buffer_load_dwordx4 v2, s[36:39], s54 offen offset:1024 lds
    s_lshl_b32 s59, s50, 8
    s_lshl_b32 s54, s49, 6
    s_add_u32 s59, s59, s54
    v_lshrrev_b32 v5, 5, v1
    v_mul_u32_u24 v3, 4, v5
    v_bfe_u32 v5, v1, 3, 1
    v_mad_u32_u24 v3, v5, 8, v3
    v_bfe_u32 v5, v1, 2, 1
    v_mad_u32_u24 v3, v5, 2, v3
    v_bfe_u32 v5, v1, 1, 1
    v_mad_u32_u24 v3, v5, 1, v3
    v_mov_b32 v6, 8192
    v_mul_lo_u32 v3, v3, v6
    v_bfe_u32 v5, v1, 4, 1
    v_lshl_add_u32 v3, v5, 5, v3
    v_and_b32 v5, 1, v1
    v_lshl_add_u32 v3, v5, 4, v3
    s_mul_i32 s58, s49, 20480
    s_add_u32 s58, s58, 81920
    v_lshrrev_b32 v5, 5, v1
    v_lshlrev_b32 v4, 10, v5
    v_and_b32 v5, 31, v1
    v_lshl_add_u32 v4, v5, 3, v4
    v_add_u32 v4, s58, v4
    s_add_u32 s54, s59, 0
    s_add_u32 m0, s58, 0
    s_nop 0
    buffer_load_dwordx4 v3, s[8:11], s54 offen lds
    s_add_u32 s54, s59, 131072
    s_add_u32 m0, s58, 1024
    s_nop 0
    buffer_load_dwordx4 v3, s[8:11], s54 offen lds
    s_add_u32 s54, s59, 262144
    s_add_u32 m0, s58, 2048
    s_nop 0
    buffer_load_dwordx4 v3, s[8:11], s54 offen lds
    s_add_u32 s54, s59, 393216
    s_add_u32 m0, s58, 3072
    s_nop 0
    buffer_load_dwordx4 v3, s[8:11], s54 offen lds
    s_add_u32 s54, s59, 524288
    s_add_u32 m0, s58, 4096
    s_nop 0
    buffer_load_dwordx4 v3, s[8:11], s54 offen lds
    s_add_u32 s54, s59, 655360
    s_add_u32 m0, s58, 5120
    s_nop 0
    buffer_load_dwordx4 v3, s[8:11], s54 offen lds
    s_add_u32 s54, s59, 786432
    s_add_u32 m0, s58, 6144
    s_nop 0
    buffer_load_dwordx4 v3, s[8:11], s54 offen lds
    s_add_u32 s54, s59, 917504
    s_add_u32 m0, s58, 7168
    s_nop 0
    buffer_load_dwordx4 v3, s[8:11], s54 offen lds
    s_add_u32 s54, s59, 1048576
    s_add_u32 m0, s58, 8192
    s_nop 0
    buffer_load_dwordx4 v3, s[8:11], s54 offen lds
    s_add_u32 s54, s59, 1179648
    s_add_u32 m0, s58, 9216
    s_nop 0
    buffer_load_dwordx4 v3, s[8:11], s54 offen lds
    s_add_u32 s54, s59, 1310720
    s_add_u32 m0, s58, 10240
    s_nop 0
    buffer_load_dwordx4 v3, s[8:11], s54 offen lds
    s_add_u32 s54, s59, 1441792
    s_add_u32 m0, s58, 11264
    s_nop 0
    buffer_load_dwordx4 v3, s[8:11], s54 offen lds
    s_add_u32 s54, s59, 1572864
    s_add_u32 m0, s58, 12288
    s_nop 0
    buffer_load_dwordx4 v3, s[8:11], s54 offen lds
    s_add_u32 s54, s59, 1703936
    s_add_u32 m0, s58, 13312
    s_nop 0
    buffer_load_dwordx4 v3, s[8:11], s54 offen lds
    s_add_u32 s54, s59, 1835008
    s_add_u32 m0, s58, 14336
    s_nop 0
    buffer_load_dwordx4 v3, s[8:11], s54 offen lds
    s_add_u32 s54, s59, 1966080
    s_add_u32 m0, s58, 15360
    s_nop 0
    buffer_load_dwordx4 v3, s[8:11], s54 offen lds
    s_add_u32 s54, s59, 2097152
    s_add_u32 m0, s58, 16384
    s_nop 0
    buffer_load_dwordx4 v3, s[8:11], s54 offen lds
    s_add_u32 s54, s59, 2228224
    s_add_u32 m0, s58, 17408
    s_nop 0
    buffer_load_dwordx4 v3, s[8:11], s54 offen lds
    s_add_u32 s54, s59, 2359296
    s_add_u32 m0, s58, 18432
    s_nop 0
    buffer_load_dwordx4 v3, s[8:11], s54 offen lds
    s_add_u32 s54, s59, 2490368
    s_add_u32 m0, s58, 19456
    s_nop 0
    buffer_load_dwordx4 v3, s[8:11], s54 offen lds
    s_waitcnt vmcnt(16)
    ds_read_b64_tr_b16 a[0:1], v4 offset:0
    ds_read_b64_tr_b16 a[2:3], v4 offset:512
    ds_read_b64_tr_b16 a[4:5], v4 offset:2048
    ds_read_b64_tr_b16 a[6:7], v4 offset:2560
    ds_read_b64_tr_b16 a[8:9], v4 offset:256
    ds_read_b64_tr_b16 a[10:11], v4 offset:768
    ds_read_b64_tr_b16 a[12:13], v4 offset:2304
    ds_read_b64_tr_b16 a[14:15], v4 offset:2816
    s_waitcnt lgkmcnt(0)
    s_add_u32 s54, s59, 2621440
    s_add_u32 m0, s58, 0
    s_nop 0
    buffer_load_dwordx4 v3, s[8:11], s54 offen lds
    s_add_u32 s54, s59, 2752512
    s_add_u32 m0, s58, 1024
    s_nop 0
    buffer_load_dwordx4 v3, s[8:11], s54 offen lds
    s_add_u32 s54, s59, 2883584
    s_add_u32 m0, s58, 2048
    s_nop 0
    buffer_load_dwordx4 v3, s[8:11], s54 offen lds
    s_add_u32 s54, s59, 3014656
    s_add_u32 m0, s58, 3072
    s_nop 0
    buffer_load_dwordx4 v3, s[8:11], s54 offen lds
    s_waitcnt vmcnt(16)
    ds_read_b64_tr_b16 a[16:17], v4 offset:4096
    ds_read_b64_tr_b16 a[18:19], v4 offset:4608
    ds_read_b64_tr_b16 a[20:21], v4 offset:6144
    ds_read_b64_tr_b16 a[22:23], v4 offset:6656
    ds_read_b64_tr_b16 a[24:25], v4 offset:4352
    ds_read_b64_tr_b16 a[26:27], v4 offset:4864
    ds_read_b64_tr_b16 a[28:29], v4 offset:6400
    ds_read_b64_tr_b16 a[30:31], v4 offset:6912
    s_waitcnt lgkmcnt(0)
    s_add_u32 s54, s59, 3145728
    s_add_u32 m0, s58, 4096
    s_nop 0
    buffer_load_dwordx4 v3, s[8:11], s54 offen lds
    s_add_u32 s54, s59, 3276800
    s_add_u32 m0, s58, 5120
    s_nop 0
    buffer_load_dwordx4 v3, s[8:11], s54 offen lds
    s_add_u32 s54, s59, 3407872
    s_add_u32 m0, s58, 6144
    s_nop 0
    buffer_load_dwordx4 v3, s[8:11], s54 offen lds
    s_add_u32 s54, s59, 3538944
    s_add_u32 m0, s58, 7168
    s_nop 0
    buffer_load_dwordx4 v3, s[8:11], s54 offen lds
    s_waitcnt vmcnt(16)
    ds_read_b64_tr_b16 a[32:33], v4 offset:8192
    ds_read_b64_tr_b16 a[34:35], v4 offset:8704
    ds_read_b64_tr_b16 a[36:37], v4 offset:10240
    ds_read_b64_tr_b16 a[38:39], v4 offset:10752
    ds_read_b64_tr_b16 a[40:41], v4 offset:8448
    ds_read_b64_tr_b16 a[42:43], v4 offset:8960
    ds_read_b64_tr_b16 a[44:45], v4 offset:10496
    ds_read_b64_tr_b16 a[46:47], v4 offset:11008
    s_waitcnt lgkmcnt(0)
    s_add_u32 s54, s59, 3670016
    s_add_u32 m0, s58, 8192
    s_nop 0
    buffer_load_dwordx4 v3, s[8:11], s54 offen lds
    s_add_u32 s54, s59, 3801088
    s_add_u32 m0, s58, 9216
    s_nop 0
    buffer_load_dwordx4 v3, s[8:11], s54 offen lds
    s_add_u32 s54, s59, 3932160
    s_add_u32 m0, s58, 10240
    s_nop 0
    buffer_load_dwordx4 v3, s[8:11], s54 offen lds
    s_add_u32 s54, s59, 4063232
    s_add_u32 m0, s58, 11264
    s_nop 0
    buffer_load_dwordx4 v3, s[8:11], s54 offen lds
    s_waitcnt vmcnt(16)
    ds_read_b64_tr_b16 a[48:49], v4 offset:12288
    ds_read_b64_tr_b16 a[50:51], v4 offset:12800
    ds_read_b64_tr_b16 a[52:53], v4 offset:14336
    ds_read_b64_tr_b16 a[54:55], v4 offset:14848
    ds_read_b64_tr_b16 a[56:57], v4 offset:12544
    ds_read_b64_tr_b16 a[58:59], v4 offset:13056
    ds_read_b64_tr_b16 a[60:61], v4 offset:14592
    ds_read_b64_tr_b16 a[62:63], v4 offset:15104
    s_waitcnt lgkmcnt(0)
    s_add_u32 s54, s59, 4194304
    s_add_u32 m0, s58, 12288
    s_nop 0
    buffer_load_dwordx4 v3, s[8:11], s54 offen lds
    s_add_u32 s54, s59, 4325376
    s_add_u32 m0, s58, 13312
    s_nop 0
    buffer_load_dwordx4 v3, s[8:11], s54 offen lds
    s_add_u32 s54, s59, 4456448
    s_add_u32 m0, s58, 14336
    s_nop 0
    buffer_load_dwordx4 v3, s[8:11], s54 offen lds
    s_add_u32 s54, s59, 4587520
    s_add_u32 m0, s58, 15360
    s_nop 0
    buffer_load_dwordx4 v3, s[8:11], s54 offen lds
    s_waitcnt vmcnt(16)
    ds_read_b64_tr_b16 a[64:65], v4 offset:16384
    ds_read_b64_tr_b16 a[66:67], v4 offset:16896
    ds_read_b64_tr_b16 a[68:69], v4 offset:18432
    ds_read_b64_tr_b16 a[70:71], v4 offset:18944
    ds_read_b64_tr_b16 a[72:73], v4 offset:16640
    ds_read_b64_tr_b16 a[74:75], v4 offset:17152
    ds_read_b64_tr_b16 a[76:77], v4 offset:18688
    ds_read_b64_tr_b16 a[78:79], v4 offset:19200
    s_waitcnt lgkmcnt(0)
    s_add_u32 s54, s59, 4718592
    s_add_u32 m0, s58, 16384
    s_nop 0
    buffer_load_dwordx4 v3, s[8:11], s54 offen lds
    s_add_u32 s54, s59, 4849664
    s_add_u32 m0, s58, 17408
    s_nop 0
    buffer_load_dwordx4 v3, s[8:11], s54 offen lds
    s_add_u32 s54, s59, 4980736
    s_add_u32 m0, s58, 18432
    s_nop 0
    buffer_load_dwordx4 v3, s[8:11], s54 offen lds
    s_add_u32 s54, s59, 5111808
    s_add_u32 m0, s58, 19456
    s_nop 0
    buffer_load_dwordx4 v3, s[8:11], s54 offen lds
    s_waitcnt vmcnt(16)
    ds_read_b64_tr_b16 a[80:81], v4 offset:0
    ds_read_b64_tr_b16 a[82:83], v4 offset:512
    ds_read_b64_tr_b16 a[84:85], v4 offset:2048
    ds_read_b64_tr_b16 a[86:87], v4 offset:2560
    ds_read_b64_tr_b16 a[88:89], v4 offset:256
    ds_read_b64_tr_b16 a[90:91], v4 offset:768
    ds_read_b64_tr_b16 a[92:93], v4 offset:2304
    ds_read_b64_tr_b16 a[94:95], v4 offset:2816
    s_waitcnt lgkmcnt(0)
    s_waitcnt vmcnt(12)
    ds_read_b64_tr_b16 a[96:97], v4 offset:4096
    ds_read_b64_tr_b16 a[98:99], v4 offset:4608
    ds_read_b64_tr_b16 a[100:101], v4 offset:6144
    ds_read_b64_tr_b16 a[102:103], v4 offset:6656
    ds_read_b64_tr_b16 a[104:105], v4 offset:4352
    ds_read_b64_tr_b16 a[106:107], v4 offset:4864
    ds_read_b64_tr_b16 a[108:109], v4 offset:6400
    ds_read_b64_tr_b16 a[110:111], v4 offset:6912
    s_waitcnt lgkmcnt(0)
    s_waitcnt vmcnt(8)
    ds_read_b64_tr_b16 a[112:113], v4 offset:8192
    ds_read_b64_tr_b16 a[114:115], v4 offset:8704
    ds_read_b64_tr_b16 a[116:117], v4 offset:10240
    ds_read_b64_tr_b16 a[118:119], v4 offset:10752
    ds_read_b64_tr_b16 a[120:121], v4 offset:8448
    ds_read_b64_tr_b16 a[122:123], v4 offset:8960
    ds_read_b64_tr_b16 a[124:125], v4 offset:10496
    ds_read_b64_tr_b16 a[126:127], v4 offset:11008
    s_waitcnt lgkmcnt(0)
    s_waitcnt vmcnt(4)
    ds_read_b64_tr_b16 a[128:129], v4 offset:12288
    ds_read_b64_tr_b16 a[130:131], v4 offset:12800
    ds_read_b64_tr_b16 a[132:133], v4 offset:14336
    ds_read_b64_tr_b16 a[134:135], v4 offset:14848
    ds_read_b64_tr_b16 a[136:137], v4 offset:12544
    ds_read_b64_tr_b16 a[138:139], v4 offset:13056
    ds_read_b64_tr_b16 a[140:141], v4 offset:14592
    ds_read_b64_tr_b16 a[142:143], v4 offset:15104
    s_waitcnt lgkmcnt(0)
    s_waitcnt vmcnt(0)
    ds_read_b64_tr_b16 a[144:145], v4 offset:16384
    ds_read_b64_tr_b16 a[146:147], v4 offset:16896
    ds_read_b64_tr_b16 a[148:149], v4 offset:18432
    ds_read_b64_tr_b16 a[150:151], v4 offset:18944
    ds_read_b64_tr_b16 a[152:153], v4 offset:16640
    ds_read_b64_tr_b16 a[154:155], v4 offset:17152
    ds_read_b64_tr_b16 a[156:157], v4 offset:18688
    ds_read_b64_tr_b16 a[158:159], v4 offset:19200
    s_waitcnt lgkmcnt(0)
    v_mov_b32 v7, v2
    s_mov_b32 s60, 40960
    s_mov_b32 s52, 0
    s_lshr_b32 s62, s49, 1
    s_and_b32 s63, s49, 1
    v_min_u32 v10, 7, v1
    v_lshlrev_b32 v10, 2, v10
    s_lshl_b32 s54, s49, 10
    s_add_u32 s54, s54, 81920
    v_add_u32 v11, s54, v2
    s_lshl_b32 s54, s62, 12
    s_add_u32 s54, s54, 81920
    v_add_u32 v12, s54, v2
    v_lshlrev_b32 v13, 2, v1
    v_and_b32 v15, 7, v1
    v_lshlrev_b32 v15, 2, v15
    v_add_u32 v3, 1024, v15
    v_add_u32 v15, 65536, v15
    v_cmp_gt_u32 vcc, 8, v1
    s_nop 1
    v_cndmask_b32 v15, v3, v15, vcc
    v_and_b32 v3, 15, v1
    v_lshrrev_b32 v4, 4, v1
    v_lshlrev_b32 v4, 2, v4
    v_sub_u32 v3, v3, v4
    s_lshl_b32 s54, s62, 4
    v_add_u32 v3, s54, v3
    v_cmp_le_i32 s[66:67], 0, v3
    v_cmp_le_i32 s[68:69], 1, v3
    v_cmp_le_i32 s[70:71], 2, v3
    v_cmp_le_i32 s[72:73], 3, v3
    v_cmp_le_i32 s[74:75], 16, v3
    v_cmp_le_i32 s[76:77], 17, v3
    v_cmp_le_i32 s[78:79], 18, v3
    v_cmp_le_i32 s[80:81], 19, v3
    v_mov_b32 v14, 0xce6e6b28
    v_mov_b32 v129, 0
    v_mov_b32 v131, 0
    v_mov_b32 v133, 0
    v_mov_b32 v135, 0
    s_lshl_b32 s84, s50, 13
    s_lshl_b32 s85, s50, 12
    s_add_u32 s85, s85, 37748736
    s_lshl_b32 s86, s50, 11
    s_lshl_b32 s54, s63, 10
    s_add_u32 s86, s86, s54
    s_add_u32 s86, s86, 46137344
    s_lshl_b32 s87, s50, 13
    s_lshl_b32 s54, s63, 12
    s_add_u32 s87, s87, s54
    s_lshl_b32 s54, s62, 10
    s_add_u32 s87, s87, s54
    s_add_u32 s87, s87, 50331648
    s_lshl_b32 s88, s50, 5
    s_add_u32 s88, s88, 121634816
    s_lshl_b32 s89, s50, 4
    s_lshl_b32 s54, s49, 2
    s_add_u32 s89, s89, s54
    s_add_u32 s89, s89, 121765888
    s_lshl_b32 s64, s63, 12
    s_mov_b32 s90, 121827328
L_wf_17:
    buffer_load_dword v180, v10, s[36:39], s88 offen sc1
    s_waitcnt vmcnt(0)
    v_cmp_eq_u32 vcc, 0, v180
    s_cbranch_vccz L_wfd_18
    s_sleep 2
    s_sub_u32 s53, s53, 1
    s_cbranch_scc0 L_wf_17
    s_branch L_fail
L_wfd_18:
L_qa_loop:
    s_barrier
    s_add_u32 s54, s84, 4194304
    s_add_u32 s55, s84, 4198400
    s_add_u32 s56, s84, s64
    s_add_u32 s56, s56, 20971520
    buffer_load_dwordx4 v[64:67], v2, s[36:39], s54 offen offset:0 sc1
    buffer_load_dwordx4 v[68:71], v2, s[36:39], s54 offen offset:1024 sc1
    buffer_load_dwordx4 v[72:75], v2, s[36:39], s54 offen offset:2048 sc1
    buffer_load_dwordx4 v[76:79], v2, s[36:39], s54 offen offset:3072 sc1
    buffer_load_dwordx4 v[80:83], v2, s[36:39], s55 offen offset:0 sc1
    buffer_load_dwordx4 v[84:87], v2, s[36:39], s55 offen offset:1024 sc1
    buffer_load_dwordx4 v[88:91], v2, s[36:39], s55 offen offset:2048 sc1
    buffer_load_dwordx4 v[92:95], v2, s[36:39], s55 offen offset:3072 sc1
    buffer_load_dwordx4 v[96:99], v2, s[36:39], s56 offen offset:0 sc1
    buffer_load_dwordx4 v[100:103], v2, s[36:39], s56 offen offset:1024 sc1
    buffer_load_dwordx4 v[104:107], v2, s[36:39], s56 offen offset:2048 sc1
    buffer_load_dwordx4 v[108:111], v2, s[36:39], s56 offen offset:3072 sc1
    s_add_u32 s55, s52, 1
    s_min_u32 s55, s55, 63
    s_mul_i32 s55, s55, 40960
    s_add_u32 s55, s55, s61
    s_add_u32 s55, s55, 0
    s_add_u32 s56, s61, s60
    s_add_u32 s54, s55, 0
    s_add_u32 m0, s56, 0
    s_nop 0
    buffer_load_dwordx4 v2, s[36:39], s54 offen offset:0 lds
    buffer_load_dwordx4 v2, s[36:39], s54 offen offset:1024 lds
    buffer_load_dwordx4 v2, s[36:39], s54 offen offset:2048 lds
    buffer_load_dwordx4 v2, s[36:39], s54 offen offset:3072 lds
    s_add_u32 s54, s55, 4096
    s_add_u32 m0, s56, 4096
    s_nop 0
    buffer_load_dwordx4 v2, s[36:39], s54 offen offset:0 lds
    buffer_load_dwordx4 v2, s[36:39], s54 offen offset:1024 lds
    buffer_load_dwordx4 v2, s[36:39], s54 offen offset:2048 lds
    buffer_load_dwordx4 v2, s[36:39], s54 offen offset:3072 lds
    s_add_u32 s54, s55, 8192
    s_add_u32 m0, s56, 8192
    s_nop 0
    buffer_load_dwordx4 v2, s[36:39], s54 offen offset:0 lds
    buffer_load_dwordx4 v2, s[36:39], s54 offen offset:1024 lds
    ds_read_b128 v[16:19], v7 offset:0
    ds_read_b128 v[20:23], v7 offset:1024
    ds_read_b128 v[24:27], v7 offset:2048
    ds_read_b128 v[28:31], v7 offset:3072
    ds_read_b128 v[32:35], v7 offset:4096
    ds_read_b128 v[36:39], v7 offset:5120
    s_waitcnt lgkmcnt(4)
    v_mfma_f32_16x16x32_bf16 v[40:43], a[0:3], v[16:19], 0
    v_mfma_f32_16x16x32_bf16 v[44:47], a[0:3], v[20:23], 0
    v_mfma_f32_16x16x32_bf16 v[48:51], a[8:11], v[16:19], 0
    v_mfma_f32_16x16x32_bf16 v[52:55], a[8:11], v[20:23], 0
    ds_read_b128 v[16:19], v7 offset:6144
    ds_read_b128 v[20:23], v7 offset:7168
    s_waitcnt lgkmcnt(4)
    v_mfma_f32_16x16x32_bf16 v[40:43], a[4:7], v[24:27], v[40:43]
    v_mfma_f32_16x16x32_bf16 v[44:47], a[4:7], v[28:31], v[44:47]
    v_mfma_f32_16x16x32_bf16 v[48:51], a[12:15], v[24:27], v[48:51]
    v_mfma_f32_16x16x32_bf16 v[52:55], a[12:15], v[28:31], v[52:55]
    ds_read_b128 v[24:27], v7 offset:8192
    ds_read_b128 v[28:31], v7 offset:9216
    s_waitcnt lgkmcnt(4)
    v_mfma_f32_16x16x32_bf16 v[40:43], a[16:19], v[32:35], v[40:43]
    v_mfma_f32_16x16x32_bf16 v[44:47], a[16:19], v[36:39], v[44:47]
    v_mfma_f32_16x16x32_bf16 v[48:51], a[24:27], v[32:35], v[48:51]
    v_mfma_f32_16x16x32_bf16 v[52:55], a[24:27], v[36:39], v[52:55]
    ds_read_b128 v[32:35], v7 offset:10240
    ds_read_b128 v[36:39], v7 offset:11264
    s_waitcnt lgkmcnt(4)
    v_mfma_f32_16x16x32_bf16 v[40:43], a[20:23], v[16:19], v[40:43]
    v_mfma_f32_16x16x32_bf16 v[44:47], a[20:23], v[20:23], v[44:47]
    v_mfma_f32_16x16x32_bf16 v[48:51], a[28:31], v[16:19], v[48:51]
    v_mfma_f32_16x16x32_bf16 v[52:55], a[28:31], v[20:23], v[52:55]
    ds_read_b128 v[16:19], v7 offset:12288
    ds_read_b128 v[20:23], v7 offset:13312
    s_waitcnt lgkmcnt(4)
    v_mfma_f32_16x16x32_bf16 v[40:43], a[32:35], v[24:27], v[40:43]
    v_mfma_f32_16x16x32_bf16 v[44:47], a[32:35], v[28:31], v[44:47]
    v_mfma_f32_16x16x32_bf16 v[48:51], a[40:43], v[24:27], v[48:51]
    v_mfma_f32_16x16x32_bf16 v[52:55], a[40:43], v[28:31], v[52:55]
    ds_read_b128 v[24:27], v7 offset:14336
    ds_read_b128 v[28:31], v7 offset:15360
    s_waitcnt lgkmcnt(4)
    v_mfma_f32_16x16x32_bf16 v[40:43], a[36:39], v[32:35], v[40:43]
    v_mfma_f32_16x16x32_bf16 v[44:47], a[36:39], v[36:39], v[44:47]
    v_mfma_f32_16x16x32_bf16 v[48:51], a[44:47], v[32:35], v[48:51]
    v_mfma_f32_16x16x32_bf16 v[52:55], a[44:47], v[36:39], v[52:55]
    ds_read_b128 v[32:35], v7 offset:16384
    ds_read_b128 v[36:39], v7 offset:17408
    s_waitcnt lgkmcnt(4)
    v_mfma_f32_16x16x32_bf16 v[40:43], a[48:51], v[16:19], v[40:43]
    v_mfma_f32_16x16x32_bf16 v[44:47], a[48:51], v[20:23], v[44:47]
    v_mfma_f32_16x16x32_bf16 v[48:51], a[56:59], v[16:19], v[48:51]
    v_mfma_f32_16x16x32_bf16 v[52:55], a[56:59], v[20:23], v[52:55]
    ds_read_b128 v[16:19], v7 offset:18432
    ds_read_b128 v[20:23], v7 offset:19456
    s_waitcnt lgkmcnt(4)
    v_mfma_f32_16x16x32_bf16 v[40:43], a[52:55], v[24:27], v[40:43]
    v_mfma_f32_16x16x32_bf16 v[44:47], a[52:55], v[28:31], v[44:47]
    v_mfma_f32_16x16x32_bf16 v[48:51], a[60:63], v[24:27], v[48:51]
    v_mfma_f32_16x16x32_bf16 v[52:55], a[60:63], v[28:31], v[52:55]
    s_waitcnt vmcnt(22)
    s_mov_b64 exec, 1
    buffer_store_dword v9, v8, s[36:39], s90 offen sc1
    s_mov_b64 exec, -1
    ds_read_b128 v[24:27], v7 offset:20480
    ds_read_b128 v[28:31], v7 offset:21504
    s_waitcnt lgkmcnt(4)
    v_mfma_f32_16x16x32_bf16 v[40:43], a[64:67], v[32:35], v[40:43]
    v_mfma_f32_16x16x32_bf16 v[44:47], a[64:67], v[36:39], v[44:47]
    v_mfma_f32_16x16x32_bf16 v[48:51], a[72:75], v[32:35], v[48:51]
    v_mfma_f32_16x16x32_bf16 v[52:55], a[72:75], v[36:39], v[52:55]
    ds_read_b128 v[32:35], v7 offset:22528
    ds_read_b128 v[36:39], v7 offset:23552
    s_waitcnt lgkmcnt(4)
    v_mfma_f32_16x16x32_bf16 v[40:43], a[68:71], v[16:19], v[40:43]
    v_mfma_f32_16x16x32_bf16 v[44:47], a[68:71], v[20:23], v[44:47]
    v_mfma_f32_16x16x32_bf16 v[48:51], a[76:79], v[16:19], v[48:51]
    v_mfma_f32_16x16x32_bf16 v[52:55], a[76:79], v[20:23], v[52:55]
    ds_read_b128 v[16:19], v7 offset:24576
    ds_read_b128 v[20:23], v7 offset:25600
    s_waitcnt lgkmcnt(4)
    v_mfma_f32_16x16x32_bf16 v[40:43], a[80:83], v[24:27], v[40:43]
    v_mfma_f32_16x16x32_bf16 v[44:47], a[80:83], v[28:31], v[44:47]
    v_mfma_f32_16x16x32_bf16 v[48:51], a[88:91], v[24:27], v[48:51]
    v_mfma_f32_16x16x32_bf16 v[52:55], a[88:91], v[28:31], v[52:55]
    ds_read_b128 v[24:27], v7 offset:26624
    ds_read_b128 v[28:31], v7 offset:27648
    s_waitcnt lgkmcnt(4)
    v_mfma_f32_16x16x32_bf16 v[40:43], a[84:87], v[32:35], v[40:43]
    v_mfma_f32_16x16x32_bf16 v[44:47], a[84:87], v[36:39], v[44:47]
    v_mfma_f32_16x16x32_bf16 v[48:51], a[92:95], v[32:35], v[48:51]
    v_mfma_f32_16x16x32_bf16 v[52:55], a[92:95], v[36:39], v[52:55]
    ds_read_b128 v[32:35], v7 offset:28672
    ds_read_b128 v[36:39], v7 offset:29696
    s_waitcnt lgkmcnt(4)
    v_mfma_f32_16x16x32_bf16 v[40:43], a[96:99], v[16:19], v[40:43]
    v_mfma_f32_16x16x32_bf16 v[44:47], a[96:99], v[20:23], v[44:47]
    v_mfma_f32_16x16x32_bf16 v[48:51], a[104:107], v[16:19], v[48:51]
    v_mfma_f32_16x16x32_bf16 v[52:55], a[104:107], v[20:23], v[52:55]
    buffer_load_dword v184, v15, s[36:39], s88 offen sc1
    ds_read_b128 v[16:19], v7 offset:30720
    ds_read_b128 v[20:23], v7 offset:31744
    s_waitcnt lgkmcnt(4)
    v_mfma_f32_16x16x32_bf16 v[40:43], a[100:103], v[24:27], v[40:43]
    v_mfma_f32_16x16x32_bf16 v[44:47], a[100:103], v[28:31], v[44:47]
    v_mfma_f32_16x16x32_bf16 v[48:51], a[108:111], v[24:27], v[48:51]
    v_mfma_f32_16x16x32_bf16 v[52:55], a[108:111], v[28:31], v[52:55]
    ds_read_b128 v[24:27], v7 offset:32768
    ds_read_b128 v[28:31], v7 offset:33792
    s_waitcnt lgkmcnt(4)
    v_mfma_f32_16x16x32_bf16 v[40:43], a[112:115], v[32:35], v[40:43]
    v_mfma_f32_16x16x32_bf16 v[44:47], a[112:115], v[36:39], v[44:47]
    v_mfma_f32_16x16x32_bf16 v[48:51], a[120:123], v[32:35], v[48:51]
    v_mfma_f32_16x16x32_bf16 v[52:55], a[120:123], v[36:39], v[52:55]
    ds_read_b128 v[32:35], v7 offset:34816
    ds_read_b128 v[36:39], v7 offset:35840
    s_waitcnt lgkmcnt(4)
    v_mfma_f32_16x16x32_bf16 v[40:43], a[116:119], v[16:19], v[40:43]
    v_mfma_f32_16x16x32_bf16 v[44:47], a[116:119], v[20:23], v[44:47]
    v_mfma_f32_16x16x32_bf16 v[48:51], a[124:127], v[16:19], v[48:51]
    v_mfma_f32_16x16x32_bf16 v[52:55], a[124:127], v[20:23], v[52:55]
    ds_read_b128 v[16:19], v7 offset:36864
    ds_read_b128 v[20:23], v7 offset:37888
    s_waitcnt lgkmcnt(4)
    v_mfma_f32_16x16x32_bf16 v[40:43], a[128:131], v[24:27], v[40:43]
    v_mfma_f32_16x16x32_bf16 v[44:47], a[128:131], v[28:31], v[44:47]
    v_mfma_f32_16x16x32_bf16 v[48:51], a[136:139], v[24:27], v[48:51]
    v_mfma_f32_16x16x32_bf16 v[52:55], a[136:139], v[28:31], v[52:55]
    ds_read_b128 v[24:27], v7 offset:38912
    ds_read_b128 v[28:31], v7 offset:39936
    s_waitcnt lgkmcnt(4)
    v_mfma_f32_16x16x32_bf16 v[40:43], a[132:135], v[32:35], v[40:43]
    v_mfma_f32_16x16x32_bf16 v[44:47], a[132:135], v[36:39], v[44:47]
    v_mfma_f32_16x16x32_bf16 v[48:51], a[140:143], v[32:35], v[48:51]
    v_mfma_f32_16x16x32_bf16 v[52:55], a[140:143], v[36:39], v[52:55]
    s_waitcnt lgkmcnt(2)
    v_mfma_f32_16x16x32_bf16 v[40:43], a[144:147], v[16:19], v[40:43]
    v_mfma_f32_16x16x32_bf16 v[44:47], a[144:147], v[20:23], v[44:47]
    v_mfma_f32_16x16x32_bf16 v[48:51], a[152:155], v[16:19], v[48:51]
    v_mfma_f32_16x16x32_bf16 v[52:55], a[152:155], v[20:23], v[52:55]
    s_waitcnt lgkmcnt(0)
    v_mfma_f32_16x16x32_bf16 v[40:43], a[148:151], v[24:27], v[40:43]
    v_mfma_f32_16x16x32_bf16 v[44:47], a[148:151], v[28:31], v[44:47]
    v_mfma_f32_16x16x32_bf16 v[48:51], a[156:159], v[24:27], v[48:51]
    v_mfma_f32_16x16x32_bf16 v[52:55], a[156:159], v[28:31], v[52:55]
    s_xor_b32 s60, s60, 40960
    v_xor_b32 v7, 0xa000, v7
    s_nop 6
    v_cvt_pk_bf16_f32 v56, v40, v48
    v_cvt_pk_bf16_f32 v57, v41, v49
    v_cvt_pk_bf16_f32 v58, v42, v50
    v_cvt_pk_bf16_f32 v59, v43, v51
    ds_write_b128 v11, v[56:59] offset:0
    v_cvt_pk_bf16_f32 v60, v44, v52
    v_cvt_pk_bf16_f32 v61, v45, v53
    v_cvt_pk_bf16_f32 v62, v46, v54
    v_cvt_pk_bf16_f32 v63, v47, v55
    ds_write_b128 v11, v[60:63] offset:4096
    s_waitcnt lgkmcnt(0)
    s_barrier
    ds_read_b128 v[136:139], v12 offset:0
    ds_read_b128 v[140:143], v12 offset:1024
    ds_read_b128 v[144:147], v12 offset:2048
    ds_read_b128 v[148:151], v12 offset:3072
    s_waitcnt vmcnt(0) lgkmcnt(0)
    v_mfma_f32_16x16x32_bf16 v[152:155], v[64:67], v[136:139], 0
    v_mfma_f32_16x16x32_bf16 v[156:159], v[80:83], v[136:139], 0
    v_mfma_f32_16x16x32_bf16 v[152:155], v[68:71], v[140:143], v[152:155]
    v_mfma_f32_16x16x32_bf16 v[156:159], v[84:87], v[140:143], v[156:159]
    v_mfma_f32_16x16x32_bf16 v[152:155], v[72:75], v[144:147], v[152:155]
    v_mfma_f32_16x16x32_bf16 v[156:159], v[88:91], v[144:147], v[156:159]
    v_mfma_f32_16x16x32_bf16 v[152:155], v[76:79], v[148:151], v[152:155]
    v_mfma_f32_16x16x32_bf16 v[156:159], v[92:95], v[148:151], v[156:159]
    v_cmp_eq_u32 vcc, 0, v184
    s_cbranch_vccz L_qa_go
L_wf_19:
    buffer_load_dword v180, v15, s[36:39], s88 offen sc1
    s_waitcnt vmcnt(0)
    v_cmp_eq_u32 vcc, 0, v180
    s_cbranch_vccz L_wfd_20
    s_sleep 2
    s_sub_u32 s53, s53, 1
    s_cbranch_scc0 L_wf_19
    s_branch L_fail
L_wfd_20:
L_qa_go:
    s_nop 4
    buffer_load_dwordx4 v[112:115], v2, s[36:39], s85 offen offset:0 sc1
    buffer_load_dwordx4 v[116:119], v2, s[36:39], s85 offen offset:1024 sc1
    buffer_load_dwordx4 v[120:123], v2, s[36:39], s85 offen offset:2048 sc1
    buffer_load_dwordx4 v[124:127], v2, s[36:39], s85 offen offset:3072 sc1
    buffer_load_dword v128, v13, s[36:39], s86 offen offset:0 sc1
    buffer_load_dword v130, v13, s[36:39], s86 offen offset:256 sc1
    buffer_load_dword v132, v13, s[36:39], s86 offen offset:512 sc1
    buffer_load_dword v134, v13, s[36:39], s86 offen offset:768 sc1
    v_cvt_pk_bf16_f32 v180, v152, v153
    v_lshlrev_b32 v152, 16, v180
    v_and_b32 v153, 0xffff0000, v180
    v_mul_f32 v152, 0x3db504f3, v152
    v_mul_f32 v153, 0x3db504f3, v153
    v_cvt_pk_bf16_f32 v180, v152, v153
    v_lshlrev_b32 v152, 16, v180
    v_and_b32 v153, 0xffff0000, v180
    v_cvt_pk_bf16_f32 v180, v154, v155
    v_lshlrev_b32 v154, 16, v180
    v_and_b32 v155, 0xffff0000, v180
    v_mul_f32 v154, 0x3db504f3, v154
    v_mul_f32 v155, 0x3db504f3, v155
    v_cvt_pk_bf16_f32 v180, v154, v155
    v_lshlrev_b32 v154, 16, v180
    v_and_b32 v155, 0xffff0000, v180
    v_cvt_pk_bf16_f32 v180, v156, v157
    v_lshlrev_b32 v156, 16, v180
    v_and_b32 v157, 0xffff0000, v180
    v_mul_f32 v156, 0x3db504f3, v156
    v_mul_f32 v157, 0x3db504f3, v157
    v_cvt_pk_bf16_f32 v180, v156, v157
    v_lshlrev_b32 v156, 16, v180
    v_and_b32 v157, 0xffff0000, v180
    v_cvt_pk_bf16_f32 v180, v158, v159
    v_lshlrev_b32 v158, 16, v180
    v_and_b32 v159, 0xffff0000, v180
    v_mul_f32 v158, 0x3db504f3, v158
    v_mul_f32 v159, 0x3db504f3, v159
    v_cvt_pk_bf16_f32 v180, v158, v159
    v_lshlrev_b32 v158, 16, v180
    v_and_b32 v159, 0xffff0000, v180
    v_cndmask_b32 v152, v14, v152, s[66:67]
    v_cndmask_b32 v153, v14, v153, s[68:69]
    v_cndmask_b32 v154, v14, v154, s[70:71]
    v_cndmask_b32 v155, v14, v155, s[72:73]
    v_cndmask_b32 v156, v14, v156, s[74:75]
    v_cndmask_b32 v157, v14, v157, s[76:77]
    v_cndmask_b32 v158, v14, v158, s[78:79]
    v_cndmask_b32 v159, v14, v159, s[80:81]
    v_max3_f32 v181, v152, v153, v154
    v_max3_f32 v181, v181, v155, v156
    v_max3_f32 v181, v181, v157, v158
    v_max_f32 v181, v181, v159
    s_waitcnt vmcnt(7)
    v_mfma_f32_16x16x32_bf16 v[160:163], v[112:115], v[136:139], 0
    s_waitcnt vmcnt(6)
    v_mfma_f32_16x16x32_bf16 v[160:163], v[116:119], v[140:143], v[160:163]
    s_waitcnt vmcnt(5)
    v_mfma_f32_16x16x32_bf16 v[160:163], v[120:123], v[144:147], v[160:163]
    s_waitcnt vmcnt(4)
    v_mfma_f32_16x16x32_bf16 v[160:163], v[124:127], v[148:151], v[160:163]
    s_nop 7
    v_cvt_pk_bf16_f32 v180, v160, v161
    v_lshlrev_b32 v160, 16, v180
    v_and_b32 v161, 0xffff0000, v180
    v_mul_f32 v160, 0x3db504f3, v160
    v_mul_f32 v161, 0x3db504f3, v161
    v_cvt_pk_bf16_f32 v180, v160, v161
    v_lshlrev_b32 v160, 16, v180
    v_and_b32 v161, 0xffff0000, v180
    v_max3_f32 v181, v181, v160, v161
    v_mov_b32 v182, v181
    s_nop 1
    v_permlane32_swap_b32 v181, v182
    s_nop 0
    v_max_f32 v181, v181, v182
    v_mov_b32 v182, v181
    s_nop 1
    v_permlane16_swap_b32 v181, v182
    s_nop 0
    v_max_f32 v181, v181, v182
    v_sub_f32 v152, v152, v181
    v_sub_f32 v153, v153, v181
    v_sub_f32 v154, v154, v181
    v_sub_f32 v155, v155, v181
    v_sub_f32 v156, v156, v181
    v_sub_f32 v157, v157, v181
    v_sub_f32 v158, v158, v181
    v_sub_f32 v159, v159, v181
    v_sub_f32 v160, v160, v181
    v_sub_f32 v161, v161, v181
    v_mul_f32 v152, 0x3fb8aa3b, v152
    v_mul_f32 v153, 0x3fb8aa3b, v153
    v_mul_f32 v154, 0x3fb8aa3b, v154
    v_mul_f32 v155, 0x3fb8aa3b, v155
    v_mul_f32 v156, 0x3fb8aa3b, v156
    v_mul_f32 v157, 0x3fb8aa3b, v157
    v_mul_f32 v158, 0x3fb8aa3b, v158
    v_mul_f32 v159, 0x3fb8aa3b, v159
    v_mul_f32 v160, 0x3fb8aa3b, v160
    v_mul_f32 v161, 0x3fb8aa3b, v161
    v_exp_f32 v152, v152
    v_exp_f32 v153, v153
    v_exp_f32 v154, v154
    v_exp_f32 v155, v155
    v_exp_f32 v156, v156
    v_exp_f32 v157, v157
    v_exp_f32 v158, v158
    v_exp_f32 v159, v159
    v_exp_f32 v160, v160
    v_exp_f32 v161, v161
    v_add_f32 v183, v152, v153
    v_add_f32 v183, v183, v154
    v_add_f32 v183, v183, v155
    v_add_f32 v183, v183, v156
    v_add_f32 v183, v183, v157
    v_add_f32 v183, v183, v158
    v_add_f32 v183, v183, v159
    v_add_f32 v183, v183, v160
    v_add_f32 v183, v183, v161
    v_mov_b32 v182, v183
    s_nop 1
    v_permlane32_swap_b32 v183, v182
    s_nop 0
    v_add_f32 v183, v183, v182
    v_mov_b32 v182, v183
    s_nop 1
    v_permlane16_swap_b32 v183, v182
    s_nop 0
    v_add_f32 v183, v183, v182
    v_rcp_f32 v183, v183
    s_nop 0
    v_mul_f32 v152, v152, v183
    v_mul_f32 v153, v153, v183
    v_mul_f32 v154, v154, v183
    v_mul_f32 v155, v155, v183
    v_mul_f32 v156, v156, v183
    v_mul_f32 v157, v157, v183
    v_mul_f32 v158, v158, v183
    v_mul_f32 v159, v159, v183
    v_mul_f32 v160, v160, v183
    v_mul_f32 v161, v161, v183
    v_cvt_pk_bf16_f32 v56, v152, v153
    v_cvt_pk_bf16_f32 v57, v154, v155
    v_cvt_pk_bf16_f32 v58, v156, v157
    v_cvt_pk_bf16_f32 v59, v158, v159
    v_cvt_pk_bf16_f32 v60, v160, v161
    v_mov_b32 v61, 0
    s_waitcnt vmcnt(0)
    v_mfma_f32_16x16x32_bf16 v[164:167], v[96:99], v[56:59], 0
    v_mfma_f32_16x16x32_bf16 v[168:171], v[100:103], v[56:59], 0
    v_mfma_f32_16x16x32_bf16 v[172:175], v[104:107], v[56:59], 0
    v_mfma_f32_16x16x32_bf16 v[176:179], v[108:111], v[56:59], 0
    v_mfma_f32_16x16x16_bf16 v[164:167], v[128:129], v[60:61], v[164:167]
    v_mfma_f32_16x16x16_bf16 v[168:171], v[130:131], v[60:61], v[168:171]
    v_mfma_f32_16x16x16_bf16 v[172:175], v[132:133], v[60:61], v[172:175]
    v_mfma_f32_16x16x16_bf16 v[176:179], v[134:135], v[60:61], v[176:179]
    s_nop 7
    v_cvt_pk_bf16_f32 v152, v164, v165
    v_cvt_pk_bf16_f32 v153, v166, v167
    v_cvt_pk_bf16_f32 v154, v168, v169
    v_cvt_pk_bf16_f32 v155, v170, v171
    buffer_store_dwordx4 v[152:155], v2, s[36:39], s87 offen offset:0 sc1
    v_cvt_pk_bf16_f32 v156, v172, v173
    v_cvt_pk_bf16_f32 v157, v174, v175
    v_cvt_pk_bf16_f32 v158, v176, v177
    v_cvt_pk_bf16_f32 v159, v178, v179
    buffer_store_dwordx4 v[156:159], v2, s[36:39], s87 offen offset:2048 sc1
    s_add_u32 s84, s84, 262144
    s_add_u32 s85, s85, 131072
    s_add_u32 s86, s86, 65536
    s_add_u32 s87, s87, 262144
    s_add_u32 s88, s88, 1024
    s_mov_b32 s90, s89
    s_add_u32 s89, s89, 512
    s_add_u32 s52, s52, 1
    s_cmp_lt_u32 s52, 63
    s_cbranch_scc1 L_qa_loop
    v_add_u32 v15, 65536, v10
    s_cmp_eq_u32 s52, 63
    s_cbranch_scc1 L_qa_loop
    s_waitcnt vmcnt(0)
    s_mov_b64 exec, 1
    buffer_store_dword v9, v8, s[36:39], s90 offen sc1
    s_mov_b64 exec, -1
    s_endpgm
L_wo:
    v_and_b32 v1, 63, v0
    v_lshlrev_b32 v2, 4, v1
    v_mov_b32 v8, 0
    v_mov_b32 v9, 1
    s_mov_b32 s55, 121634816
L_wf_21:
    buffer_load_dword v10, v8, s[36:39], s55 offen sc1
    s_waitcnt vmcnt(0)
    v_cmp_eq_u32 vcc, 0, v10
    s_cbranch_vccz L_wfd_22
    s_sleep 2
    s_sub_u32 s53, s53, 1
    s_cbranch_scc0 L_wf_21
    s_branch L_fail
L_wfd_22:
    s_cmp_ge_u32 s50, 20
    s_cselect_b32 s52, 1, 0
    s_cselect_b32 s54, 20, 0
    s_sub_u32 s50, s50, s54
    s_mul_i32 s66, s50, 13
    s_lshr_b32 s66, s66, 6
    s_mul_i32 s54, s66, 5
    s_sub_u32 s67, s50, s54
    s_lshl_b32 s54, s67, 2
    s_add_u32 s61, s54, s49
    s_mul_i32 s59, s66, 1310720
    s_lshl_b32 s54, s61, 6
    s_add_u32 s59, s59, s54
    v_lshrrev_b32 v5, 5, v1
    v_mul_u32_u24 v3, 16, v5
    v_bfe_u32 v5, v1, 3, 1
    v_mad_u32_u24 v3, v5, 4, v3
    v_bfe_u32 v5, v1, 2, 1
    v_mad_u32_u24 v3, v5, 2, v3
    v_bfe_u32 v5, v1, 1, 1
    v_mad_u32_u24 v3, v5, 1, v3
    v_mov_b32 v6, 1280
    v_mul_lo_u32 v3, v3, v6
    v_bfe_u32 v5, v1, 4, 1
    v_lshl_add_u32 v3, v5, 5, v3
    v_and_b32 v5, 1, v1
    v_lshl_add_u32 v3, v5, 4, v3
    s_mul_i32 s58, s49, 32768
    s_add_u32 s58, s58, 0
    v_lshrrev_b32 v5, 5, v1
    v_lshlrev_b32 v4, 10, v5
    v_and_b32 v5, 31, v1
    v_lshl_add_u32 v4, v5, 3, v4
    v_add_u32 v4, s58, v4
    s_add_u32 s54, s59, 0
    s_add_u32 m0, s58, 0
    s_nop 0
    buffer_load_dwordx4 v3, s[20:23], s54 offen lds
    s_add_u32 s54, s59, 10240
    s_add_u32 m0, s58, 1024
    s_nop 0
    buffer_load_dwordx4 v3, s[20:23], s54 offen lds
    s_add_u32 s54, s59, 40960
    s_add_u32 m0, s58, 2048
    s_nop 0
    buffer_load_dwordx4 v3, s[20:23], s54 offen lds
    s_add_u32 s54, s59, 51200
    s_add_u32 m0, s58, 3072
    s_nop 0
    buffer_load_dwordx4 v3, s[20:23], s54 offen lds
    s_add_u32 s54, s59, 81920
    s_add_u32 m0, s58, 4096
    s_nop 0
    buffer_load_dwordx4 v3, s[20:23], s54 offen lds
    s_add_u32 s54, s59, 92160
    s_add_u32 m0, s58, 5120
    s_nop 0
    buffer_load_dwordx4 v3, s[20:23], s54 offen lds
    s_add_u32 s54, s59, 122880
    s_add_u32 m0, s58, 6144
    s_nop 0
    buffer_load_dwordx4 v3, s[20:23], s54 offen lds
    s_add_u32 s54, s59, 133120
    s_add_u32 m0, s58, 7168
    s_nop 0
    buffer_load_dwordx4 v3, s[20:23], s54 offen lds
    s_add_u32 s54, s59, 163840
    s_add_u32 m0, s58, 8192
    s_nop 0
    buffer_load_dwordx4 v3, s[20:23], s54 offen lds
    s_add_u32 s54, s59, 174080
    s_add_u32 m0, s58, 9216
    s_nop 0
    buffer_load_dwordx4 v3, s[20:23], s54 offen lds
    s_add_u32 s54, s59, 204800
    s_add_u32 m0, s58, 10240
    s_nop 0
    buffer_load_dwordx4 v3, s[20:23], s54 offen lds
    s_add_u32 s54, s59, 215040
    s_add_u32 m0, s58, 11264
    s_nop 0
    buffer_load_dwordx4 v3, s[20:23], s54 offen lds
    s_add_u32 s54, s59, 245760
    s_add_u32 m0, s58, 12288
    s_nop 0
    buffer_load_dwordx4 v3, s[20:23], s54 offen lds
    s_add_u32 s54, s59, 256000
    s_add_u32 m0, s58, 13312
    s_nop 0
    buffer_load_dwordx4 v3, s[20:23], s54 offen lds
    s_add_u32 s54, s59, 286720
    s_add_u32 m0, s58, 14336
    s_nop 0
    buffer_load_dwordx4 v3, s[20:23], s54 offen lds
    s_add_u32 s54, s59, 296960
    s_add_u32 m0, s58, 15360
    s_nop 0
    buffer_load_dwordx4 v3, s[20:23], s54 offen lds
    s_add_u32 s54, s59, 327680
    s_add_u32 m0, s58, 16384
    s_nop 0
    buffer_load_dwordx4 v3, s[20:23], s54 offen lds
    s_add_u32 s54, s59, 337920
    s_add_u32 m0, s58, 17408
    s_nop 0
    buffer_load_dwordx4 v3, s[20:23], s54 offen lds
    s_add_u32 s54, s59, 368640
    s_add_u32 m0, s58, 18432
    s_nop 0
    buffer_load_dwordx4 v3, s[20:23], s54 offen lds
    s_add_u32 s54, s59, 378880
    s_add_u32 m0, s58, 19456
    s_nop 0
    buffer_load_dwordx4 v3, s[20:23], s54 offen lds
    s_add_u32 s54, s59, 409600
    s_add_u32 m0, s58, 20480
    s_nop 0
    buffer_load_dwordx4 v3, s[20:23], s54 offen lds
    s_add_u32 s54, s59, 419840
    s_add_u32 m0, s58, 21504
    s_nop 0
    buffer_load_dwordx4 v3, s[20:23], s54 offen lds
    s_add_u32 s54, s59, 450560
    s_add_u32 m0, s58, 22528
    s_nop 0
    buffer_load_dwordx4 v3, s[20:23], s54 offen lds
    s_add_u32 s54, s59, 460800
    s_add_u32 m0, s58, 23552
    s_nop 0
    buffer_load_dwordx4 v3, s[20:23], s54 offen lds
    s_add_u32 s54, s59, 491520
    s_add_u32 m0, s58, 24576
    s_nop 0
    buffer_load_dwordx4 v3, s[20:23], s54 offen lds
    s_add_u32 s54, s59, 501760
    s_add_u32 m0, s58, 25600
    s_nop 0
    buffer_load_dwordx4 v3, s[20:23], s54 offen lds
    s_add_u32 s54, s59, 532480
    s_add_u32 m0, s58, 26624
    s_nop 0
    buffer_load_dwordx4 v3, s[20:23], s54 offen lds
    s_add_u32 s54, s59, 542720
    s_add_u32 m0, s58, 27648
    s_nop 0
    buffer_load_dwordx4 v3, s[20:23], s54 offen lds
    s_add_u32 s54, s59, 573440
    s_add_u32 m0, s58, 28672
    s_nop 0
    buffer_load_dwordx4 v3, s[20:23], s54 offen lds
    s_add_u32 s54, s59, 583680
    s_add_u32 m0, s58, 29696
    s_nop 0
    buffer_load_dwordx4 v3, s[20:23], s54 offen lds
    s_add_u32 s54, s59, 614400
    s_add_u32 m0, s58, 30720
    s_nop 0
    buffer_load_dwordx4 v3, s[20:23], s54 offen lds
    s_add_u32 s54, s59, 624640
    s_add_u32 m0, s58, 31744
    s_nop 0
    buffer_load_dwordx4 v3, s[20:23], s54 offen lds
    s_waitcnt vmcnt(28)
    ds_read_b64_tr_b16 a[0:1], v4 offset:0
    ds_read_b64_tr_b16 a[2:3], v4 offset:512
    ds_read_b64_tr_b16 a[4:5], v4 offset:2048
    ds_read_b64_tr_b16 a[6:7], v4 offset:2560
    ds_read_b64_tr_b16 a[8:9], v4 offset:256
    ds_read_b64_tr_b16 a[10:11], v4 offset:768
    ds_read_b64_tr_b16 a[12:13], v4 offset:2304
    ds_read_b64_tr_b16 a[14:15], v4 offset:2816
    s_waitcnt lgkmcnt(0)
    s_add_u32 s54, s59, 655360
    s_add_u32 m0, s58, 0
    s_nop 0
    buffer_load_dwordx4 v3, s[20:23], s54 offen lds
    s_add_u32 s54, s59, 665600
    s_add_u32 m0, s58, 1024
    s_nop 0
    buffer_load_dwordx4 v3, s[20:23], s54 offen lds
    s_add_u32 s54, s59, 696320
    s_add_u32 m0, s58, 2048
    s_nop 0
    buffer_load_dwordx4 v3, s[20:23], s54 offen lds
    s_add_u32 s54, s59, 706560
    s_add_u32 m0, s58, 3072
    s_nop 0
    buffer_load_dwordx4 v3, s[20:23], s54 offen lds
    s_waitcnt vmcnt(28)
    ds_read_b64_tr_b16 a[16:17], v4 offset:4096
    ds_read_b64_tr_b16 a[18:19], v4 offset:4608
    ds_read_b64_tr_b16 a[20:21], v4 offset:6144
    ds_read_b64_tr_b16 a[22:23], v4 offset:6656
    ds_read_b64_tr_b16 a[24:25], v4 offset:4352
    ds_read_b64_tr_b16 a[26:27], v4 offset:4864
    ds_read_b64_tr_b16 a[28:29], v4 offset:6400
    ds_read_b64_tr_b16 a[30:31], v4 offset:6912
    s_waitcnt lgkmcnt(0)
    s_add_u32 s54, s59, 737280
    s_add_u32 m0, s58, 4096
    s_nop 0
    buffer_load_dwordx4 v3, s[20:23], s54 offen lds
    s_add_u32 s54, s59, 747520
    s_add_u32 m0, s58, 5120
    s_nop 0
    buffer_load_dwordx4 v3, s[20:23], s54 offen lds
    s_add_u32 s54, s59, 778240
    s_add_u32 m0, s58, 6144
    s_nop 0
    buffer_load_dwordx4 v3, s[20:23], s54 offen lds
    s_add_u32 s54, s59, 788480
    s_add_u32 m0, s58, 7168
    s_nop 0
    buffer_load_dwordx4 v3, s[20:23], s54 offen lds
    s_waitcnt vmcnt(28)
    ds_read_b64_tr_b16 a[32:33], v4 offset:8192
    ds_read_b64_tr_b16 a[34:35], v4 offset:8704
    ds_read_b64_tr_b16 a[36:37], v4 offset:10240
    ds_read_b64_tr_b16 a[38:39], v4 offset:10752
    ds_read_b64_tr_b16 a[40:41], v4 offset:8448
    ds_read_b64_tr_b16 a[42:43], v4 offset:8960
    ds_read_b64_tr_b16 a[44:45], v4 offset:10496
    ds_read_b64_tr_b16 a[46:47], v4 offset:11008
    s_waitcnt lgkmcnt(0)
    s_add_u32 s54, s59, 819200
    s_add_u32 m0, s58, 8192
    s_nop 0
    buffer_load_dwordx4 v3, s[20:23], s54 offen lds
    s_add_u32 s54, s59, 829440
    s_add_u32 m0, s58, 9216
    s_nop 0
    buffer_load_dwordx4 v3, s[20:23], s54 offen lds
    s_add_u32 s54, s59, 860160
    s_add_u32 m0, s58, 10240
    s_nop 0
    buffer_load_dwordx4 v3, s[20:23], s54 offen lds
    s_add_u32 s54, s59, 870400
    s_add_u32 m0, s58, 11264
    s_nop 0
    buffer_load_dwordx4 v3, s[20:23], s54 offen lds
    s_waitcnt vmcnt(28)
    ds_read_b64_tr_b16 a[48:49], v4 offset:12288
    ds_read_b64_tr_b16 a[50:51], v4 offset:12800
    ds_read_b64_tr_b16 a[52:53], v4 offset:14336
    ds_read_b64_tr_b16 a[54:55], v4 offset:14848
    ds_read_b64_tr_b16 a[56:57], v4 offset:12544
    ds_read_b64_tr_b16 a[58:59], v4 offset:13056
    ds_read_b64_tr_b16 a[60:61], v4 offset:14592
    ds_read_b64_tr_b16 a[62:63], v4 offset:15104
    s_waitcnt lgkmcnt(0)
    s_add_u32 s54, s59, 901120
    s_add_u32 m0, s58, 12288
    s_nop 0
    buffer_load_dwordx4 v3, s[20:23], s54 offen lds
    s_add_u32 s54, s59, 911360
    s_add_u32 m0, s58, 13312
    s_nop 0
    buffer_load_dwordx4 v3, s[20:23], s54 offen lds
    s_add_u32 s54, s59, 942080
    s_add_u32 m0, s58, 14336
    s_nop 0
    buffer_load_dwordx4 v3, s[20:23], s54 offen lds
    s_add_u32 s54, s59, 952320
    s_add_u32 m0, s58, 15360
    s_nop 0
    buffer_load_dwordx4 v3, s[20:23], s54 offen lds
    s_waitcnt vmcnt(28)
    ds_read_b64_tr_b16 a[64:65], v4 offset:16384
    ds_read_b64_tr_b16 a[66:67], v4 offset:16896
    ds_read_b64_tr_b16 a[68:69], v4 offset:18432
    ds_read_b64_tr_b16 a[70:71], v4 offset:18944
    ds_read_b64_tr_b16 a[72:73], v4 offset:16640
    ds_read_b64_tr_b16 a[74:75], v4 offset:17152
    ds_read_b64_tr_b16 a[76:77], v4 offset:18688
    ds_read_b64_tr_b16 a[78:79], v4 offset:19200
    s_waitcnt lgkmcnt(0)
    s_add_u32 s54, s59, 983040
    s_add_u32 m0, s58, 16384
    s_nop 0
    buffer_load_dwordx4 v3, s[20:23], s54 offen lds
    s_add_u32 s54, s59, 993280
    s_add_u32 m0, s58, 17408
    s_nop 0
    buffer_load_dwordx4 v3, s[20:23], s54 offen lds
    s_add_u32 s54, s59, 1024000
    s_add_u32 m0, s58, 18432
    s_nop 0
    buffer_load_dwordx4 v3, s[20:23], s54 offen lds
    s_add_u32 s54, s59, 1034240
    s_add_u32 m0, s58, 19456
    s_nop 0
    buffer_load_dwordx4 v3, s[20:23], s54 offen lds
    s_waitcnt vmcnt(28)
    ds_read_b64_tr_b16 a[80:81], v4 offset:20480
    ds_read_b64_tr_b16 a[82:83], v4 offset:20992
    ds_read_b64_tr_b16 a[84:85], v4 offset:22528
    ds_read_b64_tr_b16 a[86:87], v4 offset:23040
    ds_read_b64_tr_b16 a[88:89], v4 offset:20736
    ds_read_b64_tr_b16 a[90:91], v4 offset:21248
    ds_read_b64_tr_b16 a[92:93], v4 offset:22784
    ds_read_b64_tr_b16 a[94:95], v4 offset:23296
    s_waitcnt lgkmcnt(0)
    s_add_u32 s54, s59, 1064960
    s_add_u32 m0, s58, 20480
    s_nop 0
    buffer_load_dwordx4 v3, s[20:23], s54 offen lds
    s_add_u32 s54, s59, 1075200
    s_add_u32 m0, s58, 21504
    s_nop 0
    buffer_load_dwordx4 v3, s[20:23], s54 offen lds
    s_add_u32 s54, s59, 1105920
    s_add_u32 m0, s58, 22528
    s_nop 0
    buffer_load_dwordx4 v3, s[20:23], s54 offen lds
    s_add_u32 s54, s59, 1116160
    s_add_u32 m0, s58, 23552
    s_nop 0
    buffer_load_dwordx4 v3, s[20:23], s54 offen lds
    s_waitcnt vmcnt(28)
    ds_read_b64_tr_b16 a[96:97], v4 offset:24576
    ds_read_b64_tr_b16 a[98:99], v4 offset:25088
    ds_read_b64_tr_b16 a[100:101], v4 offset:26624
    ds_read_b64_tr_b16 a[102:103], v4 offset:27136
    ds_read_b64_tr_b16 a[104:105], v4 offset:24832
    ds_read_b64_tr_b16 a[106:107], v4 offset:25344
    ds_read_b64_tr_b16 a[108:109], v4 offset:26880
    ds_read_b64_tr_b16 a[110:111], v4 offset:27392
    s_waitcnt lgkmcnt(0)
    s_add_u32 s54, s59, 1146880
    s_add_u32 m0, s58, 24576
    s_nop 0
    buffer_load_dwordx4 v3, s[20:23], s54 offen lds
    s_add_u32 s54, s59, 1157120
    s_add_u32 m0, s58, 25600
    s_nop 0
    buffer_load_dwordx4 v3, s[20:23], s54 offen lds
    s_add_u32 s54, s59, 1187840
    s_add_u32 m0, s58, 26624
    s_nop 0
    buffer_load_dwordx4 v3, s[20:23], s54 offen lds
    s_add_u32 s54, s59, 1198080
    s_add_u32 m0, s58, 27648
    s_nop 0
    buffer_load_dwordx4 v3, s[20:23], s54 offen lds
    s_waitcnt vmcnt(28)
    ds_read_b64_tr_b16 a[112:113], v4 offset:28672
    ds_read_b64_tr_b16 a[114:115], v4 offset:29184
    ds_read_b64_tr_b16 a[116:117], v4 offset:30720
    ds_read_b64_tr_b16 a[118:119], v4 offset:31232
    ds_read_b64_tr_b16 a[120:121], v4 offset:28928
    ds_read_b64_tr_b16 a[122:123], v4 offset:29440
    ds_read_b64_tr_b16 a[124:125], v4 offset:30976
    ds_read_b64_tr_b16 a[126:127], v4 offset:31488
    s_waitcnt lgkmcnt(0)
    s_add_u32 s54, s59, 1228800
    s_add_u32 m0, s58, 28672
    s_nop 0
    buffer_load_dwordx4 v3, s[20:23], s54 offen lds
    s_add_u32 s54, s59, 1239040
    s_add_u32 m0, s58, 29696
    s_nop 0
    buffer_load_dwordx4 v3, s[20:23], s54 offen lds
    s_add_u32 s54, s59, 1269760
    s_add_u32 m0, s58, 30720
    s_nop 0
    buffer_load_dwordx4 v3, s[20:23], s54 offen lds
    s_add_u32 s54, s59, 1280000
    s_add_u32 m0, s58, 31744
    s_nop 0
    buffer_load_dwordx4 v3, s[20:23], s54 offen lds
    s_waitcnt vmcnt(28)
    ds_read_b64_tr_b16 a[128:129], v4 offset:0
    ds_read_b64_tr_b16 a[130:131], v4 offset:512
    ds_read_b64_tr_b16 a[132:133], v4 offset:2048
    ds_read_b64_tr_b16 a[134:135], v4 offset:2560
    ds_read_b64_tr_b16 a[136:137], v4 offset:256
    ds_read_b64_tr_b16 a[138:139], v4 offset:768
    ds_read_b64_tr_b16 a[140:141], v4 offset:2304
    ds_read_b64_tr_b16 a[142:143], v4 offset:2816
    s_waitcnt lgkmcnt(0)
    s_waitcnt vmcnt(24)
    ds_read_b64_tr_b16 a[144:145], v4 offset:4096
    ds_read_b64_tr_b16 a[146:147], v4 offset:4608
    ds_read_b64_tr_b16 a[148:149], v4 offset:6144
    ds_read_b64_tr_b16 a[150:151], v4 offset:6656
    ds_read_b64_tr_b16 a[152:153], v4 offset:4352
    ds_read_b64_tr_b16 a[154:155], v4 offset:4864
    ds_read_b64_tr_b16 a[156:157], v4 offset:6400
    ds_read_b64_tr_b16 a[158:159], v4 offset:6912
    s_waitcnt lgkmcnt(0)
    s_waitcnt vmcnt(20)
    ds_read_b64_tr_b16 a[160:161], v4 offset:8192
    ds_read_b64_tr_b16 a[162:163], v4 offset:8704
    ds_read_b64_tr_b16 a[164:165], v4 offset:10240
    ds_read_b64_tr_b16 a[166:167], v4 offset:10752
    ds_read_b64_tr_b16 a[168:169], v4 offset:8448
    ds_read_b64_tr_b16 a[170:171], v4 offset:8960
    ds_read_b64_tr_b16 a[172:173], v4 offset:10496
    ds_read_b64_tr_b16 a[174:175], v4 offset:11008
    s_waitcnt lgkmcnt(0)
    s_waitcnt vmcnt(16)
    ds_read_b64_tr_b16 a[176:177], v4 offset:12288
    ds_read_b64_tr_b16 a[178:179], v4 offset:12800
    ds_read_b64_tr_b16 a[180:181], v4 offset:14336
    ds_read_b64_tr_b16 a[182:183], v4 offset:14848
    ds_read_b64_tr_b16 a[184:185], v4 offset:12544
    ds_read_b64_tr_b16 a[186:187], v4 offset:13056
    ds_read_b64_tr_b16 a[188:189], v4 offset:14592
    ds_read_b64_tr_b16 a[190:191], v4 offset:15104
    s_waitcnt lgkmcnt(0)
    s_waitcnt vmcnt(12)
    ds_read_b64_tr_b16 a[192:193], v4 offset:16384
    ds_read_b64_tr_b16 a[194:195], v4 offset:16896
    ds_read_b64_tr_b16 a[196:197], v4 offset:18432
    ds_read_b64_tr_b16 a[198:199], v4 offset:18944
    ds_read_b64_tr_b16 a[200:201], v4 offset:16640
    ds_read_b64_tr_b16 a[202:203], v4 offset:17152
    ds_read_b64_tr_b16 a[204:205], v4 offset:18688
    ds_read_b64_tr_b16 a[206:207], v4 offset:19200
    s_waitcnt lgkmcnt(0)
    s_waitcnt vmcnt(8)
    ds_read_b64_tr_b16 a[208:209], v4 offset:20480
    ds_read_b64_tr_b16 a[210:211], v4 offset:20992
    ds_read_b64_tr_b16 a[212:213], v4 offset:22528
    ds_read_b64_tr_b16 a[214:215], v4 offset:23040
    ds_read_b64_tr_b16 a[216:217], v4 offset:20736
    ds_read_b64_tr_b16 a[218:219], v4 offset:21248
    ds_read_b64_tr_b16 a[220:221], v4 offset:22784
    ds_read_b64_tr_b16 a[222:223], v4 offset:23296
    s_waitcnt lgkmcnt(0)
    s_waitcnt vmcnt(4)
    ds_read_b64_tr_b16 a[224:225], v4 offset:24576
    ds_read_b64_tr_b16 a[226:227], v4 offset:25088
    ds_read_b64_tr_b16 a[228:229], v4 offset:26624
    ds_read_b64_tr_b16 a[230:231], v4 offset:27136
    ds_read_b64_tr_b16 a[232:233], v4 offset:24832
    ds_read_b64_tr_b16 a[234:235], v4 offset:25344
    ds_read_b64_tr_b16 a[236:237], v4 offset:26880
    ds_read_b64_tr_b16 a[238:239], v4 offset:27392
    s_waitcnt lgkmcnt(0)
    s_waitcnt vmcnt(0)
    ds_read_b64_tr_b16 a[240:241], v4 offset:28672
    ds_read_b64_tr_b16 a[242:243], v4 offset:29184
    ds_read_b64_tr_b16 a[244:245], v4 offset:30720
    ds_read_b64_tr_b16 a[246:247], v4 offset:31232
    ds_read_b64_tr_b16 a[248:249], v4 offset:28928
    ds_read_b64_tr_b16 a[250:251], v4 offset:29440
    ds_read_b64_tr_b16 a[252:253], v4 offset:30976
    ds_read_b64_tr_b16 a[254:255], v4 offset:31488
    s_waitcnt lgkmcnt(0)
    v_min_u32 v10, 31, v1
    v_lshlrev_b32 v10, 2, v10
    v_and_b32 v3, 15, v1
    v_mul_u32_u24 v11, 2560, v3
    v_lshrrev_b32 v3, 4, v1
    v_lshl_add_u32 v11, v3, 4, v11
    s_lshl_b32 s62, s49, 12
    s_lshl_b32 s68, s52, 18
    s_lshl_b32 s54, s66, 16
    s_add_u32 s68, s68, s54
    s_add_u32 s68, s68, s62
    s_add_u32 s68, s68, 50331648
    s_lshl_b32 s69, s52, 9
    s_lshl_b32 s54, s66, 7
    s_add_u32 s69, s69, s54
    s_add_u32 s69, s69, 121765888
    s_lshl_b32 s54, s52, 2
    s_add_u32 s54, s54, s66
    s_mul_i32 s70, s54, 81920
    s_lshl_b32 s54, s61, 7
    s_add_u32 s70, s70, s54
    s_add_u32 s70, s70, 67108864
    s_lshl_b32 s71, s52, 7
    s_lshl_b32 s54, s50, 2
    s_add_u32 s71, s71, s54
    s_add_u32 s71, s71, 121798656
    s_barrier
L_wo_loop:
L_wf_23:
    buffer_load_dword v12, v10, s[36:39], s69 offen sc1
    s_waitcnt vmcnt(0)
    v_cmp_eq_u32 vcc, 0, v12
    s_cbranch_vccz L_wfd_24
    s_sleep 2
    s_sub_u32 s53, s53, 1
    s_cbranch_scc0 L_wf_23
    s_branch L_fail
L_wfd_24:
    s_add_u32 s55, s68, 0
    s_add_u32 s56, s62, 0
    s_add_u32 s54, s55, 0
    s_add_u32 m0, s56, 0
    s_nop 0
    buffer_load_dwordx4 v2, s[36:39], s54 offen offset:0 sc1 lds
    buffer_load_dwordx4 v2, s[36:39], s54 offen offset:1024 sc1 lds
    buffer_load_dwordx4 v2, s[36:39], s54 offen offset:2048 sc1 lds
    buffer_load_dwordx4 v2, s[36:39], s54 offen offset:3072 sc1 lds
    s_add_u32 s55, s68, 16384
    s_add_u32 s56, s62, 16384
    s_add_u32 s54, s55, 0
    s_add_u32 m0, s56, 0
    s_nop 0
    buffer_load_dwordx4 v2, s[36:39], s54 offen offset:0 sc1 lds
    buffer_load_dwordx4 v2, s[36:39], s54 offen offset:1024 sc1 lds
    buffer_load_dwordx4 v2, s[36:39], s54 offen offset:2048 sc1 lds
    buffer_load_dwordx4 v2, s[36:39], s54 offen offset:3072 sc1 lds
    s_add_u32 s55, s68, 32768
    s_add_u32 s56, s62, 32768
    s_add_u32 s54, s55, 0
    s_add_u32 m0, s56, 0
    s_nop 0
    buffer_load_dwordx4 v2, s[36:39], s54 offen offset:0 sc1 lds
    buffer_load_dwordx4 v2, s[36:39], s54 offen offset:1024 sc1 lds
    buffer_load_dwordx4 v2, s[36:39], s54 offen offset:2048 sc1 lds
    buffer_load_dwordx4 v2, s[36:39], s54 offen offset:3072 sc1 lds
    s_add_u32 s55, s68, 49152
    s_add_u32 s56, s62, 49152
    s_add_u32 s54, s55, 0
    s_add_u32 m0, s56, 0
    s_nop 0
    buffer_load_dwordx4 v2, s[36:39], s54 offen offset:0 sc1 lds
    buffer_load_dwordx4 v2, s[36:39], s54 offen offset:1024 sc1 lds
    buffer_load_dwordx4 v2, s[36:39], s54 offen offset:2048 sc1 lds
    buffer_load_dwordx4 v2, s[36:39], s54 offen offset:3072 sc1 lds
    s_waitcnt vmcnt(12)
    s_barrier
    ds_read_b128 v[16:19], v2 offset:0
    ds_read_b128 v[20:23], v2 offset:1024
    ds_read_b128 v[24:27], v2 offset:2048
    ds_read_b128 v[28:31], v2 offset:3072
    ds_read_b128 v[32:35], v2 offset:4096
    ds_read_b128 v[36:39], v2 offset:5120
    s_waitcnt lgkmcnt(4)
    v_mfma_f32_16x16x32_bf16 v[40:43], a[0:3], v[16:19], 0
    v_mfma_f32_16x16x32_bf16 v[44:47], a[0:3], v[20:23], 0
    v_mfma_f32_16x16x32_bf16 v[48:51], a[8:11], v[16:19], 0
    v_mfma_f32_16x16x32_bf16 v[52:55], a[8:11], v[20:23], 0
    ds_read_b128 v[16:19], v2 offset:6144
    ds_read_b128 v[20:23], v2 offset:7168
    s_waitcnt lgkmcnt(4)
    v_mfma_f32_16x16x32_bf16 v[40:43], a[4:7], v[24:27], v[40:43]
    v_mfma_f32_16x16x32_bf16 v[44:47], a[4:7], v[28:31], v[44:47]
    v_mfma_f32_16x16x32_bf16 v[48:51], a[12:15], v[24:27], v[48:51]
    v_mfma_f32_16x16x32_bf16 v[52:55], a[12:15], v[28:31], v[52:55]
    ds_read_b128 v[24:27], v2 offset:8192
    ds_read_b128 v[28:31], v2 offset:9216
    s_waitcnt lgkmcnt(4)
    v_mfma_f32_16x16x32_bf16 v[40:43], a[16:19], v[32:35], v[40:43]
    v_mfma_f32_16x16x32_bf16 v[44:47], a[16:19], v[36:39], v[44:47]
    v_mfma_f32_16x16x32_bf16 v[48:51], a[24:27], v[32:35], v[48:51]
    v_mfma_f32_16x16x32_bf16 v[52:55], a[24:27], v[36:39], v[52:55]
    ds_read_b128 v[32:35], v2 offset:10240
    ds_read_b128 v[36:39], v2 offset:11264
    s_waitcnt lgkmcnt(4)
    v_mfma_f32_16x16x32_bf16 v[40:43], a[20:23], v[16:19], v[40:43]
    v_mfma_f32_16x16x32_bf16 v[44:47], a[20:23], v[20:23], v[44:47]
    v_mfma_f32_16x16x32_bf16 v[48:51], a[28:31], v[16:19], v[48:51]
    v_mfma_f32_16x16x32_bf16 v[52:55], a[28:31], v[20:23], v[52:55]
    ds_read_b128 v[16:19], v2 offset:12288
    ds_read_b128 v[20:23], v2 offset:13312
    s_waitcnt lgkmcnt(4)
    v_mfma_f32_16x16x32_bf16 v[40:43], a[32:35], v[24:27], v[40:43]
    v_mfma_f32_16x16x32_bf16 v[44:47], a[32:35], v[28:31], v[44:47]
    v_mfma_f32_16x16x32_bf16 v[48:51], a[40:43], v[24:27], v[48:51]
    v_mfma_f32_16x16x32_bf16 v[52:55], a[40:43], v[28:31], v[52:55]
    ds_read_b128 v[24:27], v2 offset:14336
    ds_read_b128 v[28:31], v2 offset:15360
    s_waitcnt lgkmcnt(4)
    v_mfma_f32_16x16x32_bf16 v[40:43], a[36:39], v[32:35], v[40:43]
    v_mfma_f32_16x16x32_bf16 v[44:47], a[36:39], v[36:39], v[44:47]
    v_mfma_f32_16x16x32_bf16 v[48:51], a[44:47], v[32:35], v[48:51]
    v_mfma_f32_16x16x32_bf16 v[52:55], a[44:47], v[36:39], v[52:55]
    s_waitcnt lgkmcnt(2)
    v_mfma_f32_16x16x32_bf16 v[40:43], a[48:51], v[16:19], v[40:43]
    v_mfma_f32_16x16x32_bf16 v[44:47], a[48:51], v[20:23], v[44:47]
    v_mfma_f32_16x16x32_bf16 v[48:51], a[56:59], v[16:19], v[48:51]
    v_mfma_f32_16x16x32_bf16 v[52:55], a[56:59], v[20:23], v[52:55]
    s_waitcnt lgkmcnt(0)
    v_mfma_f32_16x16x32_bf16 v[40:43], a[52:55], v[24:27], v[40:43]
    v_mfma_f32_16x16x32_bf16 v[44:47], a[52:55], v[28:31], v[44:47]
    v_mfma_f32_16x16x32_bf16 v[48:51], a[60:63], v[24:27], v[48:51]
    v_mfma_f32_16x16x32_bf16 v[52:55], a[60:63], v[28:31], v[52:55]
    s_waitcnt vmcnt(8)
    s_barrier
    ds_read_b128 v[16:19], v2 offset:16384
    ds_read_b128 v[20:23], v2 offset:17408
    ds_read_b128 v[24:27], v2 offset:18432
    ds_read_b128 v[28:31], v2 offset:19456
    ds_read_b128 v[32:35], v2 offset:20480
    ds_read_b128 v[36:39], v2 offset:21504
    s_waitcnt lgkmcnt(4)
    v_mfma_f32_16x16x32_bf16 v[40:43], a[64:67], v[16:19], v[40:43]
    v_mfma_f32_16x16x32_bf16 v[44:47], a[64:67], v[20:23], v[44:47]
    v_mfma_f32_16x16x32_bf16 v[48:51], a[72:75], v[16:19], v[48:51]
    v_mfma_f32_16x16x32_bf16 v[52:55], a[72:75], v[20:23], v[52:55]
    ds_read_b128 v[16:19], v2 offset:22528
    ds_read_b128 v[20:23], v2 offset:23552
    s_waitcnt lgkmcnt(4)
    v_mfma_f32_16x16x32_bf16 v[40:43], a[68:71], v[24:27], v[40:43]
    v_mfma_f32_16x16x32_bf16 v[44:47], a[68:71], v[28:31], v[44:47]
    v_mfma_f32_16x16x32_bf16 v[48:51], a[76:79], v[24:27], v[48:51]
    v_mfma_f32_16x16x32_bf16 v[52:55], a[76:79], v[28:31], v[52:55]
    ds_read_b128 v[24:27], v2 offset:24576
    ds_read_b128 v[28:31], v2 offset:25600
    s_waitcnt lgkmcnt(4)
    v_mfma_f32_16x16x32_bf16 v[40:43], a[80:83], v[32:35], v[40:43]
    v_mfma_f32_16x16x32_bf16 v[44:47], a[80:83], v[36:39], v[44:47]
    v_mfma_f32_16x16x32_bf16 v[48:51], a[88:91], v[32:35], v[48:51]
    v_mfma_f32_16x16x32_bf16 v[52:55], a[88:91], v[36:39], v[52:55]
    ds_read_b128 v[32:35], v2 offset:26624
    ds_read_b128 v[36:39], v2 offset:27648
    s_waitcnt lgkmcnt(4)
    v_mfma_f32_16x16x32_bf16 v[40:43], a[84:87], v[16:19], v[40:43]
    v_mfma_f32_16x16x32_bf16 v[44:47], a[84:87], v[20:23], v[44:47]
    v_mfma_f32_16x16x32_bf16 v[48:51], a[92:95], v[16:19], v[48:51]
    v_mfma_f32_16x16x32_bf16 v[52:55], a[92:95], v[20:23], v[52:55]
    ds_read_b128 v[16:19], v2 offset:28672
    ds_read_b128 v[20:23], v2 offset:29696
    s_waitcnt lgkmcnt(4)
    v_mfma_f32_16x16x32_bf16 v[40:43], a[96:99], v[24:27], v[40:43]
    v_mfma_f32_16x16x32_bf16 v[44:47], a[96:99], v[28:31], v[44:47]
    v_mfma_f32_16x16x32_bf16 v[48:51], a[104:107], v[24:27], v[48:51]
    v_mfma_f32_16x16x32_bf16 v[52:55], a[104:107], v[28:31], v[52:55]
    ds_read_b128 v[24:27], v2 offset:30720
    ds_read_b128 v[28:31], v2 offset:31744
    s_waitcnt lgkmcnt(4)
    v_mfma_f32_16x16x32_bf16 v[40:43], a[100:103], v[32:35], v[40:43]
    v_mfma_f32_16x16x32_bf16 v[44:47], a[100:103], v[36:39], v[44:47]
    v_mfma_f32_16x16x32_bf16 v[48:51], a[108:111], v[32:35], v[48:51]
    v_mfma_f32_16x16x32_bf16 v[52:55], a[108:111], v[36:39], v[52:55]
    s_waitcnt lgkmcnt(2)
    v_mfma_f32_16x16x32_bf16 v[40:43], a[112:115], v[16:19], v[40:43]
    v_mfma_f32_16x16x32_bf16 v[44:47], a[112:115], v[20:23], v[44:47]
    v_mfma_f32_16x16x32_bf16 v[48:51], a[120:123], v[16:19], v[48:51]
    v_mfma_f32_16x16x32_bf16 v[52:55], a[120:123], v[20:23], v[52:55]
    s_waitcnt lgkmcnt(0)
    v_mfma_f32_16x16x32_bf16 v[40:43], a[116:119], v[24:27], v[40:43]
    v_mfma_f32_16x16x32_bf16 v[44:47], a[116:119], v[28:31], v[44:47]
    v_mfma_f32_16x16x32_bf16 v[48:51], a[124:127], v[24:27], v[48:51]
    v_mfma_f32_16x16x32_bf16 v[52:55], a[124:127], v[28:31], v[52:55]
    s_waitcnt vmcnt(4)
    s_barrier
    ds_read_b128 v[16:19], v2 offset:32768
    ds_read_b128 v[20:23], v2 offset:33792
    ds_read_b128 v[24:27], v2 offset:34816
    ds_read_b128 v[28:31], v2 offset:35840
    ds_read_b128 v[32:35], v2 offset:36864
    ds_read_b128 v[36:39], v2 offset:37888
    s_waitcnt lgkmcnt(4)
    v_mfma_f32_16x16x32_bf16 v[40:43], a[128:131], v[16:19], v[40:43]
    v_mfma_f32_16x16x32_bf16 v[44:47], a[128:131], v[20:23], v[44:47]
    v_mfma_f32_16x16x32_bf16 v[48:51], a[136:139], v[16:19], v[48:51]
    v_mfma_f32_16x16x32_bf16 v[52:55], a[136:139], v[20:23], v[52:55]
    ds_read_b128 v[16:19], v2 offset:38912
    ds_read_b128 v[20:23], v2 offset:39936
    s_waitcnt lgkmcnt(4)
    v_mfma_f32_16x16x32_bf16 v[40:43], a[132:135], v[24:27], v[40:43]
    v_mfma_f32_16x16x32_bf16 v[44:47], a[132:135], v[28:31], v[44:47]
    v_mfma_f32_16x16x32_bf16 v[48:51], a[140:143], v[24:27], v[48:51]
    v_mfma_f32_16x16x32_bf16 v[52:55], a[140:143], v[28:31], v[52:55]
    ds_read_b128 v[24:27], v2 offset:40960
    ds_read_b128 v[28:31], v2 offset:41984
    s_waitcnt lgkmcnt(4)
    v_mfma_f32_16x16x32_bf16 v[40:43], a[144:147], v[32:35], v[40:43]
    v_mfma_f32_16x16x32_bf16 v[44:47], a[144:147], v[36:39], v[44:47]
    v_mfma_f32_16x16x32_bf16 v[48:51], a[152:155], v[32:35], v[48:51]
    v_mfma_f32_16x16x32_bf16 v[52:55], a[152:155], v[36:39], v[52:55]
    ds_read_b128 v[32:35], v2 offset:43008
    ds_read_b128 v[36:39], v2 offset:44032
    s_waitcnt lgkmcnt(4)
    v_mfma_f32_16x16x32_bf16 v[40:43], a[148:151], v[16:19], v[40:43]
    v_mfma_f32_16x16x32_bf16 v[44:47], a[148:151], v[20:23], v[44:47]
    v_mfma_f32_16x16x32_bf16 v[48:51], a[156:159], v[16:19], v[48:51]
    v_mfma_f32_16x16x32_bf16 v[52:55], a[156:159], v[20:23], v[52:55]
    ds_read_b128 v[16:19], v2 offset:45056
    ds_read_b128 v[20:23], v2 offset:46080
    s_waitcnt lgkmcnt(4)
    v_mfma_f32_16x16x32_bf16 v[40:43], a[160:163], v[24:27], v[40:43]
    v_mfma_f32_16x16x32_bf16 v[44:47], a[160:163], v[28:31], v[44:47]
    v_mfma_f32_16x16x32_bf16 v[48:51], a[168:171], v[24:27], v[48:51]
    v_mfma_f32_16x16x32_bf16 v[52:55], a[168:171], v[28:31], v[52:55]
    ds_read_b128 v[24:27], v2 offset:47104
    ds_read_b128 v[28:31], v2 offset:48128
    s_waitcnt lgkmcnt(4)
    v_mfma_f32_16x16x32_bf16 v[40:43], a[164:167], v[32:35], v[40:43]
    v_mfma_f32_16x16x32_bf16 v[44:47], a[164:167], v[36:39], v[44:47]
    v_mfma_f32_16x16x32_bf16 v[48:51], a[172:175], v[32:35], v[48:51]
    v_mfma_f32_16x16x32_bf16 v[52:55], a[172:175], v[36:39], v[52:55]
    s_waitcnt lgkmcnt(2)
    v_mfma_f32_16x16x32_bf16 v[40:43], a[176:179], v[16:19], v[40:43]
    v_mfma_f32_16x16x32_bf16 v[44:47], a[176:179], v[20:23], v[44:47]
    v_mfma_f32_16x16x32_bf16 v[48:51], a[184:187], v[16:19], v[48:51]
    v_mfma_f32_16x16x32_bf16 v[52:55], a[184:187], v[20:23], v[52:55]
    s_waitcnt lgkmcnt(0)
    v_mfma_f32_16x16x32_bf16 v[40:43], a[180:183], v[24:27], v[40:43]
    v_mfma_f32_16x16x32_bf16 v[44:47], a[180:183], v[28:31], v[44:47]
    v_mfma_f32_16x16x32_bf16 v[48:51], a[188:191], v[24:27], v[48:51]
    v_mfma_f32_16x16x32_bf16 v[52:55], a[188:191], v[28:31], v[52:55]
    s_waitcnt vmcnt(0)
    s_barrier
    ds_read_b128 v[16:19], v2 offset:49152
    ds_read_b128 v[20:23], v2 offset:50176
    ds_read_b128 v[24:27], v2 offset:51200
    ds_read_b128 v[28:31], v2 offset:52224
    ds_read_b128 v[32:35], v2 offset:53248
    ds_read_b128 v[36:39], v2 offset:54272
    s_waitcnt lgkmcnt(4)
    v_mfma_f32_16x16x32_bf16 v[40:43], a[192:195], v[16:19], v[40:43]
    v_mfma_f32_16x16x32_bf16 v[44:47], a[192:195], v[20:23], v[44:47]
    v_mfma_f32_16x16x32_bf16 v[48:51], a[200:203], v[16:19], v[48:51]
    v_mfma_f32_16x16x32_bf16 v[52:55], a[200:203], v[20:23], v[52:55]
    ds_read_b128 v[16:19], v2 offset:55296
    ds_read_b128 v[20:23], v2 offset:56320
    s_waitcnt lgkmcnt(4)
    v_mfma_f32_16x16x32_bf16 v[40:43], a[196:199], v[24:27], v[40:43]
    v_mfma_f32_16x16x32_bf16 v[44:47], a[196:199], v[28:31], v[44:47]
    v_mfma_f32_16x16x32_bf16 v[48:51], a[204:207], v[24:27], v[48:51]
    v_mfma_f32_16x16x32_bf16 v[52:55], a[204:207], v[28:31], v[52:55]
    ds_read_b128 v[24:27], v2 offset:57344
    ds_read_b128 v[28:31], v2 offset:58368
    s_waitcnt lgkmcnt(4)
    v_mfma_f32_16x16x32_bf16 v[40:43], a[208:211], v[32:35], v[40:43]
    v_mfma_f32_16x16x32_bf16 v[44:47], a[208:211], v[36:39], v[44:47]
    v_mfma_f32_16x16x32_bf16 v[48:51], a[216:219], v[32:35], v[48:51]
    v_mfma_f32_16x16x32_bf16 v[52:55], a[216:219], v[36:39], v[52:55]
    ds_read_b128 v[32:35], v2 offset:59392
    ds_read_b128 v[36:39], v2 offset:60416
    s_waitcnt lgkmcnt(4)
    v_mfma_f32_16x16x32_bf16 v[40:43], a[212:215], v[16:19], v[40:43]
    v_mfma_f32_16x16x32_bf16 v[44:47], a[212:215], v[20:23], v[44:47]
    v_mfma_f32_16x16x32_bf16 v[48:51], a[220:223], v[16:19], v[48:51]
    v_mfma_f32_16x16x32_bf16 v[52:55], a[220:223], v[20:23], v[52:55]
    ds_read_b128 v[16:19], v2 offset:61440
    ds_read_b128 v[20:23], v2 offset:62464
    s_waitcnt lgkmcnt(4)
    v_mfma_f32_16x16x32_bf16 v[40:43], a[224:227], v[24:27], v[40:43]
    v_mfma_f32_16x16x32_bf16 v[44:47], a[224:227], v[28:31], v[44:47]
    v_mfma_f32_16x16x32_bf16 v[48:51], a[232:235], v[24:27], v[48:51]
    v_mfma_f32_16x16x32_bf16 v[52:55], a[232:235], v[28:31], v[52:55]
    ds_read_b128 v[24:27], v2 offset:63488
    ds_read_b128 v[28:31], v2 offset:64512
    s_waitcnt lgkmcnt(4)
    v_mfma_f32_16x16x32_bf16 v[40:43], a[228:231], v[32:35], v[40:43]
    v_mfma_f32_16x16x32_bf16 v[44:47], a[228:231], v[36:39], v[44:47]
    v_mfma_f32_16x16x32_bf16 v[48:51], a[236:239], v[32:35], v[48:51]
    v_mfma_f32_16x16x32_bf16 v[52:55], a[236:239], v[36:39], v[52:55]
    s_waitcnt lgkmcnt(2)
    v_mfma_f32_16x16x32_bf16 v[40:43], a[240:243], v[16:19], v[40:43]
    v_mfma_f32_16x16x32_bf16 v[44:47], a[240:243], v[20:23], v[44:47]
    v_mfma_f32_16x16x32_bf16 v[48:51], a[248:251], v[16:19], v[48:51]
    v_mfma_f32_16x16x32_bf16 v[52:55], a[248:251], v[20:23], v[52:55]
    s_waitcnt lgkmcnt(0)
    v_mfma_f32_16x16x32_bf16 v[40:43], a[244:247], v[24:27], v[40:43]
    v_mfma_f32_16x16x32_bf16 v[44:47], a[244:247], v[28:31], v[44:47]
    v_mfma_f32_16x16x32_bf16 v[48:51], a[252:255], v[24:27], v[48:51]
    v_mfma_f32_16x16x32_bf16 v[52:55], a[252:255], v[28:31], v[52:55]
    s_add_u32 s54, s70, 40960
    s_nop 6
    buffer_store_dwordx4 v[40:43], v11, s[36:39], s70 offen offset:0 sc1
    buffer_store_dwordx4 v[44:47], v11, s[36:39], s54 offen offset:0 sc1
    buffer_store_dwordx4 v[48:51], v11, s[36:39], s70 offen offset:64 sc1
    buffer_store_dwordx4 v[52:55], v11, s[36:39], s54 offen offset:64 sc1
    s_add_u32 s68, s68, 524288
    s_add_u32 s69, s69, 1024
    s_add_u32 s70, s70, 655360
    s_waitcnt vmcnt(0)
    s_barrier
    s_cmp_lg_u32 s49, 0
    s_cbranch_scc1 L_wo_nf
    s_mov_b64 exec, 1
    buffer_store_dword v9, v8, s[36:39], s71 offen sc1
    s_mov_b64 exec, -1
L_wo_nf:
    s_add_u32 s71, s71, 256
    s_add_u32 s52, s52, 2
    s_cmp_lt_u32 s52, 64
    s_cbranch_scc1 L_wo_loop
    s_endpgm
L_red:
    v_and_b32 v1, 63, v0
    v_lshlrev_b32 v2, 4, v1
    v_mov_b32 v8, 0
    v_mov_b32 v9, 1
    s_cmp_ge_u32 s50, 4
    s_cselect_b32 s52, 1, 0
    s_cselect_b32 s54, 4, 0
    s_sub_u32 s50, s50, s54
    v_min_u32 v10, 19, v1
    v_lshlrev_b32 v10, 2, v10
    s_lshl_b32 s61, s50, 2
    s_add_u32 s61, s61, s49
    v_lshlrev_b32 v11, 3, v1
    v_lshlrev_b32 v12, 2, v1
    v_lshrrev_b32 v3, 4, v1
    v_lshlrev_b32 v13, 11, v3
    v_bfe_u32 v3, v1, 2, 2
    v_lshl_add_u32 v13, v3, 8, v13
    v_and_b32 v3, 3, v1
    v_lshl_add_u32 v13, v3, 2, v13
    v_lshlrev_b32 v14, 6, v1
    s_mul_i32 s66, s61, 2560
    s_mul_i32 s54, s52, 327680
    s_add_u32 s66, s66, s54
    s_add_u32 s66, s66, 67108864
    s_mul_i32 s67, s61, 1280
    s_mul_i32 s54, s52, 40960
    s_add_u32 s67, s67, s54
    s_lshl_b32 s68, s61, 4
    s_add_u32 s68, s68, s54
    s_add_u32 s68, s68, 92274688
    s_lshl_b32 s54, s52, 7
    s_add_u32 s69, s54, 121798656
    s_lshl_b32 s70, s61, 2
    s_add_u32 s70, s70, s54
    s_add_u32 s70, s70, 121806848
L_red_loop:
    s_add_u32 s54, s67, 0
    buffer_load_dword v96, v12, s[4:7], s54 offen offset:0
    buffer_load_dword v97, v12, s[4:7], s54 offen offset:256
    buffer_load_dword v98, v12, s[4:7], s54 offen offset:512
    buffer_load_dword v99, v12, s[4:7], s54 offen offset:768
    buffer_load_dword v100, v12, s[4:7], s54 offen offset:1024
    s_add_u32 s54, s67, 20480
    buffer_load_dword v101, v12, s[4:7], s54 offen offset:0
    buffer_load_dword v102, v12, s[4:7], s54 offen offset:256
    buffer_load_dword v103, v12, s[4:7], s54 offen offset:512
    buffer_load_dword v104, v12, s[4:7], s54 offen offset:768
    buffer_load_dword v105, v12, s[4:7], s54 offen offset:1024
L_wf_25:
    buffer_load_dword v124, v10, s[36:39], s69 offen sc1
    s_waitcnt vmcnt(0)
    v_cmp_eq_u32 vcc, 0, v124
    s_cbranch_vccz L_wfd_26
    s_sleep 2
    s_sub_u32 s53, s53, 1
    s_cbranch_scc0 L_wf_25
    s_branch L_fail
L_wfd_26:
    s_add_u32 s54, s66, 0
    buffer_load_dwordx2 v[16:17], v11, s[36:39], s54 offen offset:0 sc1
    buffer_load_dwordx2 v[18:19], v11, s[36:39], s54 offen offset:512 sc1
    buffer_load_dwordx2 v[20:21], v11, s[36:39], s54 offen offset:1024 sc1
    buffer_load_dwordx2 v[22:23], v11, s[36:39], s54 offen offset:1536 sc1
    buffer_load_dwordx2 v[24:25], v11, s[36:39], s54 offen offset:2048 sc1
    s_add_u32 s54, s66, 81920
    buffer_load_dwordx2 v[26:27], v11, s[36:39], s54 offen offset:0 sc1
    buffer_load_dwordx2 v[28:29], v11, s[36:39], s54 offen offset:512 sc1
    buffer_load_dwordx2 v[30:31], v11, s[36:39], s54 offen offset:1024 sc1
    buffer_load_dwordx2 v[32:33], v11, s[36:39], s54 offen offset:1536 sc1
    buffer_load_dwordx2 v[34:35], v11, s[36:39], s54 offen offset:2048 sc1
    s_add_u32 s54, s66, 163840
    buffer_load_dwordx2 v[36:37], v11, s[36:39], s54 offen offset:0 sc1
    buffer_load_dwordx2 v[38:39], v11, s[36:39], s54 offen offset:512 sc1
    buffer_load_dwordx2 v[40:41], v11, s[36:39], s54 offen offset:1024 sc1
    buffer_load_dwordx2 v[42:43], v11, s[36:39], s54 offen offset:1536 sc1
    buffer_load_dwordx2 v[44:45], v11, s[36:39], s54 offen offset:2048 sc1
    s_add_u32 s54, s66, 245760
    buffer_load_dwordx2 v[46:47], v11, s[36:39], s54 offen offset:0 sc1
    buffer_load_dwordx2 v[48:49], v11, s[36:39], s54 offen offset:512 sc1
    buffer_load_dwordx2 v[50:51], v11, s[36:39], s54 offen offset:1024 sc1
    buffer_load_dwordx2 v[52:53], v11, s[36:39], s54 offen offset:1536 sc1
    buffer_load_dwordx2 v[54:55], v11, s[36:39], s54 offen offset:2048 sc1
    s_add_u32 s54, s66, 40960
    buffer_load_dwordx2 v[56:57], v11, s[36:39], s54 offen offset:0 sc1
    buffer_load_dwordx2 v[58:59], v11, s[36:39], s54 offen offset:512 sc1
    buffer_load_dwordx2 v[60:61], v11, s[36:39], s54 offen offset:1024 sc1
    buffer_load_dwordx2 v[62:63], v11, s[36:39], s54 offen offset:1536 sc1
    buffer_load_dwordx2 v[64:65], v11, s[36:39], s54 offen offset:2048 sc1
    s_add_u32 s54, s66, 122880
    buffer_load_dwordx2 v[66:67], v11, s[36:39], s54 offen offset:0 sc1
    buffer_load_dwordx2 v[68:69], v11, s[36:39], s54 offen offset:512 sc1
    buffer_load_dwordx2 v[70:71], v11, s[36:39], s54 offen offset:1024 sc1
    buffer_load_dwordx2 v[72:73], v11, s[36:39], s54 offen offset:1536 sc1
    buffer_load_dwordx2 v[74:75], v11, s[36:39], s54 offen offset:2048 sc1
    s_add_u32 s54, s66, 204800
    buffer_load_dwordx2 v[76:77], v11, s[36:39], s54 offen offset:0 sc1
    buffer_load_dwordx2 v[78:79], v11, s[36:39], s54 offen offset:512 sc1
    buffer_load_dwordx2 v[80:81], v11, s[36:39], s54 offen offset:1024 sc1
    buffer_load_dwordx2 v[82:83], v11, s[36:39], s54 offen offset:1536 sc1
    buffer_load_dwordx2 v[84:85], v11, s[36:39], s54 offen offset:2048 sc1
    s_add_u32 s54, s66, 286720
    buffer_load_dwordx2 v[86:87], v11, s[36:39], s54 offen offset:0 sc1
    buffer_load_dwordx2 v[88:89], v11, s[36:39], s54 offen offset:512 sc1
    buffer_load_dwordx2 v[90:91], v11, s[36:39], s54 offen offset:1024 sc1
    buffer_load_dwordx2 v[92:93], v11, s[36:39], s54 offen offset:1536 sc1
    buffer_load_dwordx2 v[94:95], v11, s[36:39], s54 offen offset:2048 sc1
    s_waitcnt vmcnt(20)
    v_add_f32 v16, v16, v26
    v_add_f32 v17, v17, v27
    v_add_f32 v18, v18, v28
    v_add_f32 v19, v19, v29
    v_add_f32 v20, v20, v30
    v_add_f32 v21, v21, v31
    v_add_f32 v22, v22, v32
    v_add_f32 v23, v23, v33
    v_add_f32 v24, v24, v34
    v_add_f32 v25, v25, v35
    v_add_f32 v36, v36, v46
    v_add_f32 v37, v37, v47
    v_add_f32 v38, v38, v48
    v_add_f32 v39, v39, v49
    v_add_f32 v40, v40, v50
    v_add_f32 v41, v41, v51
    v_add_f32 v42, v42, v52
    v_add_f32 v43, v43, v53
    v_add_f32 v44, v44, v54
    v_add_f32 v45, v45, v55
    v_add_f32 v16, v16, v36
    v_add_f32 v17, v17, v37
    v_add_f32 v18, v18, v38
    v_add_f32 v19, v19, v39
    v_add_f32 v20, v20, v40
    v_add_f32 v21, v21, v41
    v_add_f32 v22, v22, v42
    v_add_f32 v23, v23, v43
    v_add_f32 v24, v24, v44
    v_add_f32 v25, v25, v45
    s_add_u32 s54, s67, 96468992
    v_cvt_pk_bf16_f32 v124, v16, v17
    v_lshlrev_b32 v112, 16, v124
    v_and_b32 v113, 0xffff0000, v124
    v_lshlrev_b32 v124, 16, v96
    v_and_b32 v125, 0xffff0000, v96
    v_add_f32 v112, v112, v124
    v_add_f32 v113, v113, v125
    v_cvt_pk_bf16_f32 v36, v112, v113
    v_lshlrev_b32 v112, 16, v36
    v_and_b32 v113, 0xffff0000, v36
    buffer_store_dword v36, v12, s[36:39], s54 offen offset:0 sc1
    v_cvt_pk_bf16_f32 v124, v18, v19
    v_lshlrev_b32 v114, 16, v124
    v_and_b32 v115, 0xffff0000, v124
    v_lshlrev_b32 v124, 16, v97
    v_and_b32 v125, 0xffff0000, v97
    v_add_f32 v114, v114, v124
    v_add_f32 v115, v115, v125
    v_cvt_pk_bf16_f32 v37, v114, v115
    v_lshlrev_b32 v114, 16, v37
    v_and_b32 v115, 0xffff0000, v37
    buffer_store_dword v37, v12, s[36:39], s54 offen offset:256 sc1
    v_cvt_pk_bf16_f32 v124, v20, v21
    v_lshlrev_b32 v116, 16, v124
    v_and_b32 v117, 0xffff0000, v124
    v_lshlrev_b32 v124, 16, v98
    v_and_b32 v125, 0xffff0000, v98
    v_add_f32 v116, v116, v124
    v_add_f32 v117, v117, v125
    v_cvt_pk_bf16_f32 v38, v116, v117
    v_lshlrev_b32 v116, 16, v38
    v_and_b32 v117, 0xffff0000, v38
    buffer_store_dword v38, v12, s[36:39], s54 offen offset:512 sc1
    v_cvt_pk_bf16_f32 v124, v22, v23
    v_lshlrev_b32 v118, 16, v124
    v_and_b32 v119, 0xffff0000, v124
    v_lshlrev_b32 v124, 16, v99
    v_and_b32 v125, 0xffff0000, v99
    v_add_f32 v118, v118, v124
    v_add_f32 v119, v119, v125
    v_cvt_pk_bf16_f32 v39, v118, v119
    v_lshlrev_b32 v118, 16, v39
    v_and_b32 v119, 0xffff0000, v39
    buffer_store_dword v39, v12, s[36:39], s54 offen offset:768 sc1
    v_cvt_pk_bf16_f32 v124, v24, v25
    v_lshlrev_b32 v120, 16, v124
    v_and_b32 v121, 0xffff0000, v124
    v_lshlrev_b32 v124, 16, v100
    v_and_b32 v125, 0xffff0000, v100
    v_add_f32 v120, v120, v124
    v_add_f32 v121, v121, v125
    v_cvt_pk_bf16_f32 v40, v120, v121
    v_lshlrev_b32 v120, 16, v40
    v_and_b32 v121, 0xffff0000, v40
    buffer_store_dword v40, v12, s[36:39], s54 offen offset:1024 sc1
    v_add_f32 v124, v112, v113
    v_add_f32 v124, v124, v114
    v_add_f32 v124, v124, v115
    v_add_f32 v124, v124, v116
    v_add_f32 v124, v124, v117
    v_add_f32 v124, v124, v118
    v_add_f32 v124, v124, v119
    v_add_f32 v124, v124, v120
    v_add_f32 v124, v124, v121
    s_nop 1
    v_add_f32_dpp v124, v124, v124 row_ror:8 row_mask:0xf bank_mask:0xf
    s_nop 1
    v_add_f32_dpp v124, v124, v124 row_ror:4 row_mask:0xf bank_mask:0xf
    s_nop 1
    v_add_f32_dpp v124, v124, v124 row_ror:2 row_mask:0xf bank_mask:0xf
    s_nop 1
    v_add_f32_dpp v124, v124, v124 row_ror:1 row_mask:0xf bank_mask:0xf
    v_mov_b32 v128, v124
    s_nop 1
    v_permlane32_swap_b32 v124, v128
    s_nop 0
    v_add_f32 v124, v124, v128
    v_mov_b32 v128, v124
    s_nop 1
    v_permlane16_swap_b32 v124, v128
    s_nop 0
    v_add_f32 v124, v124, v128
    v_mul_f32 v125, 0x3acccccd, v124
    v_mov_b32 v126, 0
    v_sub_f32 v127, v112, v125
    v_fmac_f32 v126, v127, v127
    v_sub_f32 v127, v113, v125
    v_fmac_f32 v126, v127, v127
    v_sub_f32 v127, v114, v125
    v_fmac_f32 v126, v127, v127
    v_sub_f32 v127, v115, v125
    v_fmac_f32 v126, v127, v127
    v_sub_f32 v127, v116, v125
    v_fmac_f32 v126, v127, v127
    v_sub_f32 v127, v117, v125
    v_fmac_f32 v126, v127, v127
    v_sub_f32 v127, v118, v125
    v_fmac_f32 v126, v127, v127
    v_sub_f32 v127, v119, v125
    v_fmac_f32 v126, v127, v127
    v_sub_f32 v127, v120, v125
    v_fmac_f32 v126, v127, v127
    v_sub_f32 v127, v121, v125
    v_fmac_f32 v126, v127, v127
    s_nop 1
    v_add_f32_dpp v126, v126, v126 row_ror:8 row_mask:0xf bank_mask:0xf
    s_nop 1
    v_add_f32_dpp v126, v126, v126 row_ror:4 row_mask:0xf bank_mask:0xf
    s_nop 1
    v_add_f32_dpp v126, v126, v126 row_ror:2 row_mask:0xf bank_mask:0xf
    s_nop 1
    v_add_f32_dpp v126, v126, v126 row_ror:1 row_mask:0xf bank_mask:0xf
    v_mov_b32 v128, v126
    s_nop 1
    v_permlane32_swap_b32 v126, v128
    s_nop 0
    v_add_f32 v126, v126, v128
    v_mov_b32 v128, v126
    s_nop 1
    v_permlane16_swap_b32 v126, v128
    s_nop 0
    v_add_f32 v126, v126, v128
    v_mul_f32 v126, 0x3acccccd, v126
    v_cvt_pk_bf16_f32 v126, v126, v126
    v_lshlrev_b32 v126, 16, v126
    v_add_f32 v126, 0x3727c5ac, v126
    v_cvt_pk_bf16_f32 v126, v126, v126
    v_lshlrev_b32 v126, 16, v126
    v_sqrt_f32 v126, v126
    s_nop 0
    v_cvt_pk_bf16_f32 v126, v126, v126
    v_lshlrev_b32 v126, 16, v126
    v_rcp_f32 v126, v126
    v_cvt_pk_bf16_f32 v125, v125, v125
    v_lshlrev_b32 v125, 16, v125
    v_sub_f32 v112, v112, v125
    v_sub_f32 v113, v113, v125
    v_cvt_pk_bf16_f32 v127, v112, v113
    v_lshlrev_b32 v112, 16, v127
    v_and_b32 v113, 0xffff0000, v127
    v_mul_f32 v112, v112, v126
    v_mul_f32 v113, v113, v126
    v_sub_f32 v114, v114, v125
    v_sub_f32 v115, v115, v125
    v_cvt_pk_bf16_f32 v127, v114, v115
    v_lshlrev_b32 v114, 16, v127
    v_and_b32 v115, 0xffff0000, v127
    v_mul_f32 v114, v114, v126
    v_mul_f32 v115, v115, v126
    v_sub_f32 v116, v116, v125
    v_sub_f32 v117, v117, v125
    v_cvt_pk_bf16_f32 v127, v116, v117
    v_lshlrev_b32 v116, 16, v127
    v_and_b32 v117, 0xffff0000, v127
    v_mul_f32 v116, v116, v126
    v_mul_f32 v117, v117, v126
    v_sub_f32 v118, v118, v125
    v_sub_f32 v119, v119, v125
    v_cvt_pk_bf16_f32 v127, v118, v119
    v_lshlrev_b32 v118, 16, v127
    v_and_b32 v119, 0xffff0000, v127
    v_mul_f32 v118, v118, v126
    v_mul_f32 v119, v119, v126
    v_sub_f32 v120, v120, v125
    v_sub_f32 v121, v121, v125
    v_cvt_pk_bf16_f32 v127, v120, v121
    v_lshlrev_b32 v120, 16, v127
    v_and_b32 v121, 0xffff0000, v127
    v_mul_f32 v120, v120, v126
    v_mul_f32 v121, v121, v126
    v_cvt_pk_bf16_f32 v16, v112, v113
    s_add_u32 s54, s68, 0
    buffer_store_dword v16, v13, s[36:39], s54 offen offset:0 sc1
    v_cvt_pk_bf16_f32 v17, v114, v115
    s_add_u32 s54, s68, 8192
    buffer_store_dword v17, v13, s[36:39], s54 offen offset:0 sc1
    v_cvt_pk_bf16_f32 v18, v116, v117
    s_add_u32 s54, s68, 16384
    buffer_store_dword v18, v13, s[36:39], s54 offen offset:0 sc1
    v_cvt_pk_bf16_f32 v19, v118, v119
    s_add_u32 s54, s68, 24576
    buffer_store_dword v19, v13, s[36:39], s54 offen offset:0 sc1
    v_cvt_pk_bf16_f32 v20, v120, v121
    s_add_u32 s54, s68, 32768
    buffer_store_dword v20, v13, s[36:39], s54 offen offset:0 sc1
    s_waitcnt vmcnt(10)
    v_add_f32 v56, v56, v66
    v_add_f32 v57, v57, v67
    v_add_f32 v58, v58, v68
    v_add_f32 v59, v59, v69
    v_add_f32 v60, v60, v70
    v_add_f32 v61, v61, v71
    v_add_f32 v62, v62, v72
    v_add_f32 v63, v63, v73
    v_add_f32 v64, v64, v74
    v_add_f32 v65, v65, v75
    v_add_f32 v76, v76, v86
    v_add_f32 v77, v77, v87
    v_add_f32 v78, v78, v88
    v_add_f32 v79, v79, v89
    v_add_f32 v80, v80, v90
    v_add_f32 v81, v81, v91
    v_add_f32 v82, v82, v92
    v_add_f32 v83, v83, v93
    v_add_f32 v84, v84, v94
    v_add_f32 v85, v85, v95
    v_add_f32 v56, v56, v76
    v_add_f32 v57, v57, v77
    v_add_f32 v58, v58, v78
    v_add_f32 v59, v59, v79
    v_add_f32 v60, v60, v80
    v_add_f32 v61, v61, v81
    v_add_f32 v62, v62, v82
    v_add_f32 v63, v63, v83
    v_add_f32 v64, v64, v84
    v_add_f32 v65, v65, v85
    s_add_u32 s54, s67, 96489472
    v_cvt_pk_bf16_f32 v124, v56, v57
    v_lshlrev_b32 v112, 16, v124
    v_and_b32 v113, 0xffff0000, v124
    v_lshlrev_b32 v124, 16, v101
    v_and_b32 v125, 0xffff0000, v101
    v_add_f32 v112, v112, v124
    v_add_f32 v113, v113, v125
    v_cvt_pk_bf16_f32 v76, v112, v113
    v_lshlrev_b32 v112, 16, v76
    v_and_b32 v113, 0xffff0000, v76
    buffer_store_dword v76, v12, s[36:39], s54 offen offset:0 sc1
    v_cvt_pk_bf16_f32 v124, v58, v59
    v_lshlrev_b32 v114, 16, v124
    v_and_b32 v115, 0xffff0000, v124
    v_lshlrev_b32 v124, 16, v102
    v_and_b32 v125, 0xffff0000, v102
    v_add_f32 v114, v114, v124
    v_add_f32 v115, v115, v125
    v_cvt_pk_bf16_f32 v77, v114, v115
    v_lshlrev_b32 v114, 16, v77
    v_and_b32 v115, 0xffff0000, v77
    buffer_store_dword v77, v12, s[36:39], s54 offen offset:256 sc1
    v_cvt_pk_bf16_f32 v124, v60, v61
    v_lshlrev_b32 v116, 16, v124
    v_and_b32 v117, 0xffff0000, v124
    v_lshlrev_b32 v124, 16, v103
    v_and_b32 v125, 0xffff0000, v103
    v_add_f32 v116, v116, v124
    v_add_f32 v117, v117, v125
    v_cvt_pk_bf16_f32 v78, v116, v117
    v_lshlrev_b32 v116, 16, v78
    v_and_b32 v117, 0xffff0000, v78
    buffer_store_dword v78, v12, s[36:39], s54 offen offset:512 sc1
    v_cvt_pk_bf16_f32 v124, v62, v63
    v_lshlrev_b32 v118, 16, v124
    v_and_b32 v119, 0xffff0000, v124
    v_lshlrev_b32 v124, 16, v104
    v_and_b32 v125, 0xffff0000, v104
    v_add_f32 v118, v118, v124
    v_add_f32 v119, v119, v125
    v_cvt_pk_bf16_f32 v79, v118, v119
    v_lshlrev_b32 v118, 16, v79
    v_and_b32 v119, 0xffff0000, v79
    buffer_store_dword v79, v12, s[36:39], s54 offen offset:768 sc1
    v_cvt_pk_bf16_f32 v124, v64, v65
    v_lshlrev_b32 v120, 16, v124
    v_and_b32 v121, 0xffff0000, v124
    v_lshlrev_b32 v124, 16, v105
    v_and_b32 v125, 0xffff0000, v105
    v_add_f32 v120, v120, v124
    v_add_f32 v121, v121, v125
    v_cvt_pk_bf16_f32 v80, v120, v121
    v_lshlrev_b32 v120, 16, v80
    v_and_b32 v121, 0xffff0000, v80
    buffer_store_dword v80, v12, s[36:39], s54 offen offset:1024 sc1
    v_add_f32 v124, v112, v113
    v_add_f32 v124, v124, v114
    v_add_f32 v124, v124, v115
    v_add_f32 v124, v124, v116
    v_add_f32 v124, v124, v117
    v_add_f32 v124, v124, v118
    v_add_f32 v124, v124, v119
    v_add_f32 v124, v124, v120
    v_add_f32 v124, v124, v121
    s_nop 1
    v_add_f32_dpp v124, v124, v124 row_ror:8 row_mask:0xf bank_mask:0xf
    s_nop 1
    v_add_f32_dpp v124, v124, v124 row_ror:4 row_mask:0xf bank_mask:0xf
    s_nop 1
    v_add_f32_dpp v124, v124, v124 row_ror:2 row_mask:0xf bank_mask:0xf
    s_nop 1
    v_add_f32_dpp v124, v124, v124 row_ror:1 row_mask:0xf bank_mask:0xf
    v_mov_b32 v128, v124
    s_nop 1
    v_permlane32_swap_b32 v124, v128
    s_nop 0
    v_add_f32 v124, v124, v128
    v_mov_b32 v128, v124
    s_nop 1
    v_permlane16_swap_b32 v124, v128
    s_nop 0
    v_add_f32 v124, v124, v128
    v_mul_f32 v125, 0x3acccccd, v124
    v_mov_b32 v126, 0
    v_sub_f32 v127, v112, v125
    v_fmac_f32 v126, v127, v127
    v_sub_f32 v127, v113, v125
    v_fmac_f32 v126, v127, v127
    v_sub_f32 v127, v114, v125
    v_fmac_f32 v126, v127, v127
    v_sub_f32 v127, v115, v125
    v_fmac_f32 v126, v127, v127
    v_sub_f32 v127, v116, v125
    v_fmac_f32 v126, v127, v127
    v_sub_f32 v127, v117, v125
    v_fmac_f32 v126, v127, v127
    v_sub_f32 v127, v118, v125
    v_fmac_f32 v126, v127, v127
    v_sub_f32 v127, v119, v125
    v_fmac_f32 v126, v127, v127
    v_sub_f32 v127, v120, v125
    v_fmac_f32 v126, v127, v127
    v_sub_f32 v127, v121, v125
    v_fmac_f32 v126, v127, v127
    s_nop 1
    v_add_f32_dpp v126, v126, v126 row_ror:8 row_mask:0xf bank_mask:0xf
    s_nop 1
    v_add_f32_dpp v126, v126, v126 row_ror:4 row_mask:0xf bank_mask:0xf
    s_nop 1
    v_add_f32_dpp v126, v126, v126 row_ror:2 row_mask:0xf bank_mask:0xf
    s_nop 1
    v_add_f32_dpp v126, v126, v126 row_ror:1 row_mask:0xf bank_mask:0xf
    v_mov_b32 v128, v126
    s_nop 1
    v_permlane32_swap_b32 v126, v128
    s_nop 0
    v_add_f32 v126, v126, v128
    v_mov_b32 v128, v126
    s_nop 1
    v_permlane16_swap_b32 v126, v128
    s_nop 0
    v_add_f32 v126, v126, v128
    v_mul_f32 v126, 0x3acccccd, v126
    v_cvt_pk_bf16_f32 v126, v126, v126
    v_lshlrev_b32 v126, 16, v126
    v_add_f32 v126, 0x3727c5ac, v126
    v_cvt_pk_bf16_f32 v126, v126, v126
    v_lshlrev_b32 v126, 16, v126
    v_sqrt_f32 v126, v126
    s_nop 0
    v_cvt_pk_bf16_f32 v126, v126, v126
    v_lshlrev_b32 v126, 16, v126
    v_rcp_f32 v126, v126
    v_cvt_pk_bf16_f32 v125, v125, v125
    v_lshlrev_b32 v125, 16, v125
    v_sub_f32 v112, v112, v125
    v_sub_f32 v113, v113, v125
    v_cvt_pk_bf16_f32 v127, v112, v113
    v_lshlrev_b32 v112, 16, v127
    v_and_b32 v113, 0xffff0000, v127
    v_mul_f32 v112, v112, v126
    v_mul_f32 v113, v113, v126
    v_sub_f32 v114, v114, v125
    v_sub_f32 v115, v115, v125
    v_cvt_pk_bf16_f32 v127, v114, v115
    v_lshlrev_b32 v114, 16, v127
    v_and_b32 v115, 0xffff0000, v127
    v_mul_f32 v114, v114, v126
    v_mul_f32 v115, v115, v126
    v_sub_f32 v116, v116, v125
    v_sub_f32 v117, v117, v125
    v_cvt_pk_bf16_f32 v127, v116, v117
    v_lshlrev_b32 v116, 16, v127
    v_and_b32 v117, 0xffff0000, v127
    v_mul_f32 v116, v116, v126
    v_mul_f32 v117, v117, v126
    v_sub_f32 v118, v118, v125
    v_sub_f32 v119, v119, v125
    v_cvt_pk_bf16_f32 v127, v118, v119
    v_lshlrev_b32 v118, 16, v127
    v_and_b32 v119, 0xffff0000, v127
    v_mul_f32 v118, v118, v126
    v_mul_f32 v119, v119, v126
    v_sub_f32 v120, v120, v125
    v_sub_f32 v121, v121, v125
    v_cvt_pk_bf16_f32 v127, v120, v121
    v_lshlrev_b32 v120, 16, v127
    v_and_b32 v121, 0xffff0000, v127
    v_mul_f32 v120, v120, v126
    v_mul_f32 v121, v121, v126
    v_cvt_pk_bf16_f32 v56, v112, v113
    s_add_u32 s54, s68, 0
    buffer_store_dword v56, v13, s[36:39], s54 offen offset:1024 sc1
    v_cvt_pk_bf16_f32 v57, v114, v115
    s_add_u32 s54, s68, 8192
    buffer_store_dword v57, v13, s[36:39], s54 offen offset:1024 sc1
    v_cvt_pk_bf16_f32 v58, v116, v117
    s_add_u32 s54, s68, 16384
    buffer_store_dword v58, v13, s[36:39], s54 offen offset:1024 sc1
    v_cvt_pk_bf16_f32 v59, v118, v119
    s_add_u32 s54, s68, 24576
    buffer_store_dword v59, v13, s[36:39], s54 offen offset:1024 sc1
    v_cvt_pk_bf16_f32 v60, v120, v121
    s_add_u32 s54, s68, 32768
    buffer_store_dword v60, v13, s[36:39], s54 offen offset:1024 sc1
    s_add_u32 s66, s66, 655360
    s_add_u32 s67, s67, 81920
    s_add_u32 s68, s68, 81920
    s_add_u32 s69, s69, 256
    s_waitcnt vmcnt(0)
    s_mov_b64 exec, 1
    buffer_store_dword v9, v8, s[36:39], s70 offen sc1
    s_mov_b64 exec, -1
    s_add_u32 s70, s70, 256
    s_add_u32 s52, s52, 2
    s_cmp_lt_u32 s52, 64
    s_cbranch_scc1 L_red_loop
    s_endpgm
L_ffn1:
    v_and_b32 v1, 63, v0
    v_lshlrev_b32 v2, 4, v1
    v_mov_b32 v8, 0
    v_mov_b32 v9, 1
    s_mov_b32 s55, 121634816
L_wf_27:
    buffer_load_dword v10, v8, s[36:39], s55 offen sc1
    s_waitcnt vmcnt(0)
    v_cmp_eq_u32 vcc, 0, v10
    s_cbranch_vccz L_wfd_28
    s_sleep 2
    s_sub_u32 s53, s53, 1
    s_cbranch_scc0 L_wf_27
    s_branch L_fail
L_wfd_28:
    s_cmp_ge_u32 s50, 14
    s_cselect_b32 s52, 1, 0
    s_cselect_b32 s54, 14, 0
    s_sub_u32 s50, s50, s54
    s_lshl_b32 s61, s50, 2
    s_add_u32 s61, s61, s49
    s_lshl_b32 s59, s61, 6
    v_lshrrev_b32 v5, 5, v1
    v_mul_u32_u24 v3, 4, v5
    v_bfe_u32 v5, v1, 3, 1
    v_mad_u32_u24 v3, v5, 8, v3
    v_bfe_u32 v5, v1, 2, 1
    v_mad_u32_u24 v3, v5, 2, v3
    v_bfe_u32 v5, v1, 1, 1
    v_mad_u32_u24 v3, v5, 1, v3
    v_mov_b32 v6, 3456
    v_mul_lo_u32 v3, v3, v6
    v_bfe_u32 v5, v1, 4, 1
    v_lshl_add_u32 v3, v5, 5, v3
    v_and_b32 v5, 1, v1
    v_lshl_add_u32 v3, v5, 4, v3
    s_mul_i32 s58, s49, 20480
    s_add_u32 s58, s58, 81920
    v_lshrrev_b32 v5, 5, v1
    v_lshlrev_b32 v4, 10, v5
    v_and_b32 v5, 31, v1
    v_lshl_add_u32 v4, v5, 3, v4
    v_add_u32 v4, s58, v4
    s_add_u32 s54, s59, 0
    s_add_u32 m0, s58, 0
    s_nop 0
    buffer_load_dwordx4 v3, s[24:27], s54 offen lds
    s_add_u32 s54, s59, 55296
    s_add_u32 m0, s58, 1024
    s_nop 0
    buffer_load_dwordx4 v3, s[24:27], s54 offen lds
    s_add_u32 s54, s59, 110592
    s_add_u32 m0, s58, 2048
    s_nop 0
    buffer_load_dwordx4 v3, s[24:27], s54 offen lds
    s_add_u32 s54, s59, 165888
    s_add_u32 m0, s58, 3072
    s_nop 0
    buffer_load_dwordx4 v3, s[24:27], s54 offen lds
    s_add_u32 s54, s59, 221184
    s_add_u32 m0, s58, 4096
    s_nop 0
    buffer_load_dwordx4 v3, s[24:27], s54 offen lds
    s_add_u32 s54, s59, 276480
    s_add_u32 m0, s58, 5120
    s_nop 0
    buffer_load_dwordx4 v3, s[24:27], s54 offen lds
    s_add_u32 s54, s59, 331776
    s_add_u32 m0, s58, 6144
    s_nop 0
    buffer_load_dwordx4 v3, s[24:27], s54 offen lds
    s_add_u32 s54, s59, 387072
    s_add_u32 m0, s58, 7168
    s_nop 0
    buffer_load_dwordx4 v3, s[24:27], s54 offen lds
    s_add_u32 s54, s59, 442368
    s_add_u32 m0, s58, 8192
    s_nop 0
    buffer_load_dwordx4 v3, s[24:27], s54 offen lds
    s_add_u32 s54, s59, 497664
    s_add_u32 m0, s58, 9216
    s_nop 0
    buffer_load_dwordx4 v3, s[24:27], s54 offen lds
    s_add_u32 s54, s59, 552960
    s_add_u32 m0, s58, 10240
    s_nop 0
    buffer_load_dwordx4 v3, s[24:27], s54 offen lds
    s_add_u32 s54, s59, 608256
    s_add_u32 m0, s58, 11264
    s_nop 0
    buffer_load_dwordx4 v3, s[24:27], s54 offen lds
    s_add_u32 s54, s59, 663552
    s_add_u32 m0, s58, 12288
    s_nop 0
    buffer_load_dwordx4 v3, s[24:27], s54 offen lds
    s_add_u32 s54, s59, 718848
    s_add_u32 m0, s58, 13312
    s_nop 0
    buffer_load_dwordx4 v3, s[24:27], s54 offen lds
    s_add_u32 s54, s59, 774144
    s_add_u32 m0, s58, 14336
    s_nop 0
    buffer_load_dwordx4 v3, s[24:27], s54 offen lds
    s_add_u32 s54, s59, 829440
    s_add_u32 m0, s58, 15360
    s_nop 0
    buffer_load_dwordx4 v3, s[24:27], s54 offen lds
    s_add_u32 s54, s59, 884736
    s_add_u32 m0, s58, 16384
    s_nop 0
    buffer_load_dwordx4 v3, s[24:27], s54 offen lds
    s_add_u32 s54, s59, 940032
    s_add_u32 m0, s58, 17408
    s_nop 0
    buffer_load_dwordx4 v3, s[24:27], s54 offen lds
    s_add_u32 s54, s59, 995328
    s_add_u32 m0, s58, 18432
    s_nop 0
    buffer_load_dwordx4 v3, s[24:27], s54 offen lds
    s_add_u32 s54, s59, 1050624
    s_add_u32 m0, s58, 19456
    s_nop 0
    buffer_load_dwordx4 v3, s[24:27], s54 offen lds
    s_waitcnt vmcnt(16)
    ds_read_b64_tr_b16 a[0:1], v4 offset:0
    ds_read_b64_tr_b16 a[2:3], v4 offset:512
    ds_read_b64_tr_b16 a[4:5], v4 offset:2048
    ds_read_b64_tr_b16 a[6:7], v4 offset:2560
    ds_read_b64_tr_b16 a[8:9], v4 offset:256
    ds_read_b64_tr_b16 a[10:11], v4 offset:768
    ds_read_b64_tr_b16 a[12:13], v4 offset:2304
    ds_read_b64_tr_b16 a[14:15], v4 offset:2816
    s_waitcnt lgkmcnt(0)
    s_add_u32 s54, s59, 1105920
    s_add_u32 m0, s58, 0
    s_nop 0
    buffer_load_dwordx4 v3, s[24:27], s54 offen lds
    s_add_u32 s54, s59, 1161216
    s_add_u32 m0, s58, 1024
    s_nop 0
    buffer_load_dwordx4 v3, s[24:27], s54 offen lds
    s_add_u32 s54, s59, 1216512
    s_add_u32 m0, s58, 2048
    s_nop 0
    buffer_load_dwordx4 v3, s[24:27], s54 offen lds
    s_add_u32 s54, s59, 1271808
    s_add_u32 m0, s58, 3072
    s_nop 0
    buffer_load_dwordx4 v3, s[24:27], s54 offen lds
    s_waitcnt vmcnt(16)
    ds_read_b64_tr_b16 a[16:17], v4 offset:4096
    ds_read_b64_tr_b16 a[18:19], v4 offset:4608
    ds_read_b64_tr_b16 a[20:21], v4 offset:6144
    ds_read_b64_tr_b16 a[22:23], v4 offset:6656
    ds_read_b64_tr_b16 a[24:25], v4 offset:4352
    ds_read_b64_tr_b16 a[26:27], v4 offset:4864
    ds_read_b64_tr_b16 a[28:29], v4 offset:6400
    ds_read_b64_tr_b16 a[30:31], v4 offset:6912
    s_waitcnt lgkmcnt(0)
    s_add_u32 s54, s59, 1327104
    s_add_u32 m0, s58, 4096
    s_nop 0
    buffer_load_dwordx4 v3, s[24:27], s54 offen lds
    s_add_u32 s54, s59, 1382400
    s_add_u32 m0, s58, 5120
    s_nop 0
    buffer_load_dwordx4 v3, s[24:27], s54 offen lds
    s_add_u32 s54, s59, 1437696
    s_add_u32 m0, s58, 6144
    s_nop 0
    buffer_load_dwordx4 v3, s[24:27], s54 offen lds
    s_add_u32 s54, s59, 1492992
    s_add_u32 m0, s58, 7168
    s_nop 0
    buffer_load_dwordx4 v3, s[24:27], s54 offen lds
    s_waitcnt vmcnt(16)
    ds_read_b64_tr_b16 a[32:33], v4 offset:8192
    ds_read_b64_tr_b16 a[34:35], v4 offset:8704
    ds_read_b64_tr_b16 a[36:37], v4 offset:10240
    ds_read_b64_tr_b16 a[38:39], v4 offset:10752
    ds_read_b64_tr_b16 a[40:41], v4 offset:8448
    ds_read_b64_tr_b16 a[42:43], v4 offset:8960
    ds_read_b64_tr_b16 a[44:45], v4 offset:10496
    ds_read_b64_tr_b16 a[46:47], v4 offset:11008
    s_waitcnt lgkmcnt(0)
    s_add_u32 s54, s59, 1548288
    s_add_u32 m0, s58, 8192
    s_nop 0
    buffer_load_dwordx4 v3, s[24:27], s54 offen lds
    s_add_u32 s54, s59, 1603584
    s_add_u32 m0, s58, 9216
    s_nop 0
    buffer_load_dwordx4 v3, s[24:27], s54 offen lds
    s_add_u32 s54, s59, 1658880
    s_add_u32 m0, s58, 10240
    s_nop 0
    buffer_load_dwordx4 v3, s[24:27], s54 offen lds
    s_add_u32 s54, s59, 1714176
    s_add_u32 m0, s58, 11264
    s_nop 0
    buffer_load_dwordx4 v3, s[24:27], s54 offen lds
    s_waitcnt vmcnt(16)
    ds_read_b64_tr_b16 a[48:49], v4 offset:12288
    ds_read_b64_tr_b16 a[50:51], v4 offset:12800
    ds_read_b64_tr_b16 a[52:53], v4 offset:14336
    ds_read_b64_tr_b16 a[54:55], v4 offset:14848
    ds_read_b64_tr_b16 a[56:57], v4 offset:12544
    ds_read_b64_tr_b16 a[58:59], v4 offset:13056
    ds_read_b64_tr_b16 a[60:61], v4 offset:14592
    ds_read_b64_tr_b16 a[62:63], v4 offset:15104
    s_waitcnt lgkmcnt(0)
    s_add_u32 s54, s59, 1769472
    s_add_u32 m0, s58, 12288
    s_nop 0
    buffer_load_dwordx4 v3, s[24:27], s54 offen lds
    s_add_u32 s54, s59, 1824768
    s_add_u32 m0, s58, 13312
    s_nop 0
    buffer_load_dwordx4 v3, s[24:27], s54 offen lds
    s_add_u32 s54, s59, 1880064
    s_add_u32 m0, s58, 14336
    s_nop 0
    buffer_load_dwordx4 v3, s[24:27], s54 offen lds
    s_add_u32 s54, s59, 1935360
    s_add_u32 m0, s58, 15360
    s_nop 0
    buffer_load_dwordx4 v3, s[24:27], s54 offen lds
    s_waitcnt vmcnt(16)
    ds_read_b64_tr_b16 a[64:65], v4 offset:16384
    ds_read_b64_tr_b16 a[66:67], v4 offset:16896
    ds_read_b64_tr_b16 a[68:69], v4 offset:18432
    ds_read_b64_tr_b16 a[70:71], v4 offset:18944
    ds_read_b64_tr_b16 a[72:73], v4 offset:16640
    ds_read_b64_tr_b16 a[74:75], v4 offset:17152
    ds_read_b64_tr_b16 a[76:77], v4 offset:18688
    ds_read_b64_tr_b16 a[78:79], v4 offset:19200
    s_waitcnt lgkmcnt(0)
    s_add_u32 s54, s59, 1990656
    s_add_u32 m0, s58, 16384
    s_nop 0
    buffer_load_dwordx4 v3, s[24:27], s54 offen lds
    s_add_u32 s54, s59, 2045952
    s_add_u32 m0, s58, 17408
    s_nop 0
    buffer_load_dwordx4 v3, s[24:27], s54 offen lds
    s_add_u32 s54, s59, 2101248
    s_add_u32 m0, s58, 18432
    s_nop 0
    buffer_load_dwordx4 v3, s[24:27], s54 offen lds
    s_add_u32 s54, s59, 2156544
    s_add_u32 m0, s58, 19456
    s_nop 0
    buffer_load_dwordx4 v3, s[24:27], s54 offen lds
    s_waitcnt vmcnt(16)
    ds_read_b64_tr_b16 a[80:81], v4 offset:0
    ds_read_b64_tr_b16 a[82:83], v4 offset:512
    ds_read_b64_tr_b16 a[84:85], v4 offset:2048
    ds_read_b64_tr_b16 a[86:87], v4 offset:2560
    ds_read_b64_tr_b16 a[88:89], v4 offset:256
    ds_read_b64_tr_b16 a[90:91], v4 offset:768
    ds_read_b64_tr_b16 a[92:93], v4 offset:2304
    ds_read_b64_tr_b16 a[94:95], v4 offset:2816
    s_waitcnt lgkmcnt(0)
    s_waitcnt vmcnt(12)
    ds_read_b64_tr_b16 a[96:97], v4 offset:4096
    ds_read_b64_tr_b16 a[98:99], v4 offset:4608
    ds_read_b64_tr_b16 a[100:101], v4 offset:6144
    ds_read_b64_tr_b16 a[102:103], v4 offset:6656
    ds_read_b64_tr_b16 a[104:105], v4 offset:4352
    ds_read_b64_tr_b16 a[106:107], v4 offset:4864
    ds_read_b64_tr_b16 a[108:109], v4 offset:6400
    ds_read_b64_tr_b16 a[110:111], v4 offset:6912
    s_waitcnt lgkmcnt(0)
    s_waitcnt vmcnt(8)
    ds_read_b64_tr_b16 a[112:113], v4 offset:8192
    ds_read_b64_tr_b16 a[114:115], v4 offset:8704
    ds_read_b64_tr_b16 a[116:117], v4 offset:10240
    ds_read_b64_tr_b16 a[118:119], v4 offset:10752
    ds_read_b64_tr_b16 a[120:121], v4 offset:8448
    ds_read_b64_tr_b16 a[122:123], v4 offset:8960
    ds_read_b64_tr_b16 a[124:125], v4 offset:10496
    ds_read_b64_tr_b16 a[126:127], v4 offset:11008
    s_waitcnt lgkmcnt(0)
    s_waitcnt vmcnt(4)
    ds_read_b64_tr_b16 a[128:129], v4 offset:12288
    ds_read_b64_tr_b16 a[130:131], v4 offset:12800
    ds_read_b64_tr_b16 a[132:133], v4 offset:14336
    ds_read_b64_tr_b16 a[134:135], v4 offset:14848
    ds_read_b64_tr_b16 a[136:137], v4 offset:12544
    ds_read_b64_tr_b16 a[138:139], v4 offset:13056
    ds_read_b64_tr_b16 a[140:141], v4 offset:14592
    ds_read_b64_tr_b16 a[142:143], v4 offset:15104
    s_waitcnt lgkmcnt(0)
    s_waitcnt vmcnt(0)
    ds_read_b64_tr_b16 a[144:145], v4 offset:16384
    ds_read_b64_tr_b16 a[146:147], v4 offset:16896
    ds_read_b64_tr_b16 a[148:149], v4 offset:18432
    ds_read_b64_tr_b16 a[150:151], v4 offset:18944
    ds_read_b64_tr_b16 a[152:153], v4 offset:16640
    ds_read_b64_tr_b16 a[154:155], v4 offset:17152
    ds_read_b64_tr_b16 a[156:157], v4 offset:18688
    ds_read_b64_tr_b16 a[158:159], v4 offset:19200
    s_waitcnt lgkmcnt(0)
    v_min_u32 v10, 15, v1
    v_lshlrev_b32 v10, 2, v10
    s_mul_i32 s62, s49, 5120
    s_mul_i32 s66, s52, 40960
    s_add_u32 s66, s66, s62
    s_add_u32 s66, s66, 92274688
    s_lshl_b32 s67, s52, 7
    s_add_u32 s67, s67, 121806848
    s_mul_i32 s68, s52, 110592
    s_lshl_b32 s54, s61, 11
    s_add_u32 s68, s68, s54
    s_add_u32 s68, s68, 100663296
    s_lshl_b32 s69, s52, 8
    s_lshl_b32 s54, s61, 2
    s_add_u32 s69, s69, s54
    s_add_u32 s69, s69, 121831424
L_ffn1_loop:
L_wf_29:
    buffer_load_dword v12, v10, s[36:39], s67 offen sc1
    s_waitcnt vmcnt(0)
    v_cmp_eq_u32 vcc, 0, v12
    s_cbranch_vccz L_wfd_30
    s_sleep 2
    s_sub_u32 s53, s53, 1
    s_cbranch_scc0 L_wf_29
    s_branch L_fail
L_wfd_30:
    s_barrier
    s_add_u32 s55, s66, 0
    s_add_u32 s56, s62, 0
    s_add_u32 s54, s55, 0
    s_add_u32 m0, s56, 0
    s_nop 0
    buffer_load_dwordx4 v2, s[36:39], s54 offen offset:0 sc1 lds
    buffer_load_dwordx4 v2, s[36:39], s54 offen offset:1024 sc1 lds
    buffer_load_dwordx4 v2, s[36:39], s54 offen offset:2048 sc1 lds
    buffer_load_dwordx4 v2, s[36:39], s54 offen offset:3072 sc1 lds
    s_add_u32 s54, s55, 4096
    s_add_u32 m0, s56, 4096
    s_nop 0
    buffer_load_dwordx4 v2, s[36:39], s54 offen offset:0 sc1 lds
    s_add_u32 s55, s66, 20480
    s_add_u32 s56, s62, 20480
    s_add_u32 s54, s55, 0
    s_add_u32 m0, s56, 0
    s_nop 0
    buffer_load_dwordx4 v2, s[36:39], s54 offen offset:0 sc1 lds
    buffer_load_dwordx4 v2, s[36:39], s54 offen offset:1024 sc1 lds
    buffer_load_dwordx4 v2, s[36:39], s54 offen offset:2048 sc1 lds
    buffer_load_dwordx4 v2, s[36:39], s54 offen offset:3072 sc1 lds
    s_add_u32 s54, s55, 4096
    s_add_u32 m0, s56, 4096
    s_nop 0
    buffer_load_dwordx4 v2, s[36:39], s54 offen offset:0 sc1 lds
    s_waitcnt vmcnt(5)
    s_barrier
    ds_read_b128 v[16:19], v2 offset:0
    ds_read_b128 v[20:23], v2 offset:1024
    ds_read_b128 v[24:27], v2 offset:2048
    ds_read_b128 v[28:31], v2 offset:3072
    ds_read_b128 v[32:35], v2 offset:4096
    ds_read_b128 v[36:39], v2 offset:5120
    s_waitcnt lgkmcnt(4)
    v_mfma_f32_16x16x32_bf16 v[40:43], a[0:3], v[16:19], 0
    v_mfma_f32_16x16x32_bf16 v[44:47], a[0:3], v[20:23], 0
    v_mfma_f32_16x16x32_bf16 v[48:51], a[8:11], v[16:19], 0
    v_mfma_f32_16x16x32_bf16 v[52:55], a[8:11], v[20:23], 0
    ds_read_b128 v[16:19], v2 offset:6144
    ds_read_b128 v[20:23], v2 offset:7168
    s_waitcnt lgkmcnt(4)
    v_mfma_f32_16x16x32_bf16 v[40:43], a[4:7], v[24:27], v[40:43]
    v_mfma_f32_16x16x32_bf16 v[44:47], a[4:7], v[28:31], v[44:47]
    v_mfma_f32_16x16x32_bf16 v[48:51], a[12:15], v[24:27], v[48:51]
    v_mfma_f32_16x16x32_bf16 v[52:55], a[12:15], v[28:31], v[52:55]
    ds_read_b128 v[24:27], v2 offset:8192
    ds_read_b128 v[28:31], v2 offset:9216
    s_waitcnt lgkmcnt(4)
    v_mfma_f32_16x16x32_bf16 v[40:43], a[16:19], v[32:35], v[40:43]
    v_mfma_f32_16x16x32_bf16 v[44:47], a[16:19], v[36:39], v[44:47]
    v_mfma_f32_16x16x32_bf16 v[48:51], a[24:27], v[32:35], v[48:51]
    v_mfma_f32_16x16x32_bf16 v[52:55], a[24:27], v[36:39], v[52:55]
    ds_read_b128 v[32:35], v2 offset:10240
    ds_read_b128 v[36:39], v2 offset:11264
    s_waitcnt lgkmcnt(4)
    v_mfma_f32_16x16x32_bf16 v[40:43], a[20:23], v[16:19], v[40:43]
    v_mfma_f32_16x16x32_bf16 v[44:47], a[20:23], v[20:23], v[44:47]
    v_mfma_f32_16x16x32_bf16 v[48:51], a[28:31], v[16:19], v[48:51]
    v_mfma_f32_16x16x32_bf16 v[52:55], a[28:31], v[20:23], v[52:55]
    ds_read_b128 v[16:19], v2 offset:12288
    ds_read_b128 v[20:23], v2 offset:13312
    s_waitcnt lgkmcnt(4)
    v_mfma_f32_16x16x32_bf16 v[40:43], a[32:35], v[24:27], v[40:43]
    v_mfma_f32_16x16x32_bf16 v[44:47], a[32:35], v[28:31], v[44:47]
    v_mfma_f32_16x16x32_bf16 v[48:51], a[40:43], v[24:27], v[48:51]
    v_mfma_f32_16x16x32_bf16 v[52:55], a[40:43], v[28:31], v[52:55]
    ds_read_b128 v[24:27], v2 offset:14336
    ds_read_b128 v[28:31], v2 offset:15360
    s_waitcnt lgkmcnt(4)
    v_mfma_f32_16x16x32_bf16 v[40:43], a[36:39], v[32:35], v[40:43]
    v_mfma_f32_16x16x32_bf16 v[44:47], a[36:39], v[36:39], v[44:47]
    v_mfma_f32_16x16x32_bf16 v[48:51], a[44:47], v[32:35], v[48:51]
    v_mfma_f32_16x16x32_bf16 v[52:55], a[44:47], v[36:39], v[52:55]
    ds_read_b128 v[32:35], v2 offset:16384
    ds_read_b128 v[36:39], v2 offset:17408
    s_waitcnt lgkmcnt(4)
    v_mfma_f32_16x16x32_bf16 v[40:43], a[48:51], v[16:19], v[40:43]
    v_mfma_f32_16x16x32_bf16 v[44:47], a[48:51], v[20:23], v[44:47]
    v_mfma_f32_16x16x32_bf16 v[48:51], a[56:59], v[16:19], v[48:51]
    v_mfma_f32_16x16x32_bf16 v[52:55], a[56:59], v[20:23], v[52:55]
    ds_read_b128 v[16:19], v2 offset:18432
    ds_read_b128 v[20:23], v2 offset:19456
    s_waitcnt lgkmcnt(4)
    v_mfma_f32_16x16x32_bf16 v[40:43], a[52:55], v[24:27], v[40:43]
    v_mfma_f32_16x16x32_bf16 v[44:47], a[52:55], v[28:31], v[44:47]
    v_mfma_f32_16x16x32_bf16 v[48:51], a[60:63], v[24:27], v[48:51]
    v_mfma_f32_16x16x32_bf16 v[52:55], a[60:63], v[28:31], v[52:55]
    s_waitcnt lgkmcnt(2)
    v_mfma_f32_16x16x32_bf16 v[40:43], a[64:67], v[32:35], v[40:43]
    v_mfma_f32_16x16x32_bf16 v[44:47], a[64:67], v[36:39], v[44:47]
    v_mfma_f32_16x16x32_bf16 v[48:51], a[72:75], v[32:35], v[48:51]
    v_mfma_f32_16x16x32_bf16 v[52:55], a[72:75], v[36:39], v[52:55]
    s_waitcnt lgkmcnt(0)
    v_mfma_f32_16x16x32_bf16 v[40:43], a[68:71], v[16:19], v[40:43]
    v_mfma_f32_16x16x32_bf16 v[44:47], a[68:71], v[20:23], v[44:47]
    v_mfma_f32_16x16x32_bf16 v[48:51], a[76:79], v[16:19], v[48:51]
    v_mfma_f32_16x16x32_bf16 v[52:55], a[76:79], v[20:23], v[52:55]
    s_waitcnt vmcnt(0)
    s_barrier
    ds_read_b128 v[16:19], v2 offset:20480
    ds_read_b128 v[20:23], v2 offset:21504
    ds_read_b128 v[24:27], v2 offset:22528
    ds_read_b128 v[28:31], v2 offset:23552
    ds_read_b128 v[32:35], v2 offset:24576
    ds_read_b128 v[36:39], v2 offset:25600
    s_waitcnt lgkmcnt(4)
    v_mfma_f32_16x16x32_bf16 v[40:43], a[80:83], v[16:19], v[40:43]
    v_mfma_f32_16x16x32_bf16 v[44:47], a[80:83], v[20:23], v[44:47]
    v_mfma_f32_16x16x32_bf16 v[48:51], a[88:91], v[16:19], v[48:51]
    v_mfma_f32_16x16x32_bf16 v[52:55], a[88:91], v[20:23], v[52:55]
    ds_read_b128 v[16:19], v2 offset:26624
    ds_read_b128 v[20:23], v2 offset:27648
    s_waitcnt lgkmcnt(4)
    v_mfma_f32_16x16x32_bf16 v[40:43], a[84:87], v[24:27], v[40:43]
    v_mfma_f32_16x16x32_bf16 v[44:47], a[84:87], v[28:31], v[44:47]
    v_mfma_f32_16x16x32_bf16 v[48:51], a[92:95], v[24:27], v[48:51]
    v_mfma_f32_16x16x32_bf16 v[52:55], a[92:95], v[28:31], v[52:55]
    ds_read_b128 v[24:27], v2 offset:28672
    ds_read_b128 v[28:31], v2 offset:29696
    s_waitcnt lgkmcnt(4)
    v_mfma_f32_16x16x32_bf16 v[40:43], a[96:99], v[32:35], v[40:43]
    v_mfma_f32_16x16x32_bf16 v[44:47], a[96:99], v[36:39], v[44:47]
    v_mfma_f32_16x16x32_bf16 v[48:51], a[104:107], v[32:35], v[48:51]
    v_mfma_f32_16x16x32_bf16 v[52:55], a[104:107], v[36:39], v[52:55]
    ds_read_b128 v[32:35], v2 offset:30720
    ds_read_b128 v[36:39], v2 offset:31744
    s_waitcnt lgkmcnt(4)
    v_mfma_f32_16x16x32_bf16 v[40:43], a[100:103], v[16:19], v[40:43]
    v_mfma_f32_16x16x32_bf16 v[44:47], a[100:103], v[20:23], v[44:47]
    v_mfma_f32_16x16x32_bf16 v[48:51], a[108:111], v[16:19], v[48:51]
    v_mfma_f32_16x16x32_bf16 v[52:55], a[108:111], v[20:23], v[52:55]
    ds_read_b128 v[16:19], v2 offset:32768
    ds_read_b128 v[20:23], v2 offset:33792
    s_waitcnt lgkmcnt(4)
    v_mfma_f32_16x16x32_bf16 v[40:43], a[112:115], v[24:27], v[40:43]
    v_mfma_f32_16x16x32_bf16 v[44:47], a[112:115], v[28:31], v[44:47]
    v_mfma_f32_16x16x32_bf16 v[48:51], a[120:123], v[24:27], v[48:51]
    v_mfma_f32_16x16x32_bf16 v[52:55], a[120:123], v[28:31], v[52:55]
    ds_read_b128 v[24:27], v2 offset:34816
    ds_read_b128 v[28:31], v2 offset:35840
    s_waitcnt lgkmcnt(4)
    v_mfma_f32_16x16x32_bf16 v[40:43], a[116:119], v[32:35], v[40:43]
    v_mfma_f32_16x16x32_bf16 v[44:47], a[116:119], v[36:39], v[44:47]
    v_mfma_f32_16x16x32_bf16 v[48:51], a[124:127], v[32:35], v[48:51]
    v_mfma_f32_16x16x32_bf16 v[52:55], a[124:127], v[36:39], v[52:55]
    ds_read_b128 v[32:35], v2 offset:36864
    ds_read_b128 v[36:39], v2 offset:37888
    s_waitcnt lgkmcnt(4)
    v_mfma_f32_16x16x32_bf16 v[40:43], a[128:131], v[16:19], v[40:43]
    v_mfma_f32_16x16x32_bf16 v[44:47], a[128:131], v[20:23], v[44:47]
    v_mfma_f32_16x16x32_bf16 v[48:51], a[136:139], v[16:19], v[48:51]
    v_mfma_f32_16x16x32_bf16 v[52:55], a[136:139], v[20:23], v[52:55]
    ds_read_b128 v[16:19], v2 offset:38912
    ds_read_b128 v[20:23], v2 offset:39936
    s_waitcnt lgkmcnt(4)
    v_mfma_f32_16x16x32_bf16 v[40:43], a[132:135], v[24:27], v[40:43]
    v_mfma_f32_16x16x32_bf16 v[44:47], a[132:135], v[28:31], v[44:47]
    v_mfma_f32_16x16x32_bf16 v[48:51], a[140:143], v[24:27], v[48:51]
    v_mfma_f32_16x16x32_bf16 v[52:55], a[140:143], v[28:31], v[52:55]
    s_waitcnt lgkmcnt(2)
    v_mfma_f32_16x16x32_bf16 v[40:43], a[144:147], v[32:35], v[40:43]
    v_mfma_f32_16x16x32_bf16 v[44:47], a[144:147], v[36:39], v[44:47]
    v_mfma_f32_16x16x32_bf16 v[48:51], a[152:155], v[32:35], v[48:51]
    v_mfma_f32_16x16x32_bf16 v[52:55], a[152:155], v[36:39], v[52:55]
    s_waitcnt lgkmcnt(0)
    v_mfma_f32_16x16x32_bf16 v[40:43], a[148:151], v[16:19], v[40:43]
    v_mfma_f32_16x16x32_bf16 v[44:47], a[148:151], v[20:23], v[44:47]
    v_mfma_f32_16x16x32_bf16 v[48:51], a[156:159], v[16:19], v[48:51]
    v_mfma_f32_16x16x32_bf16 v[52:55], a[156:159], v[20:23], v[52:55]
    s_cmp_ge_u32 s61, 54
    s_cbranch_scc1 L_ffn1_skip
    s_nop 5
    v_max_f32 v40, 0, v40
    v_max_f32 v41, 0, v41
    v_max_f32 v42, 0, v42
    v_max_f32 v43, 0, v43
    v_max_f32 v44, 0, v44
    v_max_f32 v45, 0, v45
    v_max_f32 v46, 0, v46
    v_max_f32 v47, 0, v47
    v_max_f32 v48, 0, v48
    v_max_f32 v49, 0, v49
    v_max_f32 v50, 0, v50
    v_max_f32 v51, 0, v51
    v_max_f32 v52, 0, v52
    v_max_f32 v53, 0, v53
    v_max_f32 v54, 0, v54
    v_max_f32 v55, 0, v55
    v_cvt_pk_bf16_f32 v56, v40, v41
    v_cvt_pk_bf16_f32 v57, v42, v43
    v_cvt_pk_bf16_f32 v58, v48, v49
    v_cvt_pk_bf16_f32 v59, v50, v51
    buffer_store_dwordx4 v[56:59], v2, s[36:39], s68 offen offset:0 sc1
    v_cvt_pk_bf16_f32 v60, v44, v45
    v_cvt_pk_bf16_f32 v61, v46, v47
    v_cvt_pk_bf16_f32 v62, v52, v53
    v_cvt_pk_bf16_f32 v63, v54, v55
    buffer_store_dwordx4 v[60:63], v2, s[36:39], s68 offen offset:1024 sc1
    s_waitcnt vmcnt(0)
    s_mov_b64 exec, 1
    buffer_store_dword v9, v8, s[36:39], s69 offen sc1
    s_mov_b64 exec, -1
L_ffn1_skip:
    s_add_u32 s66, s66, 81920
    s_add_u32 s67, s67, 256
    s_add_u32 s68, s68, 221184
    s_add_u32 s69, s69, 512
    s_add_u32 s52, s52, 2
    s_cmp_lt_u32 s52, 64
    s_cbranch_scc1 L_ffn1_loop
    s_endpgm
L_ffn2:
    v_and_b32 v1, 63, v0
    v_lshlrev_b32 v2, 4, v1
    v_mov_b32 v8, 0
    v_mov_b32 v9, 1
    s_mov_b32 s55, 121634816
L_wf_31:
    buffer_load_dword v10, v8, s[36:39], s55 offen sc1
    s_waitcnt vmcnt(0)
    v_cmp_eq_u32 vcc, 0, v10
    s_cbranch_vccz L_wfd_32
    s_sleep 2
    s_sub_u32 s53, s53, 1
    s_cbranch_scc0 L_wf_31
    s_branch L_fail
L_wfd_32:
    s_cmp_ge_u32 s50, 10
    s_cselect_b32 s52, 1, 0
    s_cselect_b32 s54, 10, 0
    s_sub_u32 s50, s50, s54
    s_lshr_b32 s69, s49, 1
    s_and_b32 s70, s49, 1
    s_lshl_b32 s61, s50, 1
    s_add_u32 s61, s61, s70
    s_mul_i32 s59, s69, 1105920
    s_lshl_b32 s54, s61, 6
    s_add_u32 s59, s59, s54
    v_lshrrev_b32 v5, 5, v1
    v_mul_u32_u24 v3, 16, v5
    v_bfe_u32 v5, v1, 3, 1
    v_mad_u32_u24 v3, v5, 4, v3
    v_bfe_u32 v5, v1, 2, 1
    v_mad_u32_u24 v3, v5, 2, v3
    v_bfe_u32 v5, v1, 1, 1
    v_mad_u32_u24 v3, v5, 1, v3
    v_mov_b32 v6, 1280
    v_mul_lo_u32 v3, v3, v6
    v_bfe_u32 v5, v1, 4, 1
    v_lshl_add_u32 v3, v5, 5, v3
    v_and_b32 v5, 1, v1
    v_lshl_add_u32 v3, v5, 4, v3
    s_mul_i32 s58, s49, 32768
    s_add_u32 s58, s58, 0
    v_lshrrev_b32 v5, 5, v1
    v_lshlrev_b32 v4, 10, v5
    v_bfe_u32 v5, v1, 2, 3
    v_lshl_add_u32 v4, v5, 5, v4
    v_bfe_u32 v5, v1, 1, 1
    v_lshl_add_u32 v4, v5, 8, v4
    v_and_b32 v5, 1, v1
    v_lshl_add_u32 v4, v5, 4, v4
    v_add_u32 v4, s58, v4
    s_add_u32 s54, s59, 0
    s_add_u32 m0, s58, 0
    s_nop 0
    buffer_load_dwordx4 v3, s[28:31], s54 offen lds
    s_add_u32 s54, s59, 10240
    s_add_u32 m0, s58, 1024
    s_nop 0
    buffer_load_dwordx4 v3, s[28:31], s54 offen lds
    s_add_u32 s54, s59, 40960
    s_add_u32 m0, s58, 2048
    s_nop 0
    buffer_load_dwordx4 v3, s[28:31], s54 offen lds
    s_add_u32 s54, s59, 51200
    s_add_u32 m0, s58, 3072
    s_nop 0
    buffer_load_dwordx4 v3, s[28:31], s54 offen lds
    s_add_u32 s54, s59, 81920
    s_add_u32 m0, s58, 4096
    s_nop 0
    buffer_load_dwordx4 v3, s[28:31], s54 offen lds
    s_add_u32 s54, s59, 92160
    s_add_u32 m0, s58, 5120
    s_nop 0
    buffer_load_dwordx4 v3, s[28:31], s54 offen lds
    s_add_u32 s54, s59, 122880
    s_add_u32 m0, s58, 6144
    s_nop 0
    buffer_load_dwordx4 v3, s[28:31], s54 offen lds
    s_add_u32 s54, s59, 133120
    s_add_u32 m0, s58, 7168
    s_nop 0
    buffer_load_dwordx4 v3, s[28:31], s54 offen lds
    s_add_u32 s54, s59, 163840
    s_add_u32 m0, s58, 8192
    s_nop 0
    buffer_load_dwordx4 v3, s[28:31], s54 offen lds
    s_add_u32 s54, s59, 174080
    s_add_u32 m0, s58, 9216
    s_nop 0
    buffer_load_dwordx4 v3, s[28:31], s54 offen lds
    s_add_u32 s54, s59, 204800
    s_add_u32 m0, s58, 10240
    s_nop 0
    buffer_load_dwordx4 v3, s[28:31], s54 offen lds
    s_add_u32 s54, s59, 215040
    s_add_u32 m0, s58, 11264
    s_nop 0
    buffer_load_dwordx4 v3, s[28:31], s54 offen lds
    s_add_u32 s54, s59, 245760
    s_add_u32 m0, s58, 12288
    s_nop 0
    buffer_load_dwordx4 v3, s[28:31], s54 offen lds
    s_add_u32 s54, s59, 256000
    s_add_u32 m0, s58, 13312
    s_nop 0
    buffer_load_dwordx4 v3, s[28:31], s54 offen lds
    s_add_u32 s54, s59, 286720
    s_add_u32 m0, s58, 14336
    s_nop 0
    buffer_load_dwordx4 v3, s[28:31], s54 offen lds
    s_add_u32 s54, s59, 296960
    s_add_u32 m0, s58, 15360
    s_nop 0
    buffer_load_dwordx4 v3, s[28:31], s54 offen lds
    s_add_u32 s54, s59, 327680
    s_add_u32 m0, s58, 16384
    s_nop 0
    buffer_load_dwordx4 v3, s[28:31], s54 offen lds
    s_add_u32 s54, s59, 337920
    s_add_u32 m0, s58, 17408
    s_nop 0
    buffer_load_dwordx4 v3, s[28:31], s54 offen lds
    s_add_u32 s54, s59, 368640
    s_add_u32 m0, s58, 18432
    s_nop 0
    buffer_load_dwordx4 v3, s[28:31], s54 offen lds
    s_add_u32 s54, s59, 378880
    s_add_u32 m0, s58, 19456
    s_nop 0
    buffer_load_dwordx4 v3, s[28:31], s54 offen lds
    s_add_u32 s54, s59, 409600
    s_add_u32 m0, s58, 20480
    s_nop 0
    buffer_load_dwordx4 v3, s[28:31], s54 offen lds
    s_add_u32 s54, s59, 419840
    s_add_u32 m0, s58, 21504
    s_nop 0
    buffer_load_dwordx4 v3, s[28:31], s54 offen lds
    s_add_u32 s54, s59, 450560
    s_add_u32 m0, s58, 22528
    s_nop 0
    buffer_load_dwordx4 v3, s[28:31], s54 offen lds
    s_add_u32 s54, s59, 460800
    s_add_u32 m0, s58, 23552
    s_nop 0
    buffer_load_dwordx4 v3, s[28:31], s54 offen lds
    s_add_u32 s54, s59, 491520
    s_add_u32 m0, s58, 24576
    s_nop 0
    buffer_load_dwordx4 v3, s[28:31], s54 offen lds
    s_add_u32 s54, s59, 501760
    s_add_u32 m0, s58, 25600
    s_nop 0
    buffer_load_dwordx4 v3, s[28:31], s54 offen lds
    s_add_u32 s54, s59, 532480
    s_add_u32 m0, s58, 26624
    s_nop 0
    buffer_load_dwordx4 v3, s[28:31], s54 offen lds
    s_add_u32 s54, s59, 542720
    s_add_u32 m0, s58, 27648
    s_nop 0
    buffer_load_dwordx4 v3, s[28:31], s54 offen lds
    s_add_u32 s54, s59, 573440
    s_add_u32 m0, s58, 28672
    s_nop 0
    buffer_load_dwordx4 v3, s[28:31], s54 offen lds
    s_add_u32 s54, s59, 583680
    s_add_u32 m0, s58, 29696
    s_nop 0
    buffer_load_dwordx4 v3, s[28:31], s54 offen lds
    s_add_u32 s54, s59, 614400
    s_add_u32 m0, s58, 30720
    s_nop 0
    buffer_load_dwordx4 v3, s[28:31], s54 offen lds
    s_add_u32 s54, s59, 624640
    s_add_u32 m0, s58, 31744
    s_nop 0
    buffer_load_dwordx4 v3, s[28:31], s54 offen lds
    s_waitcnt vmcnt(28)
    ds_read_b64_tr_b16 a[0:1], v4 offset:0
    ds_read_b64_tr_b16 a[2:3], v4 offset:512
    ds_read_b64_tr_b16 a[4:5], v4 offset:2048
    ds_read_b64_tr_b16 a[6:7], v4 offset:2560
    ds_read_b64_tr_b16 a[8:9], v4 offset:8
    ds_read_b64_tr_b16 a[10:11], v4 offset:520
    ds_read_b64_tr_b16 a[12:13], v4 offset:2056
    ds_read_b64_tr_b16 a[14:15], v4 offset:2568
    s_waitcnt lgkmcnt(0)
    s_add_u32 s54, s59, 655360
    s_add_u32 m0, s58, 0
    s_nop 0
    buffer_load_dwordx4 v3, s[28:31], s54 offen lds
    s_add_u32 s54, s59, 665600
    s_add_u32 m0, s58, 1024
    s_nop 0
    buffer_load_dwordx4 v3, s[28:31], s54 offen lds
    s_add_u32 s54, s59, 696320
    s_add_u32 m0, s58, 2048
    s_nop 0
    buffer_load_dwordx4 v3, s[28:31], s54 offen lds
    s_add_u32 s54, s59, 706560
    s_add_u32 m0, s58, 3072
    s_nop 0
    buffer_load_dwordx4 v3, s[28:31], s54 offen lds
    s_waitcnt vmcnt(28)
    ds_read_b64_tr_b16 a[16:17], v4 offset:4096
    ds_read_b64_tr_b16 a[18:19], v4 offset:4608
    ds_read_b64_tr_b16 a[20:21], v4 offset:6144
    ds_read_b64_tr_b16 a[22:23], v4 offset:6656
    ds_read_b64_tr_b16 a[24:25], v4 offset:4104
    ds_read_b64_tr_b16 a[26:27], v4 offset:4616
    ds_read_b64_tr_b16 a[28:29], v4 offset:6152
    ds_read_b64_tr_b16 a[30:31], v4 offset:6664
    s_waitcnt lgkmcnt(0)
    s_add_u32 s54, s59, 737280
    s_add_u32 m0, s58, 4096
    s_nop 0
    buffer_load_dwordx4 v3, s[28:31], s54 offen lds
    s_add_u32 s54, s59, 747520
    s_add_u32 m0, s58, 5120
    s_nop 0
    buffer_load_dwordx4 v3, s[28:31], s54 offen lds
    s_add_u32 s54, s59, 778240
    s_add_u32 m0, s58, 6144
    s_nop 0
    buffer_load_dwordx4 v3, s[28:31], s54 offen lds
    s_add_u32 s54, s59, 788480
    s_add_u32 m0, s58, 7168
    s_nop 0
    buffer_load_dwordx4 v3, s[28:31], s54 offen lds
    s_waitcnt vmcnt(28)
    ds_read_b64_tr_b16 a[32:33], v4 offset:8192
    ds_read_b64_tr_b16 a[34:35], v4 offset:8704
    ds_read_b64_tr_b16 a[36:37], v4 offset:10240
    ds_read_b64_tr_b16 a[38:39], v4 offset:10752
    ds_read_b64_tr_b16 a[40:41], v4 offset:8200
    ds_read_b64_tr_b16 a[42:43], v4 offset:8712
    ds_read_b64_tr_b16 a[44:45], v4 offset:10248
    ds_read_b64_tr_b16 a[46:47], v4 offset:10760
    s_waitcnt lgkmcnt(0)
    s_add_u32 s54, s59, 819200
    s_add_u32 m0, s58, 8192
    s_nop 0
    buffer_load_dwordx4 v3, s[28:31], s54 offen lds
    s_add_u32 s54, s59, 829440
    s_add_u32 m0, s58, 9216
    s_nop 0
    buffer_load_dwordx4 v3, s[28:31], s54 offen lds
    s_add_u32 s54, s59, 860160
    s_add_u32 m0, s58, 10240
    s_nop 0
    buffer_load_dwordx4 v3, s[28:31], s54 offen lds
    s_add_u32 s54, s59, 870400
    s_add_u32 m0, s58, 11264
    s_nop 0
    buffer_load_dwordx4 v3, s[28:31], s54 offen lds
    s_waitcnt vmcnt(28)
    ds_read_b64_tr_b16 a[48:49], v4 offset:12288
    ds_read_b64_tr_b16 a[50:51], v4 offset:12800
    ds_read_b64_tr_b16 a[52:53], v4 offset:14336
    ds_read_b64_tr_b16 a[54:55], v4 offset:14848
    ds_read_b64_tr_b16 a[56:57], v4 offset:12296
    ds_read_b64_tr_b16 a[58:59], v4 offset:12808
    ds_read_b64_tr_b16 a[60:61], v4 offset:14344
    ds_read_b64_tr_b16 a[62:63], v4 offset:14856
    s_waitcnt lgkmcnt(0)
    s_add_u32 s54, s59, 901120
    s_add_u32 m0, s58, 12288
    s_nop 0
    buffer_load_dwordx4 v3, s[28:31], s54 offen lds
    s_add_u32 s54, s59, 911360
    s_add_u32 m0, s58, 13312
    s_nop 0
    buffer_load_dwordx4 v3, s[28:31], s54 offen lds
    s_add_u32 s54, s59, 942080
    s_add_u32 m0, s58, 14336
    s_nop 0
    buffer_load_dwordx4 v3, s[28:31], s54 offen lds
    s_add_u32 s54, s59, 952320
    s_add_u32 m0, s58, 15360
    s_nop 0
    buffer_load_dwordx4 v3, s[28:31], s54 offen lds
    s_waitcnt vmcnt(28)
    ds_read_b64_tr_b16 a[64:65], v4 offset:16384
    ds_read_b64_tr_b16 a[66:67], v4 offset:16896
    ds_read_b64_tr_b16 a[68:69], v4 offset:18432
    ds_read_b64_tr_b16 a[70:71], v4 offset:18944
    ds_read_b64_tr_b16 a[72:73], v4 offset:16392
    ds_read_b64_tr_b16 a[74:75], v4 offset:16904
    ds_read_b64_tr_b16 a[76:77], v4 offset:18440
    ds_read_b64_tr_b16 a[78:79], v4 offset:18952
    s_waitcnt lgkmcnt(0)
    s_add_u32 s54, s59, 983040
    s_add_u32 m0, s58, 16384
    s_nop 0
    buffer_load_dwordx4 v3, s[28:31], s54 offen lds
    s_add_u32 s54, s59, 993280
    s_add_u32 m0, s58, 17408
    s_nop 0
    buffer_load_dwordx4 v3, s[28:31], s54 offen lds
    s_add_u32 s54, s59, 1024000
    s_add_u32 m0, s58, 18432
    s_nop 0
    buffer_load_dwordx4 v3, s[28:31], s54 offen lds
    s_add_u32 s54, s59, 1034240
    s_add_u32 m0, s58, 19456
    s_nop 0
    buffer_load_dwordx4 v3, s[28:31], s54 offen lds
    s_waitcnt vmcnt(28)
    ds_read_b64_tr_b16 a[80:81], v4 offset:20480
    ds_read_b64_tr_b16 a[82:83], v4 offset:20992
    ds_read_b64_tr_b16 a[84:85], v4 offset:22528
    ds_read_b64_tr_b16 a[86:87], v4 offset:23040
    ds_read_b64_tr_b16 a[88:89], v4 offset:20488
    ds_read_b64_tr_b16 a[90:91], v4 offset:21000
    ds_read_b64_tr_b16 a[92:93], v4 offset:22536
    ds_read_b64_tr_b16 a[94:95], v4 offset:23048
    s_waitcnt lgkmcnt(0)
    s_add_u32 s54, s59, 1064960
    s_add_u32 m0, s58, 20480
    s_nop 0
    buffer_load_dwordx4 v3, s[28:31], s54 offen lds
    s_add_u32 s54, s59, 1075200
    s_add_u32 m0, s58, 21504
    s_nop 0
    buffer_load_dwordx4 v3, s[28:31], s54 offen lds
    s_add_u32 s54, s59, 1105920
    s_add_u32 m0, s58, 22528
    s_nop 0
    buffer_load_dwordx4 v3, s[28:31], s54 offen lds
    s_add_u32 s54, s59, 1116160
    s_add_u32 m0, s58, 23552
    s_nop 0
    buffer_load_dwordx4 v3, s[28:31], s54 offen lds
    s_waitcnt vmcnt(28)
    ds_read_b64_tr_b16 a[96:97], v4 offset:24576
    ds_read_b64_tr_b16 a[98:99], v4 offset:25088
    ds_read_b64_tr_b16 a[100:101], v4 offset:26624
    ds_read_b64_tr_b16 a[102:103], v4 offset:27136
    ds_read_b64_tr_b16 a[104:105], v4 offset:24584
    ds_read_b64_tr_b16 a[106:107], v4 offset:25096
    ds_read_b64_tr_b16 a[108:109], v4 offset:26632
    ds_read_b64_tr_b16 a[110:111], v4 offset:27144
    s_waitcnt lgkmcnt(0)
    s_waitcnt vmcnt(24)
    ds_read_b64_tr_b16 a[112:113], v4 offset:28672
    ds_read_b64_tr_b16 a[114:115], v4 offset:29184
    ds_read_b64_tr_b16 a[116:117], v4 offset:30720
    ds_read_b64_tr_b16 a[118:119], v4 offset:31232
    ds_read_b64_tr_b16 a[120:121], v4 offset:28680
    ds_read_b64_tr_b16 a[122:123], v4 offset:29192
    ds_read_b64_tr_b16 a[124:125], v4 offset:30728
    ds_read_b64_tr_b16 a[126:127], v4 offset:31240
    s_waitcnt lgkmcnt(0)
    s_waitcnt vmcnt(20)
    ds_read_b64_tr_b16 a[128:129], v4 offset:0
    ds_read_b64_tr_b16 a[130:131], v4 offset:512
    ds_read_b64_tr_b16 a[132:133], v4 offset:2048
    ds_read_b64_tr_b16 a[134:135], v4 offset:2560
    ds_read_b64_tr_b16 a[136:137], v4 offset:8
    ds_read_b64_tr_b16 a[138:139], v4 offset:520
    ds_read_b64_tr_b16 a[140:141], v4 offset:2056
    ds_read_b64_tr_b16 a[142:143], v4 offset:2568
    s_waitcnt lgkmcnt(0)
    s_waitcnt vmcnt(16)
    ds_read_b64_tr_b16 a[144:145], v4 offset:4096
    ds_read_b64_tr_b16 a[146:147], v4 offset:4608
    ds_read_b64_tr_b16 a[148:149], v4 offset:6144
    ds_read_b64_tr_b16 a[150:151], v4 offset:6656
    ds_read_b64_tr_b16 a[152:153], v4 offset:4104
    ds_read_b64_tr_b16 a[154:155], v4 offset:4616
    ds_read_b64_tr_b16 a[156:157], v4 offset:6152
    ds_read_b64_tr_b16 a[158:159], v4 offset:6664
    s_waitcnt lgkmcnt(0)
    s_waitcnt vmcnt(12)
    ds_read_b64_tr_b16 a[160:161], v4 offset:8192
    ds_read_b64_tr_b16 a[162:163], v4 offset:8704
    ds_read_b64_tr_b16 a[164:165], v4 offset:10240
    ds_read_b64_tr_b16 a[166:167], v4 offset:10752
    ds_read_b64_tr_b16 a[168:169], v4 offset:8200
    ds_read_b64_tr_b16 a[170:171], v4 offset:8712
    ds_read_b64_tr_b16 a[172:173], v4 offset:10248
    ds_read_b64_tr_b16 a[174:175], v4 offset:10760
    s_waitcnt lgkmcnt(0)
    s_waitcnt vmcnt(8)
    ds_read_b64_tr_b16 a[176:177], v4 offset:12288
    ds_read_b64_tr_b16 a[178:179], v4 offset:12800
    ds_read_b64_tr_b16 a[180:181], v4 offset:14336
    ds_read_b64_tr_b16 a[182:183], v4 offset:14848
    ds_read_b64_tr_b16 a[184:185], v4 offset:12296
    ds_read_b64_tr_b16 a[186:187], v4 offset:12808
    ds_read_b64_tr_b16 a[188:189], v4 offset:14344
    ds_read_b64_tr_b16 a[190:191], v4 offset:14856
    s_waitcnt lgkmcnt(0)
    s_waitcnt vmcnt(4)
    ds_read_b64_tr_b16 a[192:193], v4 offset:16384
    ds_read_b64_tr_b16 a[194:195], v4 offset:16896
    ds_read_b64_tr_b16 a[196:197], v4 offset:18432
    ds_read_b64_tr_b16 a[198:199], v4 offset:18944
    ds_read_b64_tr_b16 a[200:201], v4 offset:16392
    ds_read_b64_tr_b16 a[202:203], v4 offset:16904
    ds_read_b64_tr_b16 a[204:205], v4 offset:18440
    ds_read_b64_tr_b16 a[206:207], v4 offset:18952
    s_waitcnt lgkmcnt(0)
    s_waitcnt vmcnt(0)
    ds_read_b64_tr_b16 a[208:209], v4 offset:20480
    ds_read_b64_tr_b16 a[210:211], v4 offset:20992
    ds_read_b64_tr_b16 a[212:213], v4 offset:22528
    ds_read_b64_tr_b16 a[214:215], v4 offset:23040
    ds_read_b64_tr_b16 a[216:217], v4 offset:20488
    ds_read_b64_tr_b16 a[218:219], v4 offset:21000
    ds_read_b64_tr_b16 a[220:221], v4 offset:22536
    ds_read_b64_tr_b16 a[222:223], v4 offset:23048
    s_waitcnt lgkmcnt(0)
    v_min_u32 v10, 53, v1
    v_lshlrev_b32 v10, 2, v10
    s_mul_i32 s62, s69, 55296
    v_add_u32 v7, s62, v2
    s_lshl_b32 s54, s70, 10
    s_add_u32 s62, s62, s54
    s_lshl_b32 s54, s49, 11
    s_add_u32 s54, s54, 114688
    v_add_u32 v11, s54, v2
    v_xor_b32 v12, 0x1000, v11
    v_and_b32 v3, 15, v1
    v_mul_u32_u24 v13, 1280, v3
    v_lshrrev_b32 v3, 4, v1
    v_lshl_add_u32 v13, v3, 4, v13
    s_mul_i32 s66, s52, 110592
    s_add_u32 s66, s66, s62
    s_add_u32 s66, s66, 100663296
    s_lshl_b32 s67, s52, 8
    s_add_u32 s67, s67, 121831424
    s_lshl_b32 s54, s52, 1
    s_add_u32 s54, s54, s69
    s_mul_i32 s68, s54, 20480
    s_lshl_b32 s54, s61, 6
    s_add_u32 s68, s68, s54
    s_barrier
L_ffn2_loop:
L_wf_33:
    buffer_load_dword v14, v10, s[36:39], s67 offen sc1
    s_waitcnt vmcnt(0)
    v_cmp_eq_u32 vcc, 0, v14
    s_cbranch_vccz L_wfd_34
    s_sleep 2
    s_sub_u32 s53, s53, 1
    s_cbranch_scc0 L_wf_33
    s_branch L_fail
L_wfd_34:
    s_add_u32 s55, s68, 96468992
    buffer_load_dwordx4 v[64:67], v13, s[36:39], s55 offen sc1
    s_add_u32 s54, s66, 0
    s_add_u32 m0, s62, 0
    s_nop 0
    buffer_load_dwordx4 v2, s[36:39], s54 offen offset:0 sc1 lds
    buffer_load_dwordx4 v2, s[36:39], s54 offen offset:2048 sc1 lds
    s_add_u32 s54, s66, 4096
    s_add_u32 m0, s62, 4096
    s_nop 0
    buffer_load_dwordx4 v2, s[36:39], s54 offen offset:0 sc1 lds
    buffer_load_dwordx4 v2, s[36:39], s54 offen offset:2048 sc1 lds
    s_add_u32 s54, s66, 8192
    s_add_u32 m0, s62, 8192
    s_nop 0
    buffer_load_dwordx4 v2, s[36:39], s54 offen offset:0 sc1 lds
    buffer_load_dwordx4 v2, s[36:39], s54 offen offset:2048 sc1 lds
    s_add_u32 s54, s66, 12288
    s_add_u32 m0, s62, 12288
    s_nop 0
    buffer_load_dwordx4 v2, s[36:39], s54 offen offset:0 sc1 lds
    buffer_load_dwordx4 v2, s[36:39], s54 offen offset:2048 sc1 lds
    s_add_u32 s54, s66, 16384
    s_add_u32 m0, s62, 16384
    s_nop 0
    buffer_load_dwordx4 v2, s[36:39], s54 offen offset:0 sc1 lds
    buffer_load_dwordx4 v2, s[36:39], s54 offen offset:2048 sc1 lds
    s_add_u32 s54, s66, 20480
    s_add_u32 m0, s62, 20480
    s_nop 0
    buffer_load_dwordx4 v2, s[36:39], s54 offen offset:0 sc1 lds
    buffer_load_dwordx4 v2, s[36:39], s54 offen offset:2048 sc1 lds
    s_add_u32 s54, s66, 24576
    s_add_u32 m0, s62, 24576
    s_nop 0
    buffer_load_dwordx4 v2, s[36:39], s54 offen offset:0 sc1 lds
    buffer_load_dwordx4 v2, s[36:39], s54 offen offset:2048 sc1 lds
    s_add_u32 s54, s66, 28672
    s_add_u32 m0, s62, 28672
    s_nop 0
    buffer_load_dwordx4 v2, s[36:39], s54 offen offset:0 sc1 lds
    buffer_load_dwordx4 v2, s[36:39], s54 offen offset:2048 sc1 lds
    s_add_u32 s54, s66, 32768
    s_add_u32 m0, s62, 32768
    s_nop 0
    buffer_load_dwordx4 v2, s[36:39], s54 offen offset:0 sc1 lds
    buffer_load_dwordx4 v2, s[36:39], s54 offen offset:2048 sc1 lds
    s_add_u32 s54, s66, 36864
    s_add_u32 m0, s62, 36864
    s_nop 0
    buffer_load_dwordx4 v2, s[36:39], s54 offen offset:0 sc1 lds
    buffer_load_dwordx4 v2, s[36:39], s54 offen offset:2048 sc1 lds
    s_add_u32 s54, s66, 40960
    s_add_u32 m0, s62, 40960
    s_nop 0
    buffer_load_dwordx4 v2, s[36:39], s54 offen offset:0 sc1 lds
    buffer_load_dwordx4 v2, s[36:39], s54 offen offset:2048 sc1 lds
    s_add_u32 s54, s66, 45056
    s_add_u32 m0, s62, 45056
    s_nop 0
    buffer_load_dwordx4 v2, s[36:39], s54 offen offset:0 sc1 lds
    buffer_load_dwordx4 v2, s[36:39], s54 offen offset:2048 sc1 lds
    s_add_u32 s54, s66, 49152
    s_add_u32 m0, s62, 49152
    s_nop 0
    buffer_load_dwordx4 v2, s[36:39], s54 offen offset:0 sc1 lds
    buffer_load_dwordx4 v2, s[36:39], s54 offen offset:2048 sc1 lds
    s_add_u32 s54, s66, 53248
    s_add_u32 m0, s62, 53248
    s_nop 0
    buffer_load_dwordx4 v2, s[36:39], s54 offen offset:0 sc1 lds
    s_waitcnt vmcnt(18)
    s_barrier
    ds_read_b128 v[16:19], v7 offset:0
    ds_read_b128 v[20:23], v7 offset:1024
    ds_read_b128 v[24:27], v7 offset:2048
    ds_read_b128 v[28:31], v7 offset:3072
    ds_read_b128 v[32:35], v7 offset:4096
    ds_read_b128 v[36:39], v7 offset:5120
    s_waitcnt lgkmcnt(4)
    v_mfma_f32_16x16x32_bf16 v[40:43], a[0:3], v[16:19], 0
    v_mfma_f32_16x16x32_bf16 v[44:47], a[0:3], v[20:23], 0
    v_mfma_f32_16x16x32_bf16 v[48:51], a[8:11], v[16:19], 0
    v_mfma_f32_16x16x32_bf16 v[52:55], a[8:11], v[20:23], 0
    ds_read_b128 v[16:19], v7 offset:6144
    ds_read_b128 v[20:23], v7 offset:7168
    s_waitcnt lgkmcnt(4)
    v_mfma_f32_16x16x32_bf16 v[40:43], a[4:7], v[24:27], v[40:43]
    v_mfma_f32_16x16x32_bf16 v[44:47], a[4:7], v[28:31], v[44:47]
    v_mfma_f32_16x16x32_bf16 v[48:51], a[12:15], v[24:27], v[48:51]
    v_mfma_f32_16x16x32_bf16 v[52:55], a[12:15], v[28:31], v[52:55]
    ds_read_b128 v[24:27], v7 offset:8192
    ds_read_b128 v[28:31], v7 offset:9216
    s_waitcnt lgkmcnt(4)
    v_mfma_f32_16x16x32_bf16 v[40:43], a[16:19], v[32:35], v[40:43]
    v_mfma_f32_16x16x32_bf16 v[44:47], a[16:19], v[36:39], v[44:47]
    v_mfma_f32_16x16x32_bf16 v[48:51], a[24:27], v[32:35], v[48:51]
    v_mfma_f32_16x16x32_bf16 v[52:55], a[24:27], v[36:39], v[52:55]
    ds_read_b128 v[32:35], v7 offset:10240
    ds_read_b128 v[36:39], v7 offset:11264
    s_waitcnt lgkmcnt(4)
    v_mfma_f32_16x16x32_bf16 v[40:43], a[20:23], v[16:19], v[40:43]
    v_mfma_f32_16x16x32_bf16 v[44:47], a[20:23], v[20:23], v[44:47]
    v_mfma_f32_16x16x32_bf16 v[48:51], a[28:31], v[16:19], v[48:51]
    v_mfma_f32_16x16x32_bf16 v[52:55], a[28:31], v[20:23], v[52:55]
    ds_read_b128 v[16:19], v7 offset:12288
    ds_read_b128 v[20:23], v7 offset:13312
    s_waitcnt lgkmcnt(4)
    v_mfma_f32_16x16x32_bf16 v[40:43], a[32:35], v[24:27], v[40:43]
    v_mfma_f32_16x16x32_bf16 v[44:47], a[32:35], v[28:31], v[44:47]
    v_mfma_f32_16x16x32_bf16 v[48:51], a[40:43], v[24:27], v[48:51]
    v_mfma_f32_16x16x32_bf16 v[52:55], a[40:43], v[28:31], v[52:55]
    ds_read_b128 v[24:27], v7 offset:14336
    ds_read_b128 v[28:31], v7 offset:15360
    s_waitcnt lgkmcnt(4)
    v_mfma_f32_16x16x32_bf16 v[40:43], a[36:39], v[32:35], v[40:43]
    v_mfma_f32_16x16x32_bf16 v[44:47], a[36:39], v[36:39], v[44:47]
    v_mfma_f32_16x16x32_bf16 v[48:51], a[44:47], v[32:35], v[48:51]
    v_mfma_f32_16x16x32_bf16 v[52:55], a[44:47], v[36:39], v[52:55]
    ds_read_b128 v[32:35], v7 offset:16384
    ds_read_b128 v[36:39], v7 offset:17408
    s_waitcnt lgkmcnt(4)
    v_mfma_f32_16x16x32_bf16 v[40:43], a[48:51], v[16:19], v[40:43]
    v_mfma_f32_16x16x32_bf16 v[44:47], a[48:51], v[20:23], v[44:47]
    v_mfma_f32_16x16x32_bf16 v[48:51], a[56:59], v[16:19], v[48:51]
    v_mfma_f32_16x16x32_bf16 v[52:55], a[56:59], v[20:23], v[52:55]
    s_waitcnt lgkmcnt(2)
    v_mfma_f32_16x16x32_bf16 v[40:43], a[52:55], v[24:27], v[40:43]
    v_mfma_f32_16x16x32_bf16 v[44:47], a[52:55], v[28:31], v[44:47]
    v_mfma_f32_16x16x32_bf16 v[48:51], a[60:63], v[24:27], v[48:51]
    v_mfma_f32_16x16x32_bf16 v[52:55], a[60:63], v[28:31], v[52:55]
    s_waitcnt lgkmcnt(0)
    v_mfma_f32_16x16x32_bf16 v[40:43], a[64:67], v[32:35], v[40:43]
    v_mfma_f32_16x16x32_bf16 v[44:47], a[64:67], v[36:39], v[44:47]
    v_mfma_f32_16x16x32_bf16 v[48:51], a[72:75], v[32:35], v[48:51]
    v_mfma_f32_16x16x32_bf16 v[52:55], a[72:75], v[36:39], v[52:55]
    s_waitcnt vmcnt(9)
    s_barrier
    ds_read_b128 v[16:19], v7 offset:18432
    ds_read_b128 v[20:23], v7 offset:19456
    ds_read_b128 v[24:27], v7 offset:20480
    ds_read_b128 v[28:31], v7 offset:21504
    ds_read_b128 v[32:35], v7 offset:22528
    ds_read_b128 v[36:39], v7 offset:23552
    s_waitcnt lgkmcnt(4)
    v_mfma_f32_16x16x32_bf16 v[40:43], a[68:71], v[16:19], v[40:43]
    v_mfma_f32_16x16x32_bf16 v[44:47], a[68:71], v[20:23], v[44:47]
    v_mfma_f32_16x16x32_bf16 v[48:51], a[76:79], v[16:19], v[48:51]
    v_mfma_f32_16x16x32_bf16 v[52:55], a[76:79], v[20:23], v[52:55]
    ds_read_b128 v[16:19], v7 offset:24576
    ds_read_b128 v[20:23], v7 offset:25600
    s_waitcnt lgkmcnt(4)
    v_mfma_f32_16x16x32_bf16 v[40:43], a[80:83], v[24:27], v[40:43]
    v_mfma_f32_16x16x32_bf16 v[44:47], a[80:83], v[28:31], v[44:47]
    v_mfma_f32_16x16x32_bf16 v[48:51], a[88:91], v[24:27], v[48:51]
    v_mfma_f32_16x16x32_bf16 v[52:55], a[88:91], v[28:31], v[52:55]
    ds_read_b128 v[24:27], v7 offset:26624
    ds_read_b128 v[28:31], v7 offset:27648
    s_waitcnt lgkmcnt(4)
    v_mfma_f32_16x16x32_bf16 v[40:43], a[84:87], v[32:35], v[40:43]
    v_mfma_f32_16x16x32_bf16 v[44:47], a[84:87], v[36:39], v[44:47]
    v_mfma_f32_16x16x32_bf16 v[48:51], a[92:95], v[32:35], v[48:51]
    v_mfma_f32_16x16x32_bf16 v[52:55], a[92:95], v[36:39], v[52:55]
    ds_read_b128 v[32:35], v7 offset:28672
    ds_read_b128 v[36:39], v7 offset:29696
    s_waitcnt lgkmcnt(4)
    v_mfma_f32_16x16x32_bf16 v[40:43], a[96:99], v[16:19], v[40:43]
    v_mfma_f32_16x16x32_bf16 v[44:47], a[96:99], v[20:23], v[44:47]
    v_mfma_f32_16x16x32_bf16 v[48:51], a[104:107], v[16:19], v[48:51]
    v_mfma_f32_16x16x32_bf16 v[52:55], a[104:107], v[20:23], v[52:55]
    ds_read_b128 v[16:19], v7 offset:30720
    ds_read_b128 v[20:23], v7 offset:31744
    s_waitcnt lgkmcnt(4)
    v_mfma_f32_16x16x32_bf16 v[40:43], a[100:103], v[24:27], v[40:43]
    v_mfma_f32_16x16x32_bf16 v[44:47], a[100:103], v[28:31], v[44:47]
    v_mfma_f32_16x16x32_bf16 v[48:51], a[108:111], v[24:27], v[48:51]
    v_mfma_f32_16x16x32_bf16 v[52:55], a[108:111], v[28:31], v[52:55]
    ds_read_b128 v[24:27], v7 offset:32768
    ds_read_b128 v[28:31], v7 offset:33792
    s_waitcnt lgkmcnt(4)
    v_mfma_f32_16x16x32_bf16 v[40:43], a[112:115], v[32:35], v[40:43]
    v_mfma_f32_16x16x32_bf16 v[44:47], a[112:115], v[36:39], v[44:47]
    v_mfma_f32_16x16x32_bf16 v[48:51], a[120:123], v[32:35], v[48:51]
    v_mfma_f32_16x16x32_bf16 v[52:55], a[120:123], v[36:39], v[52:55]
    ds_read_b128 v[32:35], v7 offset:34816
    ds_read_b128 v[36:39], v7 offset:35840
    s_waitcnt lgkmcnt(4)
    v_mfma_f32_16x16x32_bf16 v[40:43], a[116:119], v[16:19], v[40:43]
    v_mfma_f32_16x16x32_bf16 v[44:47], a[116:119], v[20:23], v[44:47]
    v_mfma_f32_16x16x32_bf16 v[48:51], a[124:127], v[16:19], v[48:51]
    v_mfma_f32_16x16x32_bf16 v[52:55], a[124:127], v[20:23], v[52:55]
    s_waitcnt lgkmcnt(2)
    v_mfma_f32_16x16x32_bf16 v[40:43], a[128:131], v[24:27], v[40:43]
    v_mfma_f32_16x16x32_bf16 v[44:47], a[128:131], v[28:31], v[44:47]
    v_mfma_f32_16x16x32_bf16 v[48:51], a[136:139], v[24:27], v[48:51]
    v_mfma_f32_16x16x32_bf16 v[52:55], a[136:139], v[28:31], v[52:55]
    s_waitcnt lgkmcnt(0)
    v_mfma_f32_16x16x32_bf16 v[40:43], a[132:135], v[32:35], v[40:43]
    v_mfma_f32_16x16x32_bf16 v[44:47], a[132:135], v[36:39], v[44:47]
    v_mfma_f32_16x16x32_bf16 v[48:51], a[140:143], v[32:35], v[48:51]
    v_mfma_f32_16x16x32_bf16 v[52:55], a[140:143], v[36:39], v[52:55]
    s_waitcnt vmcnt(0)
    s_barrier
    ds_read_b128 v[16:19], v7 offset:36864
    ds_read_b128 v[20:23], v7 offset:37888
    ds_read_b128 v[24:27], v7 offset:38912
    ds_read_b128 v[28:31], v7 offset:39936
    ds_read_b128 v[32:35], v7 offset:40960
    ds_read_b128 v[36:39], v7 offset:41984
    s_waitcnt lgkmcnt(4)
    v_mfma_f32_16x16x32_bf16 v[40:43], a[144:147], v[16:19], v[40:43]
    v_mfma_f32_16x16x32_bf16 v[44:47], a[144:147], v[20:23], v[44:47]
    v_mfma_f32_16x16x32_bf16 v[48:51], a[152:155], v[16:19], v[48:51]
    v_mfma_f32_16x16x32_bf16 v[52:55], a[152:155], v[20:23], v[52:55]
    ds_read_b128 v[16:19], v7 offset:43008
    ds_read_b128 v[20:23], v7 offset:44032
    s_waitcnt lgkmcnt(4)
    v_mfma_f32_16x16x32_bf16 v[40:43], a[148:151], v[24:27], v[40:43]
    v_mfma_f32_16x16x32_bf16 v[44:47], a[148:151], v[28:31], v[44:47]
    v_mfma_f32_16x16x32_bf16 v[48:51], a[156:159], v[24:27], v[48:51]
    v_mfma_f32_16x16x32_bf16 v[52:55], a[156:159], v[28:31], v[52:55]
    ds_read_b128 v[24:27], v7 offset:45056
    ds_read_b128 v[28:31], v7 offset:46080
    s_waitcnt lgkmcnt(4)
    v_mfma_f32_16x16x32_bf16 v[40:43], a[160:163], v[32:35], v[40:43]
    v_mfma_f32_16x16x32_bf16 v[44:47], a[160:163], v[36:39], v[44:47]
    v_mfma_f32_16x16x32_bf16 v[48:51], a[168:171], v[32:35], v[48:51]
    v_mfma_f32_16x16x32_bf16 v[52:55], a[168:171], v[36:39], v[52:55]
    ds_read_b128 v[32:35], v7 offset:47104
    ds_read_b128 v[36:39], v7 offset:48128
    s_waitcnt lgkmcnt(4)
    v_mfma_f32_16x16x32_bf16 v[40:43], a[164:167], v[16:19], v[40:43]
    v_mfma_f32_16x16x32_bf16 v[44:47], a[164:167], v[20:23], v[44:47]
    v_mfma_f32_16x16x32_bf16 v[48:51], a[172:175], v[16:19], v[48:51]
    v_mfma_f32_16x16x32_bf16 v[52:55], a[172:175], v[20:23], v[52:55]
    ds_read_b128 v[16:19], v7 offset:49152
    ds_read_b128 v[20:23], v7 offset:50176
    s_waitcnt lgkmcnt(4)
    v_mfma_f32_16x16x32_bf16 v[40:43], a[176:179], v[24:27], v[40:43]
    v_mfma_f32_16x16x32_bf16 v[44:47], a[176:179], v[28:31], v[44:47]
    v_mfma_f32_16x16x32_bf16 v[48:51], a[184:187], v[24:27], v[48:51]
    v_mfma_f32_16x16x32_bf16 v[52:55], a[184:187], v[28:31], v[52:55]
    ds_read_b128 v[24:27], v7 offset:51200
    ds_read_b128 v[28:31], v7 offset:52224
    s_waitcnt lgkmcnt(4)
    v_mfma_f32_16x16x32_bf16 v[40:43], a[180:183], v[32:35], v[40:43]
    v_mfma_f32_16x16x32_bf16 v[44:47], a[180:183], v[36:39], v[44:47]
    v_mfma_f32_16x16x32_bf16 v[48:51], a[188:191], v[32:35], v[48:51]
    v_mfma_f32_16x16x32_bf16 v[52:55], a[188:191], v[36:39], v[52:55]
    ds_read_b128 v[32:35], v7 offset:53248
    ds_read_b128 v[36:39], v7 offset:54272
    s_waitcnt lgkmcnt(4)
    v_mfma_f32_16x16x32_bf16 v[40:43], a[192:195], v[16:19], v[40:43]
    v_mfma_f32_16x16x32_bf16 v[44:47], a[192:195], v[20:23], v[44:47]
    v_mfma_f32_16x16x32_bf16 v[48:51], a[200:203], v[16:19], v[48:51]
    v_mfma_f32_16x16x32_bf16 v[52:55], a[200:203], v[20:23], v[52:55]
    s_waitcnt lgkmcnt(2)
    v_mfma_f32_16x16x32_bf16 v[40:43], a[196:199], v[24:27], v[40:43]
    v_mfma_f32_16x16x32_bf16 v[44:47], a[196:199], v[28:31], v[44:47]
    v_mfma_f32_16x16x32_bf16 v[48:51], a[204:207], v[24:27], v[48:51]
    v_mfma_f32_16x16x32_bf16 v[52:55], a[204:207], v[28:31], v[52:55]
    s_waitcnt lgkmcnt(0)
    v_mfma_f32_16x16x32_bf16 v[40:43], a[208:211], v[32:35], v[40:43]
    v_mfma_f32_16x16x32_bf16 v[44:47], a[208:211], v[36:39], v[44:47]
    v_mfma_f32_16x16x32_bf16 v[48:51], a[216:219], v[32:35], v[48:51]
    v_mfma_f32_16x16x32_bf16 v[52:55], a[216:219], v[36:39], v[52:55]
    s_nop 6
    s_cmp_eq_u32 s69, 0
    s_cbranch_scc1 L_ffn2_k0
    v_swap_b32 v40, v44
    v_swap_b32 v41, v45
    v_swap_b32 v42, v46
    v_swap_b32 v43, v47
    v_swap_b32 v48, v52
    v_swap_b32 v49, v53
    v_swap_b32 v50, v54
    v_swap_b32 v51, v55
L_ffn2_k0:
    ds_write_b128 v11, v[44:47] offset:0
    ds_write_b128 v11, v[52:55] offset:1024
    s_waitcnt lgkmcnt(0)
    s_barrier
    ds_read_b128 v[44:47], v12 offset:0
    ds_read_b128 v[52:55], v12 offset:1024
    s_waitcnt lgkmcnt(0)
    v_add_f32 v40, v40, v44
    v_add_f32 v41, v41, v45
    v_add_f32 v42, v42, v46
    v_add_f32 v43, v43, v47
    v_add_f32 v48, v48, v52
    v_add_f32 v49, v49, v53
    v_add_f32 v50, v50, v54
    v_add_f32 v51, v51, v55
    v_cvt_pk_bf16_f32 v56, v40, v41
    v_lshlrev_b32 v40, 16, v56
    v_and_b32 v41, 0xffff0000, v56
    v_lshlrev_b32 v56, 16, v64
    v_and_b32 v57, 0xffff0000, v64
    v_add_f32 v40, v40, v56
    v_add_f32 v41, v41, v57
    v_cvt_pk_bf16_f32 v60, v40, v41
    v_cvt_pk_bf16_f32 v56, v42, v43
    v_lshlrev_b32 v42, 16, v56
    v_and_b32 v43, 0xffff0000, v56
    v_lshlrev_b32 v56, 16, v65
    v_and_b32 v57, 0xffff0000, v65
    v_add_f32 v42, v42, v56
    v_add_f32 v43, v43, v57
    v_cvt_pk_bf16_f32 v61, v42, v43
    v_cvt_pk_bf16_f32 v56, v48, v49
    v_lshlrev_b32 v48, 16, v56
    v_and_b32 v49, 0xffff0000, v56
    v_lshlrev_b32 v56, 16, v66
    v_and_b32 v57, 0xffff0000, v66
    v_add_f32 v48, v48, v56
    v_add_f32 v49, v49, v57
    v_cvt_pk_bf16_f32 v62, v48, v49
    v_cvt_pk_bf16_f32 v56, v50, v51
    v_lshlrev_b32 v50, 16, v56
    v_and_b32 v51, 0xffff0000, v56
    v_lshlrev_b32 v56, 16, v67
    v_and_b32 v57, 0xffff0000, v67
    v_add_f32 v50, v50, v56
    v_add_f32 v51, v51, v57
    v_cvt_pk_bf16_f32 v63, v50, v51
    buffer_store_dwordx4 v[60:63], v13, s[32:35], s68 offen
    s_add_u32 s66, s66, 221184
    s_add_u32 s67, s67, 512
    s_add_u32 s68, s68, 81920
    s_add_u32 s52, s52, 2
    s_cmp_lt_u32 s52, 64
    s_cbranch_scc1 L_ffn2_loop
    s_endpgm
.section .rodata,"a"
.p2align 6
.amdhsa_kernel prep_kernel
  .amdhsa_next_free_vgpr 96
  .amdhsa_next_free_sgpr 102
  .amdhsa_accum_offset 96
  .amdhsa_group_segment_fixed_size 0
  .amdhsa_kernarg_size 104
  .amdhsa_user_sgpr_count 2
  .amdhsa_user_sgpr_kernarg_segment_ptr 1
  .amdhsa_system_sgpr_workgroup_id_x 1
.end_amdhsa_kernel
.p2align 6
.amdhsa_kernel main_kernel
  .amdhsa_next_free_vgpr 512
  .amdhsa_next_free_sgpr 102
  .amdhsa_accum_offset 256
  .amdhsa_group_segment_fixed_size 0
  .amdhsa_kernarg_size 104
  .amdhsa_user_sgpr_count 2
  .amdhsa_user_sgpr_kernarg_segment_ptr 1
  .amdhsa_system_sgpr_workgroup_id_x 1
.end_amdhsa_kernel
```
